```python
import torch

def _softmax(x, axis=-1):
    return torch.softmax(x, dim=axis)

def _gelu(x):
    return torch.nn.functional.gelu(x, approximate='tanh')

def _silu(x):
    return torch.nn.functional.silu(x)

def _sigmoid(x):
    return torch.sigmoid(x)

def _layernorm(x, axis=-1, eps=1e-05):
    m = x.mean(dim=axis, keepdim=True)
    v = x.var(dim=axis, keepdim=True, unbiased=False)
    return (x - m) / torch.sqrt(v + eps)

def _scatter_add(tgt, idx, src, axis=0):
    return tgt.clone().index_add_(axis, idx, src)

def _segment_sum(src, seg, n):
    out = torch.zeros((n,) + src.shape[1:], dtype=src.dtype)
    return out.index_add_(0, seg, src)

def _pad(x, pw):
    flat = tuple((v for pair in reversed(pw) for v in pair))
    return torch.nn.functional.pad(x, flat)
kernel_name = 'recurrent_scan__softmax_full_mha__mixer_gmlp__prompt'

def setup_inputs():

    _w = lambda a: (lambda t: t.to(torch.bfloat16) if t.is_floating_point() else t)(torch.as_tensor(a))

    def _A_setup():
        B, S, D = (1, 2048, 640)
        return {'x': _w((lambda *s: torch.randn(*s, dtype=torch.bfloat16) * 0.05)(B, S, D)), 'wqkv': _w((lambda *s: torch.randn(*s, dtype=torch.bfloat16) * 0.05)(D, 3 * D)), 'wo': _w((lambda *s: torch.randn(*s, dtype=torch.bfloat16) * 0.05)(D, D))}
    _A_in = _A_setup()

    def _B_setup():
        B, S, D, F = (1, 2048, 640, 1728)
        Fh = F // 2
        return {'x': _w((lambda *s: torch.randn(*s, dtype=torch.bfloat16) * 0.05)(B, S, D)), 'w_in': _w((lambda *s: torch.randn(*s, dtype=torch.bfloat16) * 1.6)(D, 2 * Fh)), 'w_sp': _w(0.01 * (lambda *s: torch.randn(*s, dtype=torch.bfloat16) * 1.6)(S, S)), 'b_sp': _w(1.0 + 0.01 * (lambda *s: torch.randn(*s, dtype=torch.bfloat16) * 0.05)(S)), 'w_out': _w((lambda *s: torch.randn(*s, dtype=torch.bfloat16) * 0.05)(Fh, D))}
    _B_in = _B_setup()
    return {'A_x': _A_in['x'], 'A_wqkv': _A_in['wqkv'], 'A_wo': _A_in['wo'], 'B_x': _B_in['x'], 'B_w_in': _B_in['w_in'], 'B_w_sp': _B_in['w_sp'], 'B_b_sp': _B_in['b_sp'], 'B_w_out': _B_in['w_out']}

def reference(A_x, A_wqkv, A_wo, B_x, B_w_in, B_w_sp, B_b_sp, B_w_out):

    def _A_ref(x, wqkv, wo):
        B, S, D = x.shape
        H = 32
        Dh = D // H
        qkv = (lambda x, *d: x.permute(*d))((x @ wqkv).reshape(B, S, 3, H, Dh), 2, 0, 3, 1, 4)
        q, k, v = (qkv[0], qkv[1], qkv[2])
        scale = Dh ** (-0.5)
        scores = torch.einsum('bhqd,bhkd->bhqk', q, k) * scale
        p = _softmax(scores, axis=-1)
        o = torch.einsum('bhqk,bhkd->bhqd', p, v)
        return (lambda x, *d: x.permute(*d))(o, 0, 2, 1, 3).reshape(B, S, D) @ wo

    def _B_ref(x, w_in, w_sp, b_sp, w_out):
        B, S, D = x.shape
        F = w_in.shape[-1]
        Fh = F // 2
        z = _gelu(torch.einsum('bsd,df->bsf', x, w_in))
        z1 = z[..., :Fh].clone()
        z2 = _layernorm(z[..., Fh:], axis=-1)
        g = torch.einsum('ts,bsf->btf', w_sp, z2) + b_sp[None, :, None]
        return torch.einsum('bsf,fd->bsd', z1 * g, w_out)
    x = A_x
    xn = _layernorm(x, axis=-1)
    s = _A_ref(xn, A_wqkv, A_wo)
    g = _silu(_B_ref(xn, B_w_in, B_w_sp, B_b_sp, B_w_out))
    return x + s * g
```

```asm
; @launch kernel=k1_kernel grid=(256,1,1) block=(256,1,1) lds=163840
; @launch kernel=recurrent_scan__softmax_full_mha__mixer_gmlp__prompt_kernel grid=(256,1,1) block=(512,1,1) lds=163840
.amdgcn_target "amdgcn-amd-amdhsa--gfx950"
.text
.globl k1_kernel
.p2align 8
.type k1_kernel,@function
k1_kernel:
    s_cmp_ge_u32 s2, 256
    s_cbranch_scc1 k1_end
    s_load_dwordx2 s[4:5], s[0:1], 0
    s_load_dwordx2 s[8:9], s[0:1], 8
    s_load_dwordx2 s[12:13], s[0:1], 32
    s_load_dwordx2 s[20:21], s[0:1], 72
    s_load_dwordx2 s[16:17], s[0:1], 80
    s_load_dwordx2 s[52:53], s[0:1], 40
    s_load_dwordx2 s[98:99], s[0:1], 40
    s_load_dwordx2 s[56:57], s[0:1], 16
    s_load_dwordx2 s[58:59], s[0:1], 56
    s_getpc_b64 s[64:65]
    s_lshr_b32 s3, s2, 3
    v_lshrrev_b32 v2, 4, v0
    v_lshl_add_u32 v2, s3, 4, v2
    v_min_u32 v2, (code_end-k1_kernel)/128-1, v2
    v_lshlrev_b32 v2, 7, v2
    v_mov_b32 v3, s65
    v_add_co_u32 v2, vcc, s64, v2
    s_nop 1
    v_addc_co_u32 v3, vcc, 0, v3, vcc
    global_load_dword v94, v[2:3], off
    v_lshrrev_b32 v1, 6, v0
    v_and_b32 v0, 63, v0
    v_readfirstlane_b32 s24, v1
    s_mov_b32 s6, 2621440
    s_mov_b32 s7, 0x00020000
    s_mov_b32 s10, 2457600
    s_mov_b32 s11, 0x00020000
    s_mov_b32 s14, 2211840
    s_mov_b32 s15, 0x00020000
    s_mov_b32 s22, 256
    s_mov_b32 s23, 0x00020000
    s_mov_b32 s18, 33554432
    s_mov_b32 s19, 0x00020000
    s_mov_b32 s54, 8388608
    s_mov_b32 s55, 0x00020000
    s_bfe_u32 s25, s2, 0x20001
    s_lshl_b32 s25, s25, 2
    s_bfe_u32 s28, s2, 0x20003
    s_add_u32 s25, s25, s28
    s_mul_i32 s27, s24, 10240
    s_lshl_b32 s28, s25, 2
    s_add_u32 s32, s28, s24
    s_mul_i32 s34, s32, 40960
    v_lshrrev_b32 v16, 4, v0
    v_and_b32 v17, 15, v0
    v_xor_b32 v17, v17, v16
    v_lshlrev_b32 v17, 4, v17
    v_mul_u32_u24 v16, 1280, v16
    v_add_u32 v28, v16, v17
    v_xor_b32 v29, 64, v28
    v_xor_b32 v30, 128, v28
    v_xor_b32 v31, 192, v28
    s_lshl_b32 s51, s2, 2
    s_add_u32 s51, s51, s24
    v_lshlrev_b32 v93, 7, v0
    s_waitcnt lgkmcnt(0)
    s_lshl_b32 s47, s25, 6
    s_add_u32 s47, s47, s24
    s_lshl_b32 s47, s47, 9
    s_add_u32 s47, s47, 31457280
    s_and_b32 s28, s2, 0xe1
    s_or_b32 s33, s28, s24
    s_cbranch_scc1 k1_nl
    buffer_load_dword v92, off, s[16:19], s47 offset:8 sc1
k1_nl:
    s_mul_i32 s28, s51, 2560
    s_bfm_b64 exec, 20, 0
    buffer_load_dword v94, v93, s[4:7], s28 offen
    s_mov_b64 exec, -1
    s_mul_i32 s28, s51, 2176
    s_bfm_b64 exec, 17, 0
    buffer_load_dword v94, v93, s[12:15], s28 offen
    s_mov_b64 exec, -1
    s_add_u32 m0, s27, 8192
    s_add_u32 s30, s34, 1024
    buffer_load_dwordx4 v28, s[4:7], s30 offen lds
    s_add_u32 m0, s27, 9216
    s_add_u32 s30, s34, 6144
    buffer_load_dwordx4 v29, s[4:7], s30 offen lds
    s_add_u32 m0, s27, 49152
    s_add_u32 s30, s34, 11264
    buffer_load_dwordx4 v30, s[4:7], s30 offen lds
    s_add_u32 m0, s27, 50176
    s_add_u32 s30, s34, 16384
    buffer_load_dwordx4 v31, s[4:7], s30 offen lds
    s_add_u32 m0, s27, 90112
    s_add_u32 s30, s34, 21504
    buffer_load_dwordx4 v28, s[4:7], s30 offen lds
    s_add_u32 m0, s27, 91136
    s_add_u32 s30, s34, 26624
    buffer_load_dwordx4 v29, s[4:7], s30 offen lds
    s_add_u32 m0, s27, 131072
    s_add_u32 s30, s34, 31744
    buffer_load_dwordx4 v30, s[4:7], s30 offen lds
    s_add_u32 m0, s27, 132096
    s_add_u32 s30, s34, 36864
    buffer_load_dwordx4 v31, s[4:7], s30 offen lds
    v_lshlrev_b32 v1, 4, v0
    v_lshrrev_b32 v16, 5, v0
    v_bfe_u32 v17, v0, 2, 2
    v_lshl_add_u32 v16, v16, 3, v17
    v_bfe_u32 v17, v0, 4, 1
    v_and_b32 v18, 3, v0
    v_lshl_add_u32 v19, v17, 2, v18
    v_lshlrev_b32 v2, 3, v19
    v_lshl_add_u32 v2, v16, 7, v2
    v_and_b32 v20, 8, v0
    v_lshl_add_u32 v2, v20, 3, v2
    v_xor_b32 v3, 64, v2
    v_mul_u32_u24 v16, 320, v16
    v_add_u32 v16, 81920, v16
    v_mul_u32_u24 v20, 160, v17
    v_lshl_add_u32 v20, v18, 3, v20
    v_add_u32 v4, v16, v20
    v_mul_u32_u24 v19, 40, v19
    v_add3_u32 v5, v16, v19, 32
    v_lshrrev_b32 v16, 3, v0
    v_mul_u32_u24 v16, 3456, v16
    v_and_b32 v18, 7, v0
    v_lshlrev_b32 v17, 2, v17
    v_xor_b32 v18, v18, v17
    v_lshl_add_u32 v11, v18, 4, v16
    s_lshr_b32 s28, s2, 5
    s_and_b32 s29, s2, 1
    s_mul_i32 s38, s24, 276480
    s_mul_i32 s35, s32, 98304
    s_add_u32 s35, s35, 23068672
    v_bfe_u32 v17, v0, 4, 1
    v_mul_u32_u24 v17, 48896, v17
    v_and_b32 v18, 32, v0
    v_mad_i32_i24 v17, v18, -8, v17
    v_add_u32 v95, v17, v1
    s_lshl_b32 s42, s32, 11
    s_add_u32 s42, s42, 15335424
    s_cmp_ge_u32 s28, 6
    s_cbranch_scc1 k1_B
    v_add_u32 v16, 0, v0
    v_mul_u32_u24 v17, 3277, v16
    v_lshrrev_b32 v17, 16, v17
    v_mul_u32_u24 v17, 3520, v17
    v_lshl_add_u32 v6, v16, 4, v17
    v_add_u32 v16, 64, v0
    v_mul_u32_u24 v17, 3277, v16
    v_lshrrev_b32 v17, 16, v17
    v_mul_u32_u24 v17, 3520, v17
    v_lshl_add_u32 v7, v16, 4, v17
    v_add_u32 v16, 128, v0
    v_mul_u32_u24 v17, 3277, v16
    v_lshrrev_b32 v17, 16, v17
    v_mul_u32_u24 v17, 3520, v17
    v_lshl_add_u32 v8, v16, 4, v17
    v_add_u32 v16, 192, v0
    v_mul_u32_u24 v17, 3277, v16
    v_lshrrev_b32 v17, 16, v17
    v_mul_u32_u24 v17, 3520, v17
    v_lshl_add_u32 v9, v16, 4, v17
    v_add_u32 v16, 256, v0
    v_mul_u32_u24 v17, 3277, v16
    v_lshrrev_b32 v17, 16, v17
    v_mul_u32_u24 v17, 3520, v17
    v_lshl_add_u32 v10, v16, 4, v17
    s_mul_i32 s26, s29, 6
    s_add_u32 s26, s26, s28
    s_mov_b32 s37, s26
    s_add_u32 s28, s26, 15
    s_lshl_b32 s29, s28, 18
    s_add_u32 s42, s42, s29
    s_add_u32 s43, s42, 131072
    s_lshl_b32 s28, s28, 7
    s_add_u32 s38, s38, s28
    s_add_u32 s39, s38, 1105920
    s_mul_i32 s40, s24, 122880
    s_mul_i32 s28, s26, 320
    s_add_u32 s40, s40, s28
    v_and_b32 v24, 31, v0
    v_lshrrev_b32 v25, 5, v0
    v_and_b32 v26, 15, v0
    v_xor_b32 v26, v26, v25
    v_lshlrev_b32 v26, 4, v26
    v_lshl_add_u32 v26, v24, 8, v26
    v_add_u32 v16, s27, v26
    v_lshrrev_b32 v25, 3, v24
    v_mul_u32_u24 v25, 38912, v25
    v_add_u32 v25, 8192, v25
    v_mov_b32 v27, 0x3f803f80
    v_xor_b32 v17, 32, v16
    v_xor_b32 v18, 64, v16
    v_xor_b32 v19, 96, v16
    v_xor_b32 v20, 128, v16
    v_xor_b32 v21, 160, v16
    v_xor_b32 v22, 192, v16
    v_xor_b32 v23, 224, v16
    v_add_u32 v32, v25, v16
    v_add_u32 v40, 81920, v16
    v_add_u32 v33, v25, v17
    v_add_u32 v41, 81920, v17
    v_add_u32 v34, v25, v18
    v_add_u32 v42, 81920, v18
    v_add_u32 v35, v25, v19
    v_add_u32 v43, 81920, v19
    v_add_u32 v36, v25, v20
    v_add_u32 v44, 81920, v20
    v_add_u32 v37, v25, v21
    v_add_u32 v45, 81920, v21
    v_add_u32 v38, v25, v22
    v_add_u32 v46, 81920, v22
    v_add_u32 v39, v25, v23
    v_add_u32 v47, 81920, v23
    v_lshrrev_b32 v48, 2, v0
    v_lshrrev_b32 v49, 5, v0
    v_xor_b32 v48, v48, v49
    v_and_b32 v48, 1, v48
    v_lshlrev_b32 v48, 4, v48
    v_bfe_u32 v49, v0, 1, 1
    v_bfe_u32 v50, v0, 3, 2
    v_lshl_add_u32 v49, v50, 1, v49
    v_add_u32 v48, v48, v49
    v_and_b32 v49, 1, v0
    v_lshlrev_b32 v49, 4, v49
    v_mov_b32 v50, 0x3f80
    v_lshlrev_b32 v49, v49, v50
    v_cmp_eq_u32 s[60:61], 0, v48
    v_cmp_eq_u32 s[62:63], 1, v48
    v_cmp_eq_u32 s[64:65], 2, v48
    v_cmp_eq_u32 s[66:67], 3, v48
    v_cmp_eq_u32 s[68:69], 4, v48
    v_cmp_eq_u32 s[70:71], 5, v48
    v_cmp_eq_u32 s[72:73], 6, v48
    v_cmp_eq_u32 s[74:75], 7, v48
    v_mov_b32 v88, 0
    v_mov_b32 v89, 0
    v_mov_b32 v90, 0
    v_mov_b32 v91, 0
    v_cndmask_b32 v80, 0, v49, s[60:61]
    v_cndmask_b32 v81, 0, v49, s[62:63]
    v_cndmask_b32 v82, 0, v49, s[64:65]
    v_cndmask_b32 v83, 0, v49, s[66:67]
    v_cndmask_b32 v84, 0, v49, s[68:69]
    v_cndmask_b32 v85, 0, v49, s[70:71]
    v_cndmask_b32 v86, 0, v49, s[72:73]
    v_cndmask_b32 v87, 0, v49, s[74:75]
    s_add_u32 m0, s27, 0
    s_add_u32 s30, s34, 0
    buffer_load_dwordx4 v28, s[4:7], s30 offen lds
    s_add_u32 m0, s27, 1024
    s_add_u32 s30, s34, 5120
    buffer_load_dwordx4 v29, s[4:7], s30 offen lds
    s_add_u32 m0, s27, 2048
    s_add_u32 s30, s34, 10240
    buffer_load_dwordx4 v30, s[4:7], s30 offen lds
    s_add_u32 m0, s27, 3072
    s_add_u32 s30, s34, 15360
    buffer_load_dwordx4 v31, s[4:7], s30 offen lds
    s_add_u32 m0, s27, 4096
    s_add_u32 s30, s34, 20480
    buffer_load_dwordx4 v28, s[4:7], s30 offen lds
    s_add_u32 m0, s27, 5120
    s_add_u32 s30, s34, 25600
    buffer_load_dwordx4 v29, s[4:7], s30 offen lds
    s_add_u32 m0, s27, 6144
    s_add_u32 s30, s34, 30720
    buffer_load_dwordx4 v30, s[4:7], s30 offen lds
    s_add_u32 m0, s27, 7168
    s_add_u32 s30, s34, 35840
    buffer_load_dwordx4 v31, s[4:7], s30 offen lds
    s_waitcnt vmcnt(8)
    ds_read_b128 v[224:227], v32 offset:0
    ds_read_b128 v[228:231], v33 offset:0
    ds_read_b128 v[232:235], v34 offset:0
    ds_read_b128 v[236:239], v35 offset:0
    ds_read_b128 v[240:243], v36 offset:0
    ds_read_b128 v[244:247], v37 offset:0
    ds_read_b128 v[248:251], v38 offset:0
    ds_read_b128 v[252:255], v39 offset:0
    s_cmp_lg_u32 s33, 0
    s_cbranch_scc1 k1_nl2
    v_add_u32 v92, 1, v92
    v_max_u32 v92, 1, v92
    s_lshl_b32 s29, s25, 4
    s_mov_b64 exec, 1
    buffer_store_dword v92, off, s[20:23], s29 sc1
    s_mov_b64 exec, -1
k1_nl2:
    s_waitcnt lgkmcnt(0)
    s_add_u32 m0, s27, 40960
    s_add_u32 s30, s34, 256
    buffer_load_dwordx4 v28, s[4:7], s30 offen lds
    v_dot2_f32_bf16 v88, v224, v27, v88
    v_dot2_f32_bf16 v89, v224, v224, v89
    v_dot2_f32_bf16 v90, v225, v27, v90
    v_dot2_f32_bf16 v91, v225, v225, v91
    v_dot2_f32_bf16 v88, v226, v27, v88
    v_dot2_f32_bf16 v89, v226, v226, v89
    v_dot2_f32_bf16 v90, v227, v27, v90
    v_dot2_f32_bf16 v91, v227, v227, v91
    s_add_u32 m0, s27, 41984
    s_add_u32 s30, s34, 5376
    buffer_load_dwordx4 v29, s[4:7], s30 offen lds
    v_dot2_f32_bf16 v88, v228, v27, v88
    v_dot2_f32_bf16 v89, v228, v228, v89
    v_dot2_f32_bf16 v90, v229, v27, v90
    v_dot2_f32_bf16 v91, v229, v229, v91
    v_dot2_f32_bf16 v88, v230, v27, v88
    v_dot2_f32_bf16 v89, v230, v230, v89
    v_dot2_f32_bf16 v90, v231, v27, v90
    v_dot2_f32_bf16 v91, v231, v231, v91
    s_add_u32 m0, s27, 43008
    s_add_u32 s30, s34, 10496
    buffer_load_dwordx4 v30, s[4:7], s30 offen lds
    v_dot2_f32_bf16 v88, v232, v27, v88
    v_dot2_f32_bf16 v89, v232, v232, v89
    v_dot2_f32_bf16 v90, v233, v27, v90
    v_dot2_f32_bf16 v91, v233, v233, v91
    v_dot2_f32_bf16 v88, v234, v27, v88
    v_dot2_f32_bf16 v89, v234, v234, v89
    v_dot2_f32_bf16 v90, v235, v27, v90
    v_dot2_f32_bf16 v91, v235, v235, v91
    s_add_u32 m0, s27, 44032
    s_add_u32 s30, s34, 15616
    buffer_load_dwordx4 v31, s[4:7], s30 offen lds
    v_dot2_f32_bf16 v88, v236, v27, v88
    v_dot2_f32_bf16 v89, v236, v236, v89
    v_dot2_f32_bf16 v90, v237, v27, v90
    v_dot2_f32_bf16 v91, v237, v237, v91
    v_dot2_f32_bf16 v88, v238, v27, v88
    v_dot2_f32_bf16 v89, v238, v238, v89
    v_dot2_f32_bf16 v90, v239, v27, v90
    v_dot2_f32_bf16 v91, v239, v239, v91
    s_add_u32 m0, s27, 45056
    s_add_u32 s30, s34, 20736
    buffer_load_dwordx4 v28, s[4:7], s30 offen lds
    v_dot2_f32_bf16 v88, v240, v27, v88
    v_dot2_f32_bf16 v89, v240, v240, v89
    v_dot2_f32_bf16 v90, v241, v27, v90
    v_dot2_f32_bf16 v91, v241, v241, v91
    v_dot2_f32_bf16 v88, v242, v27, v88
    v_dot2_f32_bf16 v89, v242, v242, v89
    v_dot2_f32_bf16 v90, v243, v27, v90
    v_dot2_f32_bf16 v91, v243, v243, v91
    s_add_u32 m0, s27, 46080
    s_add_u32 s30, s34, 25856
    buffer_load_dwordx4 v29, s[4:7], s30 offen lds
    v_dot2_f32_bf16 v88, v244, v27, v88
    v_dot2_f32_bf16 v89, v244, v244, v89
    v_dot2_f32_bf16 v90, v245, v27, v90
    v_dot2_f32_bf16 v91, v245, v245, v91
    v_dot2_f32_bf16 v88, v246, v27, v88
    v_dot2_f32_bf16 v89, v246, v246, v89
    v_dot2_f32_bf16 v90, v247, v27, v90
    v_dot2_f32_bf16 v91, v247, v247, v91
    s_add_u32 m0, s27, 47104
    s_add_u32 s30, s34, 30976
    buffer_load_dwordx4 v30, s[4:7], s30 offen lds
    v_dot2_f32_bf16 v88, v248, v27, v88
    v_dot2_f32_bf16 v89, v248, v248, v89
    v_dot2_f32_bf16 v90, v249, v27, v90
    v_dot2_f32_bf16 v91, v249, v249, v91
    v_dot2_f32_bf16 v88, v250, v27, v88
    v_dot2_f32_bf16 v89, v250, v250, v89
    v_dot2_f32_bf16 v90, v251, v27, v90
    v_dot2_f32_bf16 v91, v251, v251, v91
    s_add_u32 m0, s27, 48128
    s_add_u32 s30, s34, 36096
    buffer_load_dwordx4 v31, s[4:7], s30 offen lds
    v_dot2_f32_bf16 v88, v252, v27, v88
    v_dot2_f32_bf16 v89, v252, v252, v89
    v_dot2_f32_bf16 v90, v253, v27, v90
    v_dot2_f32_bf16 v91, v253, v253, v91
    v_dot2_f32_bf16 v88, v254, v27, v88
    v_dot2_f32_bf16 v89, v254, v254, v89
    v_dot2_f32_bf16 v90, v255, v27, v90
    v_dot2_f32_bf16 v91, v255, v255, v91
    s_waitcnt vmcnt(8)
    ds_read_b128 v[96:99], v16 offset:0
    ds_read_b128 v[100:103], v17 offset:0
    ds_read_b128 v[104:107], v18 offset:0
    ds_read_b128 v[108:111], v19 offset:0
    ds_read_b128 v[112:115], v20 offset:0
    ds_read_b128 v[116:119], v21 offset:0
    ds_read_b128 v[120:123], v22 offset:0
    ds_read_b128 v[124:127], v23 offset:0
    s_waitcnt lgkmcnt(0)
    s_add_u32 m0, s27, 81920
    s_add_u32 s30, s34, 512
    buffer_load_dwordx4 v28, s[4:7], s30 offen lds
    v_dot2_f32_bf16 v88, v96, v27, v88
    v_dot2_f32_bf16 v89, v96, v96, v89
    v_dot2_f32_bf16 v90, v97, v27, v90
    v_dot2_f32_bf16 v91, v97, v97, v91
    v_dot2_f32_bf16 v88, v98, v27, v88
    v_dot2_f32_bf16 v89, v98, v98, v89
    v_dot2_f32_bf16 v90, v99, v27, v90
    v_dot2_f32_bf16 v91, v99, v99, v91
    s_add_u32 m0, s27, 82944
    s_add_u32 s30, s34, 5632
    buffer_load_dwordx4 v29, s[4:7], s30 offen lds
    v_dot2_f32_bf16 v88, v100, v27, v88
    v_dot2_f32_bf16 v89, v100, v100, v89
    v_dot2_f32_bf16 v90, v101, v27, v90
    v_dot2_f32_bf16 v91, v101, v101, v91
    v_dot2_f32_bf16 v88, v102, v27, v88
    v_dot2_f32_bf16 v89, v102, v102, v89
    v_dot2_f32_bf16 v90, v103, v27, v90
    v_dot2_f32_bf16 v91, v103, v103, v91
    s_add_u32 m0, s27, 83968
    s_add_u32 s30, s34, 10752
    buffer_load_dwordx4 v30, s[4:7], s30 offen lds
    v_dot2_f32_bf16 v88, v104, v27, v88
    v_dot2_f32_bf16 v89, v104, v104, v89
    v_dot2_f32_bf16 v90, v105, v27, v90
    v_dot2_f32_bf16 v91, v105, v105, v91
    v_dot2_f32_bf16 v88, v106, v27, v88
    v_dot2_f32_bf16 v89, v106, v106, v89
    v_dot2_f32_bf16 v90, v107, v27, v90
    v_dot2_f32_bf16 v91, v107, v107, v91
    s_add_u32 m0, s27, 84992
    s_add_u32 s30, s34, 15872
    buffer_load_dwordx4 v31, s[4:7], s30 offen lds
    v_dot2_f32_bf16 v88, v108, v27, v88
    v_dot2_f32_bf16 v89, v108, v108, v89
    v_dot2_f32_bf16 v90, v109, v27, v90
    v_dot2_f32_bf16 v91, v109, v109, v91
    v_dot2_f32_bf16 v88, v110, v27, v88
    v_dot2_f32_bf16 v89, v110, v110, v89
    v_dot2_f32_bf16 v90, v111, v27, v90
    v_dot2_f32_bf16 v91, v111, v111, v91
    s_add_u32 m0, s27, 86016
    s_add_u32 s30, s34, 20992
    buffer_load_dwordx4 v28, s[4:7], s30 offen lds
    v_dot2_f32_bf16 v88, v112, v27, v88
    v_dot2_f32_bf16 v89, v112, v112, v89
    v_dot2_f32_bf16 v90, v113, v27, v90
    v_dot2_f32_bf16 v91, v113, v113, v91
    v_dot2_f32_bf16 v88, v114, v27, v88
    v_dot2_f32_bf16 v89, v114, v114, v89
    v_dot2_f32_bf16 v90, v115, v27, v90
    v_dot2_f32_bf16 v91, v115, v115, v91
    s_add_u32 m0, s27, 87040
    s_add_u32 s30, s34, 26112
    buffer_load_dwordx4 v29, s[4:7], s30 offen lds
    v_dot2_f32_bf16 v88, v116, v27, v88
    v_dot2_f32_bf16 v89, v116, v116, v89
    v_dot2_f32_bf16 v90, v117, v27, v90
    v_dot2_f32_bf16 v91, v117, v117, v91
    v_dot2_f32_bf16 v88, v118, v27, v88
    v_dot2_f32_bf16 v89, v118, v118, v89
    v_dot2_f32_bf16 v90, v119, v27, v90
    v_dot2_f32_bf16 v91, v119, v119, v91
    s_add_u32 m0, s27, 88064
    s_add_u32 s30, s34, 31232
    buffer_load_dwordx4 v30, s[4:7], s30 offen lds
    v_dot2_f32_bf16 v88, v120, v27, v88
    v_dot2_f32_bf16 v89, v120, v120, v89
    v_dot2_f32_bf16 v90, v121, v27, v90
    v_dot2_f32_bf16 v91, v121, v121, v91
    v_dot2_f32_bf16 v88, v122, v27, v88
    v_dot2_f32_bf16 v89, v122, v122, v89
    v_dot2_f32_bf16 v90, v123, v27, v90
    v_dot2_f32_bf16 v91, v123, v123, v91
    s_add_u32 m0, s27, 89088
    s_add_u32 s30, s34, 36352
    buffer_load_dwordx4 v31, s[4:7], s30 offen lds
    v_dot2_f32_bf16 v88, v124, v27, v88
    v_dot2_f32_bf16 v89, v124, v124, v89
    v_dot2_f32_bf16 v90, v125, v27, v90
    v_dot2_f32_bf16 v91, v125, v125, v91
    v_dot2_f32_bf16 v88, v126, v27, v88
    v_dot2_f32_bf16 v89, v126, v126, v89
    v_dot2_f32_bf16 v90, v127, v27, v90
    v_dot2_f32_bf16 v91, v127, v127, v91
    s_waitcnt vmcnt(8)
    ds_read_b128 v[128:131], v16 offset:40960
    ds_read_b128 v[132:135], v17 offset:40960
    ds_read_b128 v[136:139], v18 offset:40960
    ds_read_b128 v[140:143], v19 offset:40960
    ds_read_b128 v[144:147], v20 offset:40960
    ds_read_b128 v[148:151], v21 offset:40960
    ds_read_b128 v[152:155], v22 offset:40960
    ds_read_b128 v[156:159], v23 offset:40960
    s_waitcnt lgkmcnt(0)
    s_add_u32 m0, s27, 122880
    s_add_u32 s30, s34, 768
    buffer_load_dwordx4 v28, s[4:7], s30 offen lds
    v_dot2_f32_bf16 v88, v128, v27, v88
    v_dot2_f32_bf16 v89, v128, v128, v89
    v_dot2_f32_bf16 v90, v129, v27, v90
    v_dot2_f32_bf16 v91, v129, v129, v91
    v_dot2_f32_bf16 v88, v130, v27, v88
    v_dot2_f32_bf16 v89, v130, v130, v89
    v_dot2_f32_bf16 v90, v131, v27, v90
    v_dot2_f32_bf16 v91, v131, v131, v91
    s_add_u32 m0, s27, 123904
    s_add_u32 s30, s34, 5888
    buffer_load_dwordx4 v29, s[4:7], s30 offen lds
    v_dot2_f32_bf16 v88, v132, v27, v88
    v_dot2_f32_bf16 v89, v132, v132, v89
    v_dot2_f32_bf16 v90, v133, v27, v90
    v_dot2_f32_bf16 v91, v133, v133, v91
    v_dot2_f32_bf16 v88, v134, v27, v88
    v_dot2_f32_bf16 v89, v134, v134, v89
    v_dot2_f32_bf16 v90, v135, v27, v90
    v_dot2_f32_bf16 v91, v135, v135, v91
    s_add_u32 m0, s27, 124928
    s_add_u32 s30, s34, 11008
    buffer_load_dwordx4 v30, s[4:7], s30 offen lds
    v_dot2_f32_bf16 v88, v136, v27, v88
    v_dot2_f32_bf16 v89, v136, v136, v89
    v_dot2_f32_bf16 v90, v137, v27, v90
    v_dot2_f32_bf16 v91, v137, v137, v91
    v_dot2_f32_bf16 v88, v138, v27, v88
    v_dot2_f32_bf16 v89, v138, v138, v89
    v_dot2_f32_bf16 v90, v139, v27, v90
    v_dot2_f32_bf16 v91, v139, v139, v91
    s_add_u32 m0, s27, 125952
    s_add_u32 s30, s34, 16128
    buffer_load_dwordx4 v31, s[4:7], s30 offen lds
    v_dot2_f32_bf16 v88, v140, v27, v88
    v_dot2_f32_bf16 v89, v140, v140, v89
    v_dot2_f32_bf16 v90, v141, v27, v90
    v_dot2_f32_bf16 v91, v141, v141, v91
    v_dot2_f32_bf16 v88, v142, v27, v88
    v_dot2_f32_bf16 v89, v142, v142, v89
    v_dot2_f32_bf16 v90, v143, v27, v90
    v_dot2_f32_bf16 v91, v143, v143, v91
    s_add_u32 m0, s27, 126976
    s_add_u32 s30, s34, 21248
    buffer_load_dwordx4 v28, s[4:7], s30 offen lds
    v_dot2_f32_bf16 v88, v144, v27, v88
    v_dot2_f32_bf16 v89, v144, v144, v89
    v_dot2_f32_bf16 v90, v145, v27, v90
    v_dot2_f32_bf16 v91, v145, v145, v91
    v_dot2_f32_bf16 v88, v146, v27, v88
    v_dot2_f32_bf16 v89, v146, v146, v89
    v_dot2_f32_bf16 v90, v147, v27, v90
    v_dot2_f32_bf16 v91, v147, v147, v91
    s_add_u32 m0, s27, 128000
    s_add_u32 s30, s34, 26368
    buffer_load_dwordx4 v29, s[4:7], s30 offen lds
    v_dot2_f32_bf16 v88, v148, v27, v88
    v_dot2_f32_bf16 v89, v148, v148, v89
    v_dot2_f32_bf16 v90, v149, v27, v90
    v_dot2_f32_bf16 v91, v149, v149, v91
    v_dot2_f32_bf16 v88, v150, v27, v88
    v_dot2_f32_bf16 v89, v150, v150, v89
    v_dot2_f32_bf16 v90, v151, v27, v90
    v_dot2_f32_bf16 v91, v151, v151, v91
    s_add_u32 m0, s27, 129024
    s_add_u32 s30, s34, 31488
    buffer_load_dwordx4 v30, s[4:7], s30 offen lds
    v_dot2_f32_bf16 v88, v152, v27, v88
    v_dot2_f32_bf16 v89, v152, v152, v89
    v_dot2_f32_bf16 v90, v153, v27, v90
    v_dot2_f32_bf16 v91, v153, v153, v91
    v_dot2_f32_bf16 v88, v154, v27, v88
    v_dot2_f32_bf16 v89, v154, v154, v89
    v_dot2_f32_bf16 v90, v155, v27, v90
    v_dot2_f32_bf16 v91, v155, v155, v91
    s_add_u32 m0, s27, 130048
    s_add_u32 s30, s34, 36608
    buffer_load_dwordx4 v31, s[4:7], s30 offen lds
    v_dot2_f32_bf16 v88, v156, v27, v88
    v_dot2_f32_bf16 v89, v156, v156, v89
    v_dot2_f32_bf16 v90, v157, v27, v90
    v_dot2_f32_bf16 v91, v157, v157, v91
    v_dot2_f32_bf16 v88, v158, v27, v88
    v_dot2_f32_bf16 v89, v158, v158, v89
    v_dot2_f32_bf16 v90, v159, v27, v90
    v_dot2_f32_bf16 v91, v159, v159, v91
    s_waitcnt vmcnt(8)
    ds_read_b128 v[160:163], v40 offset:0
    ds_read_b128 v[164:167], v41 offset:0
    ds_read_b128 v[168:171], v42 offset:0
    ds_read_b128 v[172:175], v43 offset:0
    ds_read_b128 v[176:179], v44 offset:0
    ds_read_b128 v[180:183], v45 offset:0
    ds_read_b128 v[184:187], v46 offset:0
    ds_read_b128 v[188:191], v47 offset:0
    s_waitcnt lgkmcnt(0)
    s_add_u32 m0, s27, 0
    s_add_u32 s30, s38, 0
    buffer_load_dwordx4 v11, s[12:15], s30 offen lds
    v_dot2_f32_bf16 v88, v160, v27, v88
    v_dot2_f32_bf16 v89, v160, v160, v89
    v_dot2_f32_bf16 v90, v161, v27, v90
    v_dot2_f32_bf16 v91, v161, v161, v91
    v_dot2_f32_bf16 v88, v162, v27, v88
    v_dot2_f32_bf16 v89, v162, v162, v89
    v_dot2_f32_bf16 v90, v163, v27, v90
    v_dot2_f32_bf16 v91, v163, v163, v91
    s_add_u32 m0, m0, 1024
    s_add_u32 s30, s38, 27648
    buffer_load_dwordx4 v11, s[12:15], s30 offen lds
    v_dot2_f32_bf16 v88, v164, v27, v88
    v_dot2_f32_bf16 v89, v164, v164, v89
    v_dot2_f32_bf16 v90, v165, v27, v90
    v_dot2_f32_bf16 v91, v165, v165, v91
    v_dot2_f32_bf16 v88, v166, v27, v88
    v_dot2_f32_bf16 v89, v166, v166, v89
    v_dot2_f32_bf16 v90, v167, v27, v90
    v_dot2_f32_bf16 v91, v167, v167, v91
    s_add_u32 m0, m0, 1024
    s_add_u32 s30, s38, 55296
    buffer_load_dwordx4 v11, s[12:15], s30 offen lds
    v_dot2_f32_bf16 v88, v168, v27, v88
    v_dot2_f32_bf16 v89, v168, v168, v89
    v_dot2_f32_bf16 v90, v169, v27, v90
    v_dot2_f32_bf16 v91, v169, v169, v91
    v_dot2_f32_bf16 v88, v170, v27, v88
    v_dot2_f32_bf16 v89, v170, v170, v89
    v_dot2_f32_bf16 v90, v171, v27, v90
    v_dot2_f32_bf16 v91, v171, v171, v91
    s_add_u32 m0, m0, 1024
    s_add_u32 s30, s38, 82944
    buffer_load_dwordx4 v11, s[12:15], s30 offen lds
    v_dot2_f32_bf16 v88, v172, v27, v88
    v_dot2_f32_bf16 v89, v172, v172, v89
    v_dot2_f32_bf16 v90, v173, v27, v90
    v_dot2_f32_bf16 v91, v173, v173, v91
    v_dot2_f32_bf16 v88, v174, v27, v88
    v_dot2_f32_bf16 v89, v174, v174, v89
    v_dot2_f32_bf16 v90, v175, v27, v90
    v_dot2_f32_bf16 v91, v175, v175, v91
    s_add_u32 m0, m0, 1024
    s_add_u32 s30, s38, 110592
    buffer_load_dwordx4 v11, s[12:15], s30 offen lds
    v_dot2_f32_bf16 v88, v176, v27, v88
    v_dot2_f32_bf16 v89, v176, v176, v89
    v_dot2_f32_bf16 v90, v177, v27, v90
    v_dot2_f32_bf16 v91, v177, v177, v91
    v_dot2_f32_bf16 v88, v178, v27, v88
    v_dot2_f32_bf16 v89, v178, v178, v89
    v_dot2_f32_bf16 v90, v179, v27, v90
    v_dot2_f32_bf16 v91, v179, v179, v91
    s_add_u32 m0, m0, 1024
    s_add_u32 s30, s38, 138240
    buffer_load_dwordx4 v11, s[12:15], s30 offen lds
    v_dot2_f32_bf16 v88, v180, v27, v88
    v_dot2_f32_bf16 v89, v180, v180, v89
    v_dot2_f32_bf16 v90, v181, v27, v90
    v_dot2_f32_bf16 v91, v181, v181, v91
    v_dot2_f32_bf16 v88, v182, v27, v88
    v_dot2_f32_bf16 v89, v182, v182, v89
    v_dot2_f32_bf16 v90, v183, v27, v90
    v_dot2_f32_bf16 v91, v183, v183, v91
    s_add_u32 m0, m0, 1024
    s_add_u32 s30, s38, 165888
    buffer_load_dwordx4 v11, s[12:15], s30 offen lds
    v_dot2_f32_bf16 v88, v184, v27, v88
    v_dot2_f32_bf16 v89, v184, v184, v89
    v_dot2_f32_bf16 v90, v185, v27, v90
    v_dot2_f32_bf16 v91, v185, v185, v91
    v_dot2_f32_bf16 v88, v186, v27, v88
    v_dot2_f32_bf16 v89, v186, v186, v89
    v_dot2_f32_bf16 v90, v187, v27, v90
    v_dot2_f32_bf16 v91, v187, v187, v91
    s_add_u32 m0, m0, 1024
    s_add_u32 s30, s38, 193536
    buffer_load_dwordx4 v11, s[12:15], s30 offen lds
    v_dot2_f32_bf16 v88, v188, v27, v88
    v_dot2_f32_bf16 v89, v188, v188, v89
    v_dot2_f32_bf16 v90, v189, v27, v90
    v_dot2_f32_bf16 v91, v189, v189, v91
    v_dot2_f32_bf16 v88, v190, v27, v88
    v_dot2_f32_bf16 v89, v190, v190, v89
    v_dot2_f32_bf16 v90, v191, v27, v90
    v_dot2_f32_bf16 v91, v191, v191, v91
    s_waitcnt vmcnt(8)
    ds_read_b128 v[192:195], v40 offset:40960
    ds_read_b128 v[196:199], v41 offset:40960
    ds_read_b128 v[200:203], v42 offset:40960
    ds_read_b128 v[204:207], v43 offset:40960
    ds_read_b128 v[208:211], v44 offset:40960
    ds_read_b128 v[212:215], v45 offset:40960
    ds_read_b128 v[216:219], v46 offset:40960
    ds_read_b128 v[220:223], v47 offset:40960
    s_waitcnt lgkmcnt(0)
    s_add_u32 m0, m0, 1024
    s_add_u32 s30, s38, 221184
    buffer_load_dwordx4 v11, s[12:15], s30 offen lds
    v_dot2_f32_bf16 v88, v192, v27, v88
    v_dot2_f32_bf16 v89, v192, v192, v89
    v_dot2_f32_bf16 v90, v193, v27, v90
    v_dot2_f32_bf16 v91, v193, v193, v91
    v_dot2_f32_bf16 v88, v194, v27, v88
    v_dot2_f32_bf16 v89, v194, v194, v89
    v_dot2_f32_bf16 v90, v195, v27, v90
    v_dot2_f32_bf16 v91, v195, v195, v91
    v_dot2_f32_bf16 v88, v196, v27, v88
    v_dot2_f32_bf16 v89, v196, v196, v89
    v_dot2_f32_bf16 v90, v197, v27, v90
    v_dot2_f32_bf16 v91, v197, v197, v91
    v_dot2_f32_bf16 v88, v198, v27, v88
    v_dot2_f32_bf16 v89, v198, v198, v89
    v_dot2_f32_bf16 v90, v199, v27, v90
    v_dot2_f32_bf16 v91, v199, v199, v91
    v_dot2_f32_bf16 v88, v200, v27, v88
    v_dot2_f32_bf16 v89, v200, v200, v89
    v_dot2_f32_bf16 v90, v201, v27, v90
    v_dot2_f32_bf16 v91, v201, v201, v91
    s_add_u32 m0, m0, 1024
    s_add_u32 s30, s38, 248832
    buffer_load_dwordx4 v11, s[12:15], s30 offen lds
    v_dot2_f32_bf16 v88, v202, v27, v88
    v_dot2_f32_bf16 v89, v202, v202, v89
    v_dot2_f32_bf16 v90, v203, v27, v90
    v_dot2_f32_bf16 v91, v203, v203, v91
    v_dot2_f32_bf16 v88, v204, v27, v88
    v_dot2_f32_bf16 v89, v204, v204, v89
    v_dot2_f32_bf16 v90, v205, v27, v90
    v_dot2_f32_bf16 v91, v205, v205, v91
    v_dot2_f32_bf16 v88, v206, v27, v88
    v_dot2_f32_bf16 v89, v206, v206, v89
    v_dot2_f32_bf16 v90, v207, v27, v90
    v_dot2_f32_bf16 v91, v207, v207, v91
    v_dot2_f32_bf16 v88, v208, v27, v88
    v_dot2_f32_bf16 v89, v208, v208, v89
    v_dot2_f32_bf16 v90, v209, v27, v90
    v_dot2_f32_bf16 v91, v209, v209, v91
    v_dot2_f32_bf16 v88, v210, v27, v88
    v_dot2_f32_bf16 v89, v210, v210, v89
    v_dot2_f32_bf16 v90, v211, v27, v90
    v_dot2_f32_bf16 v91, v211, v211, v91
    s_add_u32 m0, s27, 40960
    s_add_u32 s30, s39, 0
    buffer_load_dwordx4 v11, s[12:15], s30 offen lds
    v_dot2_f32_bf16 v88, v212, v27, v88
    v_dot2_f32_bf16 v89, v212, v212, v89
    v_dot2_f32_bf16 v90, v213, v27, v90
    v_dot2_f32_bf16 v91, v213, v213, v91
    v_dot2_f32_bf16 v88, v214, v27, v88
    v_dot2_f32_bf16 v89, v214, v214, v89
    v_dot2_f32_bf16 v90, v215, v27, v90
    v_dot2_f32_bf16 v91, v215, v215, v91
    v_dot2_f32_bf16 v88, v216, v27, v88
    v_dot2_f32_bf16 v89, v216, v216, v89
    v_dot2_f32_bf16 v90, v217, v27, v90
    v_dot2_f32_bf16 v91, v217, v217, v91
    v_dot2_f32_bf16 v88, v218, v27, v88
    v_dot2_f32_bf16 v89, v218, v218, v89
    v_dot2_f32_bf16 v90, v219, v27, v90
    v_dot2_f32_bf16 v91, v219, v219, v91
    v_dot2_f32_bf16 v88, v220, v27, v88
    v_dot2_f32_bf16 v89, v220, v220, v89
    v_dot2_f32_bf16 v90, v221, v27, v90
    v_dot2_f32_bf16 v91, v221, v221, v91
    s_add_u32 m0, m0, 1024
    s_add_u32 s30, s39, 27648
    buffer_load_dwordx4 v11, s[12:15], s30 offen lds
    v_dot2_f32_bf16 v88, v222, v27, v88
    v_dot2_f32_bf16 v89, v222, v222, v89
    v_dot2_f32_bf16 v90, v223, v27, v90
    v_dot2_f32_bf16 v91, v223, v223, v91
    s_nop 2
    v_add_f32 v88, v88, v90
    v_add_f32 v89, v89, v91
    v_mov_b32 v90, v88
    v_mov_b32 v91, v89
    s_nop 1
    v_permlane32_swap_b32 v88, v90
    v_permlane32_swap_b32 v89, v91
    s_nop 0
    v_add_f32 v88, v88, v90
    v_add_f32 v89, v89, v91
    v_mul_f32 v88, 0x3acccccd, v88
    v_mul_f32 v89, 0x3acccccd, v89
    v_fma_f32 v89, -v88, v88, v89
    v_max_f32 v89, 0, v89
    v_cvt_pk_bf16_f32 v88, v88, v88
    v_lshlrev_b32 v88, 16, v88
    v_cvt_pk_bf16_f32 v89, v89, v89
    v_lshlrev_b32 v89, 16, v89
    v_add_f32 v89, 0x3727c5ac, v89
    v_cvt_pk_bf16_f32 v89, v89, v89
    v_lshlrev_b32 v89, 16, v89
    v_sqrt_f32 v89, v89
    s_nop 0
    v_cvt_pk_bf16_f32 v89, v89, v89
    v_lshlrev_b32 v89, 16, v89
    v_rcp_f32 v13, v89
    v_mov_b32 v12, v89
    v_sub_f32 v64, 0, v88
    v_sub_f32 v65, 0, v88
    v_sub_f32 v66, 0, v88
    v_sub_f32 v67, 0, v88
    v_sub_f32 v68, 0, v88
    v_sub_f32 v69, 0, v88
    v_sub_f32 v70, 0, v88
    v_sub_f32 v71, 0, v88
    v_sub_f32 v72, 0, v88
    v_sub_f32 v73, 0, v88
    v_sub_f32 v74, 0, v88
    v_sub_f32 v75, 0, v88
    v_sub_f32 v76, 0, v88
    v_sub_f32 v77, 0, v88
    v_sub_f32 v78, 0, v88
    v_sub_f32 v79, 0, v88
    v_mul_f32 v14, 0xc0135761, v13
    v_mul_f32 v15, v13, v13
    v_mul_f32 v15, 0x3d372713, v15
    v_mul_f32 v15, v14, v15
    v_mfma_f32_32x32x16_bf16 v[16:31], v[80:83], v[96:99], v[64:79]
    s_add_u32 m0, m0, 1024
    s_add_u32 s30, s39, 55296
    buffer_load_dwordx4 v11, s[12:15], s30 offen lds
    s_nop 3
    v_mfma_f32_32x32x16_bf16 v[16:31], v[84:87], v[100:103], v[16:31]
    s_nop 3
    v_mfma_f32_32x32x16_bf16 v[32:47], v[80:83], v[104:107], v[64:79]
    s_add_u32 m0, m0, 1024
    s_add_u32 s30, s39, 82944
    buffer_load_dwordx4 v11, s[12:15], s30 offen lds
    s_nop 3
    v_mfma_f32_32x32x16_bf16 v[32:47], v[84:87], v[108:111], v[32:47]
    s_nop 3
    v_mfma_f32_32x32x16_bf16 v[48:63], v[80:83], v[112:115], v[64:79]
    v_cvt_pk_bf16_f32 v96, v16, v17
    v_cvt_pk_bf16_f32 v97, v18, v19
    v_cvt_pk_bf16_f32 v98, v20, v21
    v_cvt_pk_bf16_f32 v99, v22, v23
    v_mfma_f32_32x32x16_bf16 v[48:63], v[84:87], v[116:119], v[48:63]
    s_add_u32 m0, m0, 1024
    s_add_u32 s30, s39, 110592
    buffer_load_dwordx4 v11, s[12:15], s30 offen lds
    v_cvt_pk_bf16_f32 v100, v24, v25
    v_cvt_pk_bf16_f32 v101, v26, v27
    v_cvt_pk_bf16_f32 v102, v28, v29
    v_cvt_pk_bf16_f32 v103, v30, v31
    v_mfma_f32_32x32x16_bf16 v[16:31], v[80:83], v[120:123], v[64:79]
    v_cvt_pk_bf16_f32 v104, v32, v33
    v_cvt_pk_bf16_f32 v105, v34, v35
    v_cvt_pk_bf16_f32 v106, v36, v37
    v_cvt_pk_bf16_f32 v107, v38, v39
    v_mfma_f32_32x32x16_bf16 v[16:31], v[84:87], v[124:127], v[16:31]
    s_add_u32 m0, m0, 1024
    s_add_u32 s30, s39, 138240
    buffer_load_dwordx4 v11, s[12:15], s30 offen lds
    v_cvt_pk_bf16_f32 v108, v40, v41
    v_cvt_pk_bf16_f32 v109, v42, v43
    v_cvt_pk_bf16_f32 v110, v44, v45
    v_cvt_pk_bf16_f32 v111, v46, v47
    v_mfma_f32_32x32x16_bf16 v[32:47], v[80:83], v[128:131], v[64:79]
    v_cvt_pk_bf16_f32 v112, v48, v49
    v_cvt_pk_bf16_f32 v113, v50, v51
    v_cvt_pk_bf16_f32 v114, v52, v53
    v_cvt_pk_bf16_f32 v115, v54, v55
    v_mfma_f32_32x32x16_bf16 v[32:47], v[84:87], v[132:135], v[32:47]
    v_cvt_pk_bf16_f32 v116, v56, v57
    v_cvt_pk_bf16_f32 v117, v58, v59
    v_cvt_pk_bf16_f32 v118, v60, v61
    v_cvt_pk_bf16_f32 v119, v62, v63
    v_mfma_f32_32x32x16_bf16 v[48:63], v[80:83], v[136:139], v[64:79]
    s_add_u32 m0, m0, 1024
    s_add_u32 s30, s39, 165888
    buffer_load_dwordx4 v11, s[12:15], s30 offen lds
    v_cvt_pk_bf16_f32 v120, v16, v17
    v_cvt_pk_bf16_f32 v121, v18, v19
    v_cvt_pk_bf16_f32 v122, v20, v21
    v_cvt_pk_bf16_f32 v123, v22, v23
    v_mfma_f32_32x32x16_bf16 v[48:63], v[84:87], v[140:143], v[48:63]
    v_cvt_pk_bf16_f32 v124, v24, v25
    v_cvt_pk_bf16_f32 v125, v26, v27
    v_cvt_pk_bf16_f32 v126, v28, v29
    v_cvt_pk_bf16_f32 v127, v30, v31
    v_mfma_f32_32x32x16_bf16 v[16:31], v[80:83], v[144:147], v[64:79]
    s_add_u32 m0, m0, 1024
    s_add_u32 s30, s39, 193536
    buffer_load_dwordx4 v11, s[12:15], s30 offen lds
    v_cvt_pk_bf16_f32 v128, v32, v33
    v_cvt_pk_bf16_f32 v129, v34, v35
    v_cvt_pk_bf16_f32 v130, v36, v37
    v_cvt_pk_bf16_f32 v131, v38, v39
    v_mfma_f32_32x32x16_bf16 v[16:31], v[84:87], v[148:151], v[16:31]
    v_cvt_pk_bf16_f32 v132, v40, v41
    v_cvt_pk_bf16_f32 v133, v42, v43
    v_cvt_pk_bf16_f32 v134, v44, v45
    v_cvt_pk_bf16_f32 v135, v46, v47
    v_mfma_f32_32x32x16_bf16 v[32:47], v[80:83], v[152:155], v[64:79]
    v_cvt_pk_bf16_f32 v136, v48, v49
    v_cvt_pk_bf16_f32 v137, v50, v51
    v_cvt_pk_bf16_f32 v138, v52, v53
    v_cvt_pk_bf16_f32 v139, v54, v55
    v_mfma_f32_32x32x16_bf16 v[32:47], v[84:87], v[156:159], v[32:47]
    s_add_u32 m0, m0, 1024
    s_add_u32 s30, s39, 221184
    buffer_load_dwordx4 v11, s[12:15], s30 offen lds
    v_cvt_pk_bf16_f32 v140, v56, v57
    v_cvt_pk_bf16_f32 v141, v58, v59
    v_cvt_pk_bf16_f32 v142, v60, v61
    v_cvt_pk_bf16_f32 v143, v62, v63
    v_mfma_f32_32x32x16_bf16 v[48:63], v[80:83], v[160:163], v[64:79]
    v_cvt_pk_bf16_f32 v144, v16, v17
    v_cvt_pk_bf16_f32 v145, v18, v19
    v_cvt_pk_bf16_f32 v146, v20, v21
    v_cvt_pk_bf16_f32 v147, v22, v23
    v_mfma_f32_32x32x16_bf16 v[48:63], v[84:87], v[164:167], v[48:63]
    s_add_u32 m0, m0, 1024
    s_add_u32 s30, s39, 248832
    buffer_load_dwordx4 v11, s[12:15], s30 offen lds
    v_cvt_pk_bf16_f32 v148, v24, v25
    v_cvt_pk_bf16_f32 v149, v26, v27
    v_cvt_pk_bf16_f32 v150, v28, v29
    v_cvt_pk_bf16_f32 v151, v30, v31
    v_mfma_f32_32x32x16_bf16 v[16:31], v[80:83], v[168:171], v[64:79]
    v_cvt_pk_bf16_f32 v152, v32, v33
    v_cvt_pk_bf16_f32 v153, v34, v35
    v_cvt_pk_bf16_f32 v154, v36, v37
    v_cvt_pk_bf16_f32 v155, v38, v39
    v_mfma_f32_32x32x16_bf16 v[16:31], v[84:87], v[172:175], v[16:31]
    v_cvt_pk_bf16_f32 v156, v40, v41
    v_cvt_pk_bf16_f32 v157, v42, v43
    v_cvt_pk_bf16_f32 v158, v44, v45
    v_cvt_pk_bf16_f32 v159, v46, v47
    v_mfma_f32_32x32x16_bf16 v[32:47], v[80:83], v[176:179], v[64:79]
    s_add_u32 m0, s27, 81920
    s_add_u32 s30, s40, 0
    buffer_load_dwordx4 v6, s[8:11], s30 offen lds
    v_cvt_pk_bf16_f32 v160, v48, v49
    v_cvt_pk_bf16_f32 v161, v50, v51
    v_cvt_pk_bf16_f32 v162, v52, v53
    v_cvt_pk_bf16_f32 v163, v54, v55
    v_mfma_f32_32x32x16_bf16 v[32:47], v[84:87], v[180:183], v[32:47]
    v_cvt_pk_bf16_f32 v164, v56, v57
    v_cvt_pk_bf16_f32 v165, v58, v59
    v_cvt_pk_bf16_f32 v166, v60, v61
    v_cvt_pk_bf16_f32 v167, v62, v63
    v_mfma_f32_32x32x16_bf16 v[48:63], v[80:83], v[184:187], v[64:79]
    s_add_u32 m0, m0, 1024
    s_add_u32 s30, s40, 0
    buffer_load_dwordx4 v7, s[8:11], s30 offen lds
    v_cvt_pk_bf16_f32 v168, v16, v17
    v_cvt_pk_bf16_f32 v169, v18, v19
    v_cvt_pk_bf16_f32 v170, v20, v21
    v_cvt_pk_bf16_f32 v171, v22, v23
    v_mfma_f32_32x32x16_bf16 v[48:63], v[84:87], v[188:191], v[48:63]
    v_cvt_pk_bf16_f32 v172, v24, v25
    v_cvt_pk_bf16_f32 v173, v26, v27
    v_cvt_pk_bf16_f32 v174, v28, v29
    v_cvt_pk_bf16_f32 v175, v30, v31
    v_mfma_f32_32x32x16_bf16 v[16:31], v[80:83], v[192:195], v[64:79]
    v_cvt_pk_bf16_f32 v176, v32, v33
    v_cvt_pk_bf16_f32 v177, v34, v35
    v_cvt_pk_bf16_f32 v178, v36, v37
    v_cvt_pk_bf16_f32 v179, v38, v39
    v_mfma_f32_32x32x16_bf16 v[16:31], v[84:87], v[196:199], v[16:31]
    s_add_u32 m0, m0, 1024
    s_add_u32 s30, s40, 0
    buffer_load_dwordx4 v8, s[8:11], s30 offen lds
    v_cvt_pk_bf16_f32 v180, v40, v41
    v_cvt_pk_bf16_f32 v181, v42, v43
    v_cvt_pk_bf16_f32 v182, v44, v45
    v_cvt_pk_bf16_f32 v183, v46, v47
    v_mfma_f32_32x32x16_bf16 v[32:47], v[80:83], v[200:203], v[64:79]
    v_cvt_pk_bf16_f32 v184, v48, v49
    v_cvt_pk_bf16_f32 v185, v50, v51
    v_cvt_pk_bf16_f32 v186, v52, v53
    v_cvt_pk_bf16_f32 v187, v54, v55
    v_mfma_f32_32x32x16_bf16 v[32:47], v[84:87], v[204:207], v[32:47]
    s_add_u32 m0, m0, 1024
    s_add_u32 s30, s40, 0
    buffer_load_dwordx4 v9, s[8:11], s30 offen lds
    v_cvt_pk_bf16_f32 v188, v56, v57
    v_cvt_pk_bf16_f32 v189, v58, v59
    v_cvt_pk_bf16_f32 v190, v60, v61
    v_cvt_pk_bf16_f32 v191, v62, v63
    v_mfma_f32_32x32x16_bf16 v[48:63], v[80:83], v[208:211], v[64:79]
    v_cvt_pk_bf16_f32 v192, v16, v17
    v_cvt_pk_bf16_f32 v193, v18, v19
    v_cvt_pk_bf16_f32 v194, v20, v21
    v_cvt_pk_bf16_f32 v195, v22, v23
    v_mfma_f32_32x32x16_bf16 v[48:63], v[84:87], v[212:215], v[48:63]
    v_cvt_pk_bf16_f32 v196, v24, v25
    v_cvt_pk_bf16_f32 v197, v26, v27
    v_cvt_pk_bf16_f32 v198, v28, v29
    v_cvt_pk_bf16_f32 v199, v30, v31
    v_mfma_f32_32x32x16_bf16 v[16:31], v[80:83], v[216:219], v[64:79]
    s_add_u32 m0, m0, 1024
    s_add_u32 s30, s40, 0
    buffer_load_dwordx4 v10, s[8:11], s30 offen lds
    v_cvt_pk_bf16_f32 v200, v32, v33
    v_cvt_pk_bf16_f32 v201, v34, v35
    v_cvt_pk_bf16_f32 v202, v36, v37
    v_cvt_pk_bf16_f32 v203, v38, v39
    v_mfma_f32_32x32x16_bf16 v[16:31], v[84:87], v[220:223], v[16:31]
    v_cvt_pk_bf16_f32 v204, v40, v41
    v_cvt_pk_bf16_f32 v205, v42, v43
    v_cvt_pk_bf16_f32 v206, v44, v45
    v_cvt_pk_bf16_f32 v207, v46, v47
    v_mfma_f32_32x32x16_bf16 v[32:47], v[80:83], v[224:227], v[64:79]
    s_add_u32 m0, m0, 1024
    s_add_u32 s30, s40, 61440
    buffer_load_dwordx4 v6, s[8:11], s30 offen lds
    v_cvt_pk_bf16_f32 v208, v48, v49
    v_cvt_pk_bf16_f32 v209, v50, v51
    v_cvt_pk_bf16_f32 v210, v52, v53
    v_cvt_pk_bf16_f32 v211, v54, v55
    v_mfma_f32_32x32x16_bf16 v[32:47], v[84:87], v[228:231], v[32:47]
    v_cvt_pk_bf16_f32 v212, v56, v57
    v_cvt_pk_bf16_f32 v213, v58, v59
    v_cvt_pk_bf16_f32 v214, v60, v61
    v_cvt_pk_bf16_f32 v215, v62, v63
    v_mfma_f32_32x32x16_bf16 v[48:63], v[80:83], v[232:235], v[64:79]
    v_cvt_pk_bf16_f32 v216, v16, v17
    v_cvt_pk_bf16_f32 v217, v18, v19
    v_cvt_pk_bf16_f32 v218, v20, v21
    v_cvt_pk_bf16_f32 v219, v22, v23
    v_mfma_f32_32x32x16_bf16 v[48:63], v[84:87], v[236:239], v[48:63]
    s_add_u32 m0, m0, 1024
    s_add_u32 s30, s40, 61440
    buffer_load_dwordx4 v7, s[8:11], s30 offen lds
    v_cvt_pk_bf16_f32 v220, v24, v25
    v_cvt_pk_bf16_f32 v221, v26, v27
    v_cvt_pk_bf16_f32 v222, v28, v29
    v_cvt_pk_bf16_f32 v223, v30, v31
    v_mfma_f32_32x32x16_bf16 v[16:31], v[80:83], v[240:243], v[64:79]
    v_cvt_pk_bf16_f32 v224, v32, v33
    v_cvt_pk_bf16_f32 v225, v34, v35
    v_cvt_pk_bf16_f32 v226, v36, v37
    v_cvt_pk_bf16_f32 v227, v38, v39
    v_mfma_f32_32x32x16_bf16 v[16:31], v[84:87], v[244:247], v[16:31]
    s_add_u32 m0, m0, 1024
    s_add_u32 s30, s40, 61440
    buffer_load_dwordx4 v8, s[8:11], s30 offen lds
    v_cvt_pk_bf16_f32 v228, v40, v41
    v_cvt_pk_bf16_f32 v229, v42, v43
    v_cvt_pk_bf16_f32 v230, v44, v45
    v_cvt_pk_bf16_f32 v231, v46, v47
    v_mfma_f32_32x32x16_bf16 v[32:47], v[80:83], v[248:251], v[64:79]
    v_cvt_pk_bf16_f32 v232, v48, v49
    v_cvt_pk_bf16_f32 v233, v50, v51
    v_cvt_pk_bf16_f32 v234, v52, v53
    v_cvt_pk_bf16_f32 v235, v54, v55
    v_mfma_f32_32x32x16_bf16 v[32:47], v[84:87], v[252:255], v[32:47]
    s_waitcnt vmcnt(18)
    s_barrier
    ds_read_b64_tr_b16 a[0:1], v2 offset:0
    ds_read_b64_tr_b16 a[2:3], v2 offset:512
    ds_read_b64_tr_b16 a[4:5], v2 offset:2048
    ds_read_b64_tr_b16 a[6:7], v2 offset:2560
    ds_read_b64_tr_b16 a[8:9], v2 offset:4096
    ds_read_b64_tr_b16 a[10:11], v2 offset:4608
    ds_read_b64_tr_b16 a[12:13], v2 offset:6144
    ds_read_b64_tr_b16 a[14:15], v2 offset:6656
    ds_read_b64_tr_b16 a[16:17], v2 offset:8192
    ds_read_b64_tr_b16 a[18:19], v2 offset:8704
    v_cvt_pk_bf16_f32 v236, v56, v57
    v_cvt_pk_bf16_f32 v237, v58, v59
    v_cvt_pk_bf16_f32 v238, v60, v61
    v_cvt_pk_bf16_f32 v239, v62, v63
    v_cvt_pk_bf16_f32 v240, v16, v17
    v_cvt_pk_bf16_f32 v241, v18, v19
    v_cvt_pk_bf16_f32 v242, v20, v21
    v_cvt_pk_bf16_f32 v243, v22, v23
    v_cvt_pk_bf16_f32 v244, v24, v25
    v_cvt_pk_bf16_f32 v245, v26, v27
    v_cvt_pk_bf16_f32 v246, v28, v29
    v_cvt_pk_bf16_f32 v247, v30, v31
    v_cvt_pk_bf16_f32 v248, v32, v33
    v_cvt_pk_bf16_f32 v249, v34, v35
    v_cvt_pk_bf16_f32 v250, v36, v37
    v_cvt_pk_bf16_f32 v251, v38, v39
    v_cvt_pk_bf16_f32 v252, v40, v41
    v_cvt_pk_bf16_f32 v253, v42, v43
    v_cvt_pk_bf16_f32 v254, v44, v45
    v_cvt_pk_bf16_f32 v255, v46, v47
    s_waitcnt lgkmcnt(8)
    v_mfma_f32_32x32x16_bf16 v[16:31], a[0:3], v[96:99], 0
    s_waitcnt lgkmcnt(6)
    ds_read_b64_tr_b16 a[20:21], v2 offset:10240
    ds_read_b64_tr_b16 a[22:23], v2 offset:10752
    v_and_b32 v58, 31, v0
    v_mfma_f32_32x32x16_bf16 v[16:31], a[4:7], v[100:103], v[16:31]
    s_waitcnt lgkmcnt(6)
    s_add_u32 m0, m0, 1024
    s_add_u32 s30, s40, 61440
    ds_read_b64_tr_b16 a[24:25], v2 offset:12288
    ds_read_b64_tr_b16 a[26:27], v2 offset:12800
    buffer_load_dwordx4 v9, s[8:11], s30 offen lds
    v_mfma_f32_32x32x16_bf16 v[16:31], a[8:11], v[104:107], v[16:31]
    s_waitcnt lgkmcnt(6)
    ds_read_b64_tr_b16 a[28:29], v2 offset:14336
    ds_read_b64_tr_b16 a[30:31], v2 offset:14848
    v_mfma_f32_32x32x16_bf16 v[16:31], a[12:15], v[108:111], v[16:31]
    s_waitcnt lgkmcnt(6)
    s_add_u32 m0, m0, 1024
    s_add_u32 s30, s40, 61440
    ds_read_b64_tr_b16 a[0:1], v2 offset:16384
    ds_read_b64_tr_b16 a[2:3], v2 offset:16896
    buffer_load_dwordx4 v10, s[8:11], s30 offen lds
    v_mfma_f32_32x32x16_bf16 v[16:31], a[16:19], v[112:115], v[16:31]
    s_waitcnt lgkmcnt(6)
    ds_read_b64_tr_b16 a[4:5], v2 offset:18432
    ds_read_b64_tr_b16 a[6:7], v2 offset:18944
    v_mfma_f32_32x32x16_bf16 v[16:31], a[20:23], v[116:119], v[16:31]
    s_waitcnt lgkmcnt(6)
    ds_read_b64_tr_b16 a[8:9], v2 offset:20480
    ds_read_b64_tr_b16 a[10:11], v2 offset:20992
    v_mul_u32_u24 v58, 136, v58
    v_mfma_f32_32x32x16_bf16 v[16:31], a[24:27], v[120:123], v[16:31]
    s_waitcnt lgkmcnt(6)
    s_add_u32 m0, s27, 122880
    s_add_u32 s30, s40, 491520
    ds_read_b64_tr_b16 a[12:13], v2 offset:22528
    ds_read_b64_tr_b16 a[14:15], v2 offset:23040
    buffer_load_dwordx4 v6, s[8:11], s30 offen lds
    v_mfma_f32_32x32x16_bf16 v[16:31], a[28:31], v[124:127], v[16:31]
    s_waitcnt lgkmcnt(6)
    ds_read_b64_tr_b16 a[16:17], v2 offset:24576
    ds_read_b64_tr_b16 a[18:19], v2 offset:25088
    v_mfma_f32_32x32x16_bf16 v[16:31], a[0:3], v[128:131], v[16:31]
    s_waitcnt lgkmcnt(6)
    s_add_u32 m0, m0, 1024
    s_add_u32 s30, s40, 491520
    ds_read_b64_tr_b16 a[20:21], v2 offset:26624
    ds_read_b64_tr_b16 a[22:23], v2 offset:27136
    buffer_load_dwordx4 v7, s[8:11], s30 offen lds
    v_mfma_f32_32x32x16_bf16 v[16:31], a[4:7], v[132:135], v[16:31]
    s_waitcnt lgkmcnt(6)
    ds_read_b64_tr_b16 a[24:25], v2 offset:28672
    ds_read_b64_tr_b16 a[26:27], v2 offset:29184
    v_mfma_f32_32x32x16_bf16 v[16:31], a[8:11], v[136:139], v[16:31]
    s_waitcnt lgkmcnt(6)
    ds_read_b64_tr_b16 a[28:29], v2 offset:30720
    ds_read_b64_tr_b16 a[30:31], v2 offset:31232
    v_lshrrev_b32 v59, 5, v0
    v_mfma_f32_32x32x16_bf16 v[16:31], a[12:15], v[140:143], v[16:31]
    s_waitcnt lgkmcnt(6)
    s_add_u32 m0, m0, 1024
    s_add_u32 s30, s40, 491520
    ds_read_b64_tr_b16 a[0:1], v2 offset:32768
    ds_read_b64_tr_b16 a[2:3], v2 offset:33280
    buffer_load_dwordx4 v8, s[8:11], s30 offen lds
    v_mfma_f32_32x32x16_bf16 v[16:31], a[16:19], v[144:147], v[16:31]
    s_waitcnt lgkmcnt(6)
    ds_read_b64_tr_b16 a[4:5], v2 offset:34816
    ds_read_b64_tr_b16 a[6:7], v2 offset:35328
    v_mfma_f32_32x32x16_bf16 v[16:31], a[20:23], v[148:151], v[16:31]
    s_waitcnt lgkmcnt(6)
    s_add_u32 m0, m0, 1024
    s_add_u32 s30, s40, 491520
    ds_read_b64_tr_b16 a[8:9], v2 offset:36864
    ds_read_b64_tr_b16 a[10:11], v2 offset:37376
    buffer_load_dwordx4 v9, s[8:11], s30 offen lds
    v_mfma_f32_32x32x16_bf16 v[16:31], a[24:27], v[152:155], v[16:31]
    s_waitcnt lgkmcnt(6)
    ds_read_b64_tr_b16 a[12:13], v2 offset:38912
    ds_read_b64_tr_b16 a[14:15], v2 offset:39424
    v_mfma_f32_32x32x16_bf16 v[16:31], a[28:31], v[156:159], v[16:31]
    s_waitcnt vmcnt(14) lgkmcnt(6)
    s_barrier
    v_add_u32 v2, 40960, v2
    s_lshl_b32 s29, s25, 4
    buffer_load_dword v92, off, s[20:23], s29 sc1
    ds_read_b64_tr_b16 a[16:17], v2 offset:0
    ds_read_b64_tr_b16 a[18:19], v2 offset:512
    v_lshl_add_u32 v58, v59, 3, v58
    v_mfma_f32_32x32x16_bf16 v[16:31], a[0:3], v[160:163], v[16:31]
    s_waitcnt lgkmcnt(6)
    s_add_u32 m0, m0, 1024
    s_add_u32 s30, s40, 491520
    ds_read_b64_tr_b16 a[20:21], v2 offset:2048
    ds_read_b64_tr_b16 a[22:23], v2 offset:2560
    buffer_load_dwordx4 v10, s[8:11], s30 offen lds
    v_mfma_f32_32x32x16_bf16 v[16:31], a[4:7], v[164:167], v[16:31]
    s_waitcnt lgkmcnt(6)
    ds_read_b64_tr_b16 a[24:25], v2 offset:4096
    ds_read_b64_tr_b16 a[26:27], v2 offset:4608
    v_mfma_f32_32x32x16_bf16 v[16:31], a[8:11], v[168:171], v[16:31]
    s_waitcnt lgkmcnt(6)
    s_add_u32 m0, m0, 1024
    s_add_u32 s30, s40, 552960
    ds_read_b64_tr_b16 a[28:29], v2 offset:6144
    ds_read_b64_tr_b16 a[30:31], v2 offset:6656
    buffer_load_dwordx4 v6, s[8:11], s30 offen lds
    v_mfma_f32_32x32x16_bf16 v[16:31], a[12:15], v[172:175], v[16:31]
    s_waitcnt lgkmcnt(6)
    ds_read_b64_tr_b16 a[0:1], v2 offset:8192
    ds_read_b64_tr_b16 a[2:3], v2 offset:8704
    v_mfma_f32_32x32x16_bf16 v[16:31], a[16:19], v[176:179], v[16:31]
    s_waitcnt lgkmcnt(6)
    ds_read_b64_tr_b16 a[4:5], v2 offset:10240
    ds_read_b64_tr_b16 a[6:7], v2 offset:10752
    v_add_u32 v58, s27, v58
    v_mfma_f32_32x32x16_bf16 v[16:31], a[20:23], v[180:183], v[16:31]
    s_waitcnt lgkmcnt(6)
    s_add_u32 m0, m0, 1024
    s_add_u32 s30, s40, 552960
    ds_read_b64_tr_b16 a[8:9], v2 offset:12288
    ds_read_b64_tr_b16 a[10:11], v2 offset:12800
    buffer_load_dwordx4 v7, s[8:11], s30 offen lds
    v_mfma_f32_32x32x16_bf16 v[16:31], a[24:27], v[184:187], v[16:31]
    s_waitcnt lgkmcnt(6)
    ds_read_b64_tr_b16 a[12:13], v2 offset:14336
    ds_read_b64_tr_b16 a[14:15], v2 offset:14848
    v_mfma_f32_32x32x16_bf16 v[16:31], a[28:31], v[188:191], v[16:31]
    s_waitcnt lgkmcnt(6)
    s_add_u32 m0, m0, 1024
    s_add_u32 s30, s40, 552960
    ds_read_b64_tr_b16 a[16:17], v2 offset:16384
    ds_read_b64_tr_b16 a[18:19], v2 offset:16896
    buffer_load_dwordx4 v8, s[8:11], s30 offen lds
    v_mfma_f32_32x32x16_bf16 v[16:31], a[0:3], v[192:195], v[16:31]
    s_waitcnt lgkmcnt(6)
    ds_read_b64_tr_b16 a[20:21], v2 offset:18432
    ds_read_b64_tr_b16 a[22:23], v2 offset:18944
    v_mfma_f32_32x32x16_bf16 v[16:31], a[4:7], v[196:199], v[16:31]
    s_waitcnt lgkmcnt(6)
    ds_read_b64_tr_b16 a[24:25], v2 offset:20480
    ds_read_b64_tr_b16 a[26:27], v2 offset:20992
    v_bfe_u32 v59, v2, 7, 4
    v_mfma_f32_32x32x16_bf16 v[16:31], a[8:11], v[200:203], v[16:31]
    s_waitcnt lgkmcnt(6)
    s_add_u32 m0, m0, 1024
    s_add_u32 s30, s40, 552960
    ds_read_b64_tr_b16 a[28:29], v2 offset:22528
    ds_read_b64_tr_b16 a[30:31], v2 offset:23040
    buffer_load_dwordx4 v9, s[8:11], s30 offen lds
    v_mfma_f32_32x32x16_bf16 v[16:31], a[12:15], v[204:207], v[16:31]
    s_waitcnt lgkmcnt(6)
    ds_read_b64_tr_b16 a[0:1], v2 offset:24576
    ds_read_b64_tr_b16 a[2:3], v2 offset:25088
    v_mfma_f32_32x32x16_bf16 v[16:31], a[16:19], v[208:211], v[16:31]
    s_waitcnt lgkmcnt(6)
    s_add_u32 m0, m0, 1024
    s_add_u32 s30, s40, 552960
    ds_read_b64_tr_b16 a[4:5], v2 offset:26624
    ds_read_b64_tr_b16 a[6:7], v2 offset:27136
    buffer_load_dwordx4 v10, s[8:11], s30 offen lds
    v_mfma_f32_32x32x16_bf16 v[16:31], a[20:23], v[212:215], v[16:31]
    s_waitcnt lgkmcnt(6)
    ds_read_b64_tr_b16 a[8:9], v2 offset:28672
    ds_read_b64_tr_b16 a[10:11], v2 offset:29184
    v_mfma_f32_32x32x16_bf16 v[16:31], a[24:27], v[216:219], v[16:31]
    s_waitcnt lgkmcnt(6)
    ds_read_b64_tr_b16 a[12:13], v2 offset:30720
    ds_read_b64_tr_b16 a[14:15], v2 offset:31232
    v_mul_u32_u24 v59, 136, v59
    v_mfma_f32_32x32x16_bf16 v[16:31], a[28:31], v[220:223], v[16:31]
    s_waitcnt lgkmcnt(6)
    ds_read_b64_tr_b16 a[16:17], v2 offset:32768
    ds_read_b64_tr_b16 a[18:19], v2 offset:33280
    v_and_b32 v60, 63, v2
    v_mfma_f32_32x32x16_bf16 v[16:31], a[0:3], v[224:227], v[16:31]
    s_waitcnt lgkmcnt(6)
    ds_read_b64_tr_b16 a[20:21], v2 offset:34816
    ds_read_b64_tr_b16 a[22:23], v2 offset:35328
    v_add3_u32 v59, s27, v59, v60
    v_mfma_f32_32x32x16_bf16 v[16:31], a[4:7], v[228:231], v[16:31]
    s_waitcnt lgkmcnt(6)
    ds_read_b64_tr_b16 a[24:25], v2 offset:36864
    ds_read_b64_tr_b16 a[26:27], v2 offset:37376
    v_lshrrev_b32 v57, 5, v0
    v_mfma_f32_32x32x16_bf16 v[16:31], a[8:11], v[232:235], v[16:31]
    s_waitcnt lgkmcnt(6)
    ds_read_b64_tr_b16 a[28:29], v2 offset:38912
    ds_read_b64_tr_b16 a[30:31], v2 offset:39424
    v_mul_u32_u24 v57, 13824, v57
    v_mfma_f32_32x32x16_bf16 v[16:31], a[12:15], v[236:239], v[16:31]
    s_waitcnt lgkmcnt(6)
    ds_read_b64_tr_b16 a[0:1], v3 offset:0
    ds_read_b64_tr_b16 a[2:3], v3 offset:512
    v_add_u32 v57, v1, v57
    v_mfma_f32_32x32x16_bf16 v[16:31], a[16:19], v[240:243], v[16:31]
    s_waitcnt lgkmcnt(6)
    ds_read_b64_tr_b16 a[4:5], v3 offset:2048
    ds_read_b64_tr_b16 a[6:7], v3 offset:2560
    v_mfma_f32_32x32x16_bf16 v[16:31], a[20:23], v[244:247], v[16:31]
    s_waitcnt lgkmcnt(6)
    ds_read_b64_tr_b16 a[8:9], v3 offset:4096
    ds_read_b64_tr_b16 a[10:11], v3 offset:4608
    v_mfma_f32_32x32x16_bf16 v[16:31], a[24:27], v[248:251], v[16:31]
    s_waitcnt lgkmcnt(6)
    ds_read_b64_tr_b16 a[12:13], v3 offset:6144
    ds_read_b64_tr_b16 a[14:15], v3 offset:6656
    v_mfma_f32_32x32x16_bf16 v[16:31], a[28:31], v[252:255], v[16:31]
    s_waitcnt lgkmcnt(6)
    ds_read_b64_tr_b16 a[16:17], v3 offset:8192
    ds_read_b64_tr_b16 a[18:19], v3 offset:8704
    v_mfma_f32_32x32x16_bf16 v[32:47], a[0:3], v[96:99], 0
    s_waitcnt lgkmcnt(6)
    ds_read_b64_tr_b16 a[20:21], v3 offset:10240
    ds_read_b64_tr_b16 a[22:23], v3 offset:10752
    v_mfma_f32_32x32x16_bf16 v[32:47], a[4:7], v[100:103], v[32:47]
    s_waitcnt lgkmcnt(6)
    ds_read_b64_tr_b16 a[24:25], v3 offset:12288
    ds_read_b64_tr_b16 a[26:27], v3 offset:12800
    v_mfma_f32_32x32x16_bf16 v[32:47], a[8:11], v[104:107], v[32:47]
    s_waitcnt lgkmcnt(6)
    ds_read_b64_tr_b16 a[28:29], v3 offset:14336
    ds_read_b64_tr_b16 a[30:31], v3 offset:14848
    v_mfma_f32_32x32x16_bf16 v[32:47], a[12:15], v[108:111], v[32:47]
    s_waitcnt lgkmcnt(6)
    ds_read_b64_tr_b16 a[0:1], v3 offset:16384
    ds_read_b64_tr_b16 a[2:3], v3 offset:16896
    v_mul_f32 v48, v16, v16
    v_mul_f32 v49, v17, v17
    v_fma_f32 v48, v48, v15, v14
    v_fma_f32 v49, v49, v15, v14
    v_mul_f32 v48, v48, v16
    v_mul_f32 v49, v49, v17
    v_mfma_f32_32x32x16_bf16 v[32:47], a[16:19], v[112:115], v[32:47]
    s_waitcnt lgkmcnt(6)
    ds_read_b64_tr_b16 a[4:5], v3 offset:18432
    ds_read_b64_tr_b16 a[6:7], v3 offset:18944
    v_exp_f32 v48, v48
    v_exp_f32 v49, v49
    v_mfma_f32_32x32x16_bf16 v[32:47], a[20:23], v[116:119], v[32:47]
    s_waitcnt lgkmcnt(6)
    ds_read_b64_tr_b16 a[8:9], v3 offset:20480
    ds_read_b64_tr_b16 a[10:11], v3 offset:20992
    v_fma_f32 v48, v48, v12, v12
    v_fma_f32 v49, v49, v12, v12
    v_rcp_f32 v48, v48
    v_mfma_f32_32x32x16_bf16 v[32:47], a[24:27], v[120:123], v[32:47]
    s_waitcnt lgkmcnt(6)
    ds_read_b64_tr_b16 a[12:13], v3 offset:22528
    ds_read_b64_tr_b16 a[14:15], v3 offset:23040
    v_rcp_f32 v49, v49
    v_mul_f32 v16, v16, v48
    v_mul_f32 v17, v17, v49
    v_mfma_f32_32x32x16_bf16 v[32:47], a[28:31], v[124:127], v[32:47]
    s_waitcnt lgkmcnt(6)
    ds_read_b64_tr_b16 a[16:17], v3 offset:24576
    ds_read_b64_tr_b16 a[18:19], v3 offset:25088
    v_mul_f32 v48, v18, v18
    v_mul_f32 v49, v19, v19
    v_fma_f32 v48, v48, v15, v14
    v_fma_f32 v49, v49, v15, v14
    v_mfma_f32_32x32x16_bf16 v[32:47], a[0:3], v[128:131], v[32:47]
    s_waitcnt lgkmcnt(6)
    ds_read_b64_tr_b16 a[20:21], v3 offset:26624
    ds_read_b64_tr_b16 a[22:23], v3 offset:27136
    v_mul_f32 v48, v48, v18
    v_mul_f32 v49, v49, v19
    v_exp_f32 v48, v48
    v_mfma_f32_32x32x16_bf16 v[32:47], a[4:7], v[132:135], v[32:47]
    s_waitcnt lgkmcnt(6)
    ds_read_b64_tr_b16 a[24:25], v3 offset:28672
    ds_read_b64_tr_b16 a[26:27], v3 offset:29184
    v_exp_f32 v49, v49
    v_fma_f32 v48, v48, v12, v12
    v_fma_f32 v49, v49, v12, v12
    v_mfma_f32_32x32x16_bf16 v[32:47], a[8:11], v[136:139], v[32:47]
    s_waitcnt lgkmcnt(6)
    ds_read_b64_tr_b16 a[28:29], v3 offset:30720
    ds_read_b64_tr_b16 a[30:31], v3 offset:31232
    v_rcp_f32 v48, v48
    v_rcp_f32 v49, v49
    v_mfma_f32_32x32x16_bf16 v[32:47], a[12:15], v[140:143], v[32:47]
    s_waitcnt lgkmcnt(6)
    ds_read_b64_tr_b16 a[0:1], v3 offset:32768
    ds_read_b64_tr_b16 a[2:3], v3 offset:33280
    v_mul_f32 v18, v18, v48
    v_mul_f32 v19, v19, v49
    v_mul_f32 v48, v20, v20
    v_mul_f32 v49, v21, v21
    v_mfma_f32_32x32x16_bf16 v[32:47], a[16:19], v[144:147], v[32:47]
    s_waitcnt lgkmcnt(6)
    ds_read_b64_tr_b16 a[4:5], v3 offset:34816
    ds_read_b64_tr_b16 a[6:7], v3 offset:35328
    v_fma_f32 v48, v48, v15, v14
    v_fma_f32 v49, v49, v15, v14
    v_mul_f32 v48, v48, v20
    v_mul_f32 v49, v49, v21
    v_mfma_f32_32x32x16_bf16 v[32:47], a[20:23], v[148:151], v[32:47]
    s_waitcnt lgkmcnt(6)
    ds_read_b64_tr_b16 a[8:9], v3 offset:36864
    ds_read_b64_tr_b16 a[10:11], v3 offset:37376
    v_exp_f32 v48, v48
    v_exp_f32 v49, v49
    v_mfma_f32_32x32x16_bf16 v[32:47], a[24:27], v[152:155], v[32:47]
    s_waitcnt lgkmcnt(6)
    ds_read_b64_tr_b16 a[12:13], v3 offset:38912
    ds_read_b64_tr_b16 a[14:15], v3 offset:39424
    v_fma_f32 v48, v48, v12, v12
    v_fma_f32 v49, v49, v12, v12
    v_rcp_f32 v48, v48
    v_mfma_f32_32x32x16_bf16 v[32:47], a[28:31], v[156:159], v[32:47]
    s_waitcnt vmcnt(63) lgkmcnt(6)
    s_barrier
    v_add_u32 v3, 40960, v3
    ds_read_b64_tr_b16 a[16:17], v3 offset:0
    ds_read_b64_tr_b16 a[18:19], v3 offset:512
    v_rcp_f32 v49, v49
    v_mul_f32 v20, v20, v48
    v_mul_f32 v21, v21, v49
    v_mfma_f32_32x32x16_bf16 v[32:47], a[0:3], v[160:163], v[32:47]
    s_waitcnt lgkmcnt(6)
    s_add_u32 m0, s27, 0
    s_add_u32 s30, s40, 983040
    ds_read_b64_tr_b16 a[20:21], v3 offset:2048
    ds_read_b64_tr_b16 a[22:23], v3 offset:2560
    buffer_load_dwordx4 v6, s[8:11], s30 offen lds
    v_mul_f32 v48, v22, v22
    v_mul_f32 v49, v23, v23
    v_mfma_f32_32x32x16_bf16 v[32:47], a[4:7], v[164:167], v[32:47]
    s_waitcnt lgkmcnt(6)
    ds_read_b64_tr_b16 a[24:25], v3 offset:4096
    ds_read_b64_tr_b16 a[26:27], v3 offset:4608
    v_fma_f32 v48, v48, v15, v14
    v_fma_f32 v49, v49, v15, v14
    v_mul_f32 v48, v48, v22
    v_mul_f32 v49, v49, v23
    v_mfma_f32_32x32x16_bf16 v[32:47], a[8:11], v[168:171], v[32:47]
    s_waitcnt lgkmcnt(6)
    ds_read_b64_tr_b16 a[28:29], v3 offset:6144
    ds_read_b64_tr_b16 a[30:31], v3 offset:6656
    v_exp_f32 v48, v48
    v_exp_f32 v49, v49
    v_mfma_f32_32x32x16_bf16 v[32:47], a[12:15], v[172:175], v[32:47]
    s_waitcnt lgkmcnt(6)
    s_add_u32 m0, m0, 1024
    s_add_u32 s30, s40, 983040
    ds_read_b64_tr_b16 a[0:1], v3 offset:8192
    ds_read_b64_tr_b16 a[2:3], v3 offset:8704
    buffer_load_dwordx4 v7, s[8:11], s30 offen lds
    v_fma_f32 v48, v48, v12, v12
    v_fma_f32 v49, v49, v12, v12
    v_mfma_f32_32x32x16_bf16 v[32:47], a[16:19], v[176:179], v[32:47]
    s_waitcnt lgkmcnt(6)
    ds_read_b64_tr_b16 a[4:5], v3 offset:10240
    ds_read_b64_tr_b16 a[6:7], v3 offset:10752
    v_rcp_f32 v48, v48
    v_rcp_f32 v49, v49
    v_mfma_f32_32x32x16_bf16 v[32:47], a[20:23], v[180:183], v[32:47]
    s_waitcnt lgkmcnt(6)
    ds_read_b64_tr_b16 a[8:9], v3 offset:12288
    ds_read_b64_tr_b16 a[10:11], v3 offset:12800
    v_mul_f32 v22, v22, v48
    v_mul_f32 v23, v23, v49
    v_mul_f32 v48, v24, v24
    v_mul_f32 v49, v25, v25
    v_mfma_f32_32x32x16_bf16 v[32:47], a[24:27], v[184:187], v[32:47]
    s_waitcnt lgkmcnt(6)
    s_add_u32 m0, m0, 1024
    s_add_u32 s30, s40, 983040
    ds_read_b64_tr_b16 a[12:13], v3 offset:14336
    ds_read_b64_tr_b16 a[14:15], v3 offset:14848
    buffer_load_dwordx4 v8, s[8:11], s30 offen lds
    v_fma_f32 v48, v48, v15, v14
    v_fma_f32 v49, v49, v15, v14
    v_mfma_f32_32x32x16_bf16 v[32:47], a[28:31], v[188:191], v[32:47]
    s_waitcnt lgkmcnt(6)
    ds_read_b64_tr_b16 a[16:17], v3 offset:16384
    ds_read_b64_tr_b16 a[18:19], v3 offset:16896
    v_mul_f32 v48, v48, v24
    v_mul_f32 v49, v49, v25
    v_exp_f32 v48, v48
    v_mfma_f32_32x32x16_bf16 v[32:47], a[0:3], v[192:195], v[32:47]
    s_waitcnt lgkmcnt(6)
    ds_read_b64_tr_b16 a[20:21], v3 offset:18432
    ds_read_b64_tr_b16 a[22:23], v3 offset:18944
    v_exp_f32 v49, v49
    v_fma_f32 v48, v48, v12, v12
    v_fma_f32 v49, v49, v12, v12
    v_mfma_f32_32x32x16_bf16 v[32:47], a[4:7], v[196:199], v[32:47]
    s_waitcnt lgkmcnt(6)
    s_add_u32 m0, m0, 1024
    s_add_u32 s30, s40, 983040
    ds_read_b64_tr_b16 a[24:25], v3 offset:20480
    ds_read_b64_tr_b16 a[26:27], v3 offset:20992
    buffer_load_dwordx4 v9, s[8:11], s30 offen lds
    v_rcp_f32 v48, v48
    v_mfma_f32_32x32x16_bf16 v[32:47], a[8:11], v[200:203], v[32:47]
    s_waitcnt lgkmcnt(6)
    ds_read_b64_tr_b16 a[28:29], v3 offset:22528
    ds_read_b64_tr_b16 a[30:31], v3 offset:23040
    v_rcp_f32 v49, v49
    v_mul_f32 v24, v24, v48
    v_mul_f32 v25, v25, v49
    v_mfma_f32_32x32x16_bf16 v[32:47], a[12:15], v[204:207], v[32:47]
    s_waitcnt lgkmcnt(6)
    ds_read_b64_tr_b16 a[0:1], v3 offset:24576
    ds_read_b64_tr_b16 a[2:3], v3 offset:25088
    v_mul_f32 v48, v26, v26
    v_mul_f32 v49, v27, v27
    v_fma_f32 v48, v48, v15, v14
    v_fma_f32 v49, v49, v15, v14
    v_mfma_f32_32x32x16_bf16 v[32:47], a[16:19], v[208:211], v[32:47]
    s_waitcnt lgkmcnt(6)
    s_add_u32 m0, m0, 1024
    s_add_u32 s30, s40, 983040
    ds_read_b64_tr_b16 a[4:5], v3 offset:26624
    ds_read_b64_tr_b16 a[6:7], v3 offset:27136
    buffer_load_dwordx4 v10, s[8:11], s30 offen lds
    v_mul_f32 v48, v48, v26
    v_mul_f32 v49, v49, v27
    v_mfma_f32_32x32x16_bf16 v[32:47], a[20:23], v[212:215], v[32:47]
    s_waitcnt lgkmcnt(6)
    ds_read_b64_tr_b16 a[8:9], v3 offset:28672
    ds_read_b64_tr_b16 a[10:11], v3 offset:29184
    v_exp_f32 v48, v48
    v_exp_f32 v49, v49
    v_mfma_f32_32x32x16_bf16 v[32:47], a[24:27], v[216:219], v[32:47]
    s_waitcnt lgkmcnt(6)
    ds_read_b64_tr_b16 a[12:13], v3 offset:30720
    ds_read_b64_tr_b16 a[14:15], v3 offset:31232
    v_fma_f32 v48, v48, v12, v12
    v_fma_f32 v49, v49, v12, v12
    v_rcp_f32 v48, v48
    v_mfma_f32_32x32x16_bf16 v[32:47], a[28:31], v[220:223], v[32:47]
    s_waitcnt lgkmcnt(6)
    s_add_u32 m0, m0, 1024
    s_add_u32 s30, s40, 1044480
    ds_read_b64_tr_b16 a[16:17], v3 offset:32768
    ds_read_b64_tr_b16 a[18:19], v3 offset:33280
    buffer_load_dwordx4 v6, s[8:11], s30 offen lds
    v_rcp_f32 v49, v49
    v_mfma_f32_32x32x16_bf16 v[32:47], a[0:3], v[224:227], v[32:47]
    s_waitcnt lgkmcnt(6)
    ds_read_b64_tr_b16 a[20:21], v3 offset:34816
    ds_read_b64_tr_b16 a[22:23], v3 offset:35328
    v_mul_f32 v26, v26, v48
    v_mul_f32 v27, v27, v49
    v_mul_f32 v48, v28, v28
    v_mul_f32 v49, v29, v29
    v_mfma_f32_32x32x16_bf16 v[32:47], a[4:7], v[228:231], v[32:47]
    s_waitcnt lgkmcnt(6)
    ds_read_b64_tr_b16 a[24:25], v3 offset:36864
    ds_read_b64_tr_b16 a[26:27], v3 offset:37376
    v_fma_f32 v48, v48, v15, v14
    v_fma_f32 v49, v49, v15, v14
    v_mul_f32 v48, v48, v28
    v_mul_f32 v49, v49, v29
    v_mfma_f32_32x32x16_bf16 v[32:47], a[8:11], v[232:235], v[32:47]
    s_waitcnt lgkmcnt(6)
    s_add_u32 m0, m0, 1024
    s_add_u32 s30, s40, 1044480
    ds_read_b64_tr_b16 a[28:29], v3 offset:38912
    ds_read_b64_tr_b16 a[30:31], v3 offset:39424
    buffer_load_dwordx4 v7, s[8:11], s30 offen lds
    v_exp_f32 v48, v48
    v_mfma_f32_32x32x16_bf16 v[32:47], a[12:15], v[236:239], v[32:47]
    s_waitcnt vmcnt(17) lgkmcnt(6)
    s_barrier
    ds_read_b64_tr_b16 a[0:1], v4 offset:0
    ds_read_b64_tr_b16 a[2:3], v4 offset:1280
    v_exp_f32 v49, v49
    v_fma_f32 v48, v48, v12, v12
    v_fma_f32 v49, v49, v12, v12
    v_mfma_f32_32x32x16_bf16 v[32:47], a[16:19], v[240:243], v[32:47]
    s_waitcnt lgkmcnt(6)
    ds_read_b64_tr_b16 a[4:5], v4 offset:40
    ds_read_b64_tr_b16 a[6:7], v4 offset:1320
    v_rcp_f32 v48, v48
    v_rcp_f32 v49, v49
    v_mfma_f32_32x32x16_bf16 v[32:47], a[20:23], v[244:247], v[32:47]
    s_waitcnt lgkmcnt(6)
    s_add_u32 m0, m0, 1024
    s_add_u32 s30, s40, 1044480
    ds_read_b64_tr_b16 a[8:9], v4 offset:80
    ds_read_b64_tr_b16 a[10:11], v4 offset:1360
    buffer_load_dwordx4 v8, s[8:11], s30 offen lds
    v_mul_f32 v28, v28, v48
    v_mul_f32 v29, v29, v49
    v_mfma_f32_32x32x16_bf16 v[32:47], a[24:27], v[248:251], v[32:47]
    s_waitcnt lgkmcnt(6)
    ds_read_b64_tr_b16 a[12:13], v4 offset:120
    ds_read_b64_tr_b16 a[14:15], v4 offset:1400
    v_mul_f32 v48, v30, v30
    v_mul_f32 v49, v31, v31
    v_fma_f32 v48, v48, v15, v14
    v_fma_f32 v49, v49, v15, v14
    v_mfma_f32_32x32x16_bf16 v[32:47], a[28:31], v[252:255], v[32:47]
    s_waitcnt lgkmcnt(6)
    ds_read_b64_tr_b16 a[16:17], v5 offset:0
    ds_read_b64_tr_b16 a[18:19], v5 offset:1280
    v_mul_f32 v48, v48, v30
    v_mul_f32 v49, v49, v31
    v_exp_f32 v48, v48
    v_mfma_f32_32x32x16_bf16 a[64:79], a[0:3], v[96:99], 0
    s_waitcnt lgkmcnt(6)
    ds_read_b64_tr_b16 a[20:21], v4 offset:5120
    ds_read_b64_tr_b16 a[22:23], v4 offset:6400
    v_exp_f32 v49, v49
    v_fma_f32 v48, v48, v12, v12
    v_fma_f32 v49, v49, v12, v12
    v_mfma_f32_32x32x16_bf16 a[80:95], a[4:7], v[96:99], 0
    s_waitcnt lgkmcnt(6)
    s_add_u32 m0, m0, 1024
    s_add_u32 s30, s40, 1044480
    ds_read_b64_tr_b16 a[24:25], v4 offset:5160
    ds_read_b64_tr_b16 a[26:27], v4 offset:6440
    buffer_load_dwordx4 v9, s[8:11], s30 offen lds
    v_rcp_f32 v48, v48
    v_mfma_f32_32x32x16_bf16 a[96:111], a[8:11], v[96:99], 0
    s_waitcnt lgkmcnt(6)
    ds_read_b64_tr_b16 a[28:29], v4 offset:5200
    ds_read_b64_tr_b16 a[30:31], v4 offset:6480
    v_rcp_f32 v49, v49
    v_mul_f32 v30, v30, v48
    v_mul_f32 v31, v31, v49
    v_mfma_f32_32x32x16_bf16 a[112:127], a[12:15], v[96:99], 0
    s_waitcnt lgkmcnt(6)
    ds_read_b64_tr_b16 a[0:1], v4 offset:5240
    ds_read_b64_tr_b16 a[2:3], v4 offset:6520
    v_mul_f32 v48, v32, v32
    v_mul_f32 v49, v33, v33
    v_fma_f32 v48, v48, v15, v14
    v_fma_f32 v49, v49, v15, v14
    v_mfma_f32_32x32x16_bf16 a[128:143], a[16:19], v[96:99], 0
    s_waitcnt lgkmcnt(6)
    s_add_u32 m0, m0, 1024
    s_add_u32 s30, s40, 1044480
    ds_read_b64_tr_b16 a[4:5], v5 offset:5120
    ds_read_b64_tr_b16 a[6:7], v5 offset:6400
    buffer_load_dwordx4 v10, s[8:11], s30 offen lds
    v_mul_f32 v48, v48, v32
    v_mul_f32 v49, v49, v33
    v_mfma_f32_32x32x16_bf16 a[64:79], a[20:23], v[100:103], a[64:79]
    s_waitcnt lgkmcnt(6)
    ds_read_b64_tr_b16 a[8:9], v4 offset:10240
    ds_read_b64_tr_b16 a[10:11], v4 offset:11520
    v_exp_f32 v48, v48
    v_exp_f32 v49, v49
    v_mfma_f32_32x32x16_bf16 a[80:95], a[24:27], v[100:103], a[80:95]
    s_waitcnt lgkmcnt(6)
    ds_read_b64_tr_b16 a[12:13], v4 offset:10280
    ds_read_b64_tr_b16 a[14:15], v4 offset:11560
    v_fma_f32 v48, v48, v12, v12
    v_fma_f32 v49, v49, v12, v12
    v_rcp_f32 v48, v48
    v_mfma_f32_32x32x16_bf16 a[96:111], a[28:31], v[100:103], a[96:111]
    s_waitcnt lgkmcnt(6)
    s_add_u32 m0, s27, 40960
    s_add_u32 s30, s40, 1474560
    ds_read_b64_tr_b16 a[16:17], v4 offset:10320
    ds_read_b64_tr_b16 a[18:19], v4 offset:11600
    buffer_load_dwordx4 v6, s[8:11], s30 offen lds
    v_rcp_f32 v49, v49
    v_mfma_f32_32x32x16_bf16 a[112:127], a[0:3], v[100:103], a[112:127]
    s_waitcnt lgkmcnt(6)
    ds_read_b64_tr_b16 a[20:21], v4 offset:10360
    ds_read_b64_tr_b16 a[22:23], v4 offset:11640
    v_mul_f32 v32, v32, v48
    v_mul_f32 v33, v33, v49
    v_mul_f32 v48, v34, v34
    v_mul_f32 v49, v35, v35
    v_mfma_f32_32x32x16_bf16 a[128:143], a[4:7], v[100:103], a[128:143]
    s_waitcnt lgkmcnt(6)
    ds_read_b64_tr_b16 a[24:25], v5 offset:10240
    ds_read_b64_tr_b16 a[26:27], v5 offset:11520
    v_fma_f32 v48, v48, v15, v14
    v_fma_f32 v49, v49, v15, v14
    v_mul_f32 v48, v48, v34
    v_mul_f32 v49, v49, v35
    v_mfma_f32_32x32x16_bf16 a[64:79], a[8:11], v[104:107], a[64:79]
    s_waitcnt lgkmcnt(6)
    s_add_u32 m0, m0, 1024
    s_add_u32 s30, s40, 1474560
    ds_read_b64_tr_b16 a[28:29], v4 offset:15360
    ds_read_b64_tr_b16 a[30:31], v4 offset:16640
    buffer_load_dwordx4 v7, s[8:11], s30 offen lds
    v_exp_f32 v48, v48
    v_mfma_f32_32x32x16_bf16 a[80:95], a[12:15], v[104:107], a[80:95]
    s_waitcnt lgkmcnt(6)
    ds_read_b64_tr_b16 a[0:1], v4 offset:15400
    ds_read_b64_tr_b16 a[2:3], v4 offset:16680
    v_exp_f32 v49, v49
    v_fma_f32 v48, v48, v12, v12
    v_fma_f32 v49, v49, v12, v12
    v_mfma_f32_32x32x16_bf16 a[96:111], a[16:19], v[104:107], a[96:111]
    s_waitcnt lgkmcnt(6)
    ds_read_b64_tr_b16 a[4:5], v4 offset:15440
    ds_read_b64_tr_b16 a[6:7], v4 offset:16720
    v_rcp_f32 v48, v48
    v_rcp_f32 v49, v49
    v_mfma_f32_32x32x16_bf16 a[112:127], a[20:23], v[104:107], a[112:127]
    s_waitcnt lgkmcnt(6)
    s_add_u32 m0, m0, 1024
    s_add_u32 s30, s40, 1474560
    ds_read_b64_tr_b16 a[8:9], v4 offset:15480
    ds_read_b64_tr_b16 a[10:11], v4 offset:16760
    buffer_load_dwordx4 v8, s[8:11], s30 offen lds
    v_mul_f32 v34, v34, v48
    v_mul_f32 v35, v35, v49
    v_mfma_f32_32x32x16_bf16 a[128:143], a[24:27], v[104:107], a[128:143]
    s_waitcnt lgkmcnt(6)
    ds_read_b64_tr_b16 a[12:13], v5 offset:15360
    ds_read_b64_tr_b16 a[14:15], v5 offset:16640
    v_mul_f32 v48, v36, v36
    v_mul_f32 v49, v37, v37
    v_fma_f32 v48, v48, v15, v14
    v_fma_f32 v49, v49, v15, v14
    v_mfma_f32_32x32x16_bf16 a[64:79], a[28:31], v[108:111], a[64:79]
    s_waitcnt lgkmcnt(6)
    ds_read_b64_tr_b16 a[16:17], v4 offset:20480
    ds_read_b64_tr_b16 a[18:19], v4 offset:21760
    v_mul_f32 v48, v48, v36
    v_mul_f32 v49, v49, v37
    v_exp_f32 v48, v48
    v_mfma_f32_32x32x16_bf16 a[80:95], a[0:3], v[108:111], a[80:95]
    s_waitcnt lgkmcnt(6)
    s_add_u32 m0, m0, 1024
    s_add_u32 s30, s40, 1474560
    ds_read_b64_tr_b16 a[20:21], v4 offset:20520
    ds_read_b64_tr_b16 a[22:23], v4 offset:21800
    buffer_load_dwordx4 v9, s[8:11], s30 offen lds
    v_exp_f32 v49, v49
    v_mfma_f32_32x32x16_bf16 a[96:111], a[4:7], v[108:111], a[96:111]
    s_waitcnt lgkmcnt(6)
    ds_read_b64_tr_b16 a[24:25], v4 offset:20560
    ds_read_b64_tr_b16 a[26:27], v4 offset:21840
    v_fma_f32 v48, v48, v12, v12
    v_fma_f32 v49, v49, v12, v12
    v_rcp_f32 v48, v48
    v_mfma_f32_32x32x16_bf16 a[112:127], a[8:11], v[108:111], a[112:127]
    s_waitcnt lgkmcnt(6)
    ds_read_b64_tr_b16 a[28:29], v4 offset:20600
    ds_read_b64_tr_b16 a[30:31], v4 offset:21880
    v_rcp_f32 v49, v49
    v_mul_f32 v36, v36, v48
    v_mul_f32 v37, v37, v49
    v_mfma_f32_32x32x16_bf16 a[128:143], a[12:15], v[108:111], a[128:143]
    s_waitcnt lgkmcnt(6)
    s_add_u32 m0, m0, 1024
    s_add_u32 s30, s40, 1474560
    ds_read_b64_tr_b16 a[0:1], v5 offset:20480
    ds_read_b64_tr_b16 a[2:3], v5 offset:21760
    buffer_load_dwordx4 v10, s[8:11], s30 offen lds
    v_mul_f32 v48, v38, v38
    v_mul_f32 v49, v39, v39
    v_mfma_f32_32x32x16_bf16 a[64:79], a[16:19], v[112:115], a[64:79]
    s_waitcnt lgkmcnt(6)
    ds_read_b64_tr_b16 a[4:5], v4 offset:25600
    ds_read_b64_tr_b16 a[6:7], v4 offset:26880
    v_fma_f32 v48, v48, v15, v14
    v_fma_f32 v49, v49, v15, v14
    v_mul_f32 v48, v48, v38
    v_mul_f32 v49, v49, v39
    v_mfma_f32_32x32x16_bf16 a[80:95], a[20:23], v[112:115], a[80:95]
    s_waitcnt lgkmcnt(6)
    ds_read_b64_tr_b16 a[8:9], v4 offset:25640
    ds_read_b64_tr_b16 a[10:11], v4 offset:26920
    v_exp_f32 v48, v48
    v_exp_f32 v49, v49
    v_mfma_f32_32x32x16_bf16 a[96:111], a[24:27], v[112:115], a[96:111]
    s_waitcnt lgkmcnt(6)
    s_add_u32 m0, m0, 1024
    s_add_u32 s30, s40, 1536000
    ds_read_b64_tr_b16 a[12:13], v4 offset:25680
    ds_read_b64_tr_b16 a[14:15], v4 offset:26960
    buffer_load_dwordx4 v6, s[8:11], s30 offen lds
    v_fma_f32 v48, v48, v12, v12
    v_fma_f32 v49, v49, v12, v12
    v_mfma_f32_32x32x16_bf16 a[112:127], a[28:31], v[112:115], a[112:127]
    s_waitcnt lgkmcnt(6)
    ds_read_b64_tr_b16 a[16:17], v4 offset:25720
    ds_read_b64_tr_b16 a[18:19], v4 offset:27000
    v_rcp_f32 v48, v48
    v_rcp_f32 v49, v49
    v_mfma_f32_32x32x16_bf16 a[128:143], a[0:3], v[112:115], a[128:143]
    s_waitcnt lgkmcnt(6)
    ds_read_b64_tr_b16 a[20:21], v5 offset:25600
    ds_read_b64_tr_b16 a[22:23], v5 offset:26880
    v_mul_f32 v38, v38, v48
    v_mul_f32 v39, v39, v49
    v_mul_f32 v48, v40, v40
    v_mul_f32 v49, v41, v41
    v_mfma_f32_32x32x16_bf16 a[64:79], a[4:7], v[116:119], a[64:79]
    s_waitcnt lgkmcnt(6)
    s_add_u32 m0, m0, 1024
    s_add_u32 s30, s40, 1536000
    ds_read_b64_tr_b16 a[24:25], v4 offset:30720
    ds_read_b64_tr_b16 a[26:27], v4 offset:32000
    buffer_load_dwordx4 v7, s[8:11], s30 offen lds
    v_fma_f32 v48, v48, v15, v14
    v_fma_f32 v49, v49, v15, v14
    v_mfma_f32_32x32x16_bf16 a[80:95], a[8:11], v[116:119], a[80:95]
    s_waitcnt lgkmcnt(6)
    ds_read_b64_tr_b16 a[28:29], v4 offset:30760
    ds_read_b64_tr_b16 a[30:31], v4 offset:32040
    v_mul_f32 v48, v48, v40
    v_mul_f32 v49, v49, v41
    v_exp_f32 v48, v48
    v_mfma_f32_32x32x16_bf16 a[96:111], a[12:15], v[116:119], a[96:111]
    s_waitcnt lgkmcnt(6)
    ds_read_b64_tr_b16 a[0:1], v4 offset:30800
    ds_read_b64_tr_b16 a[2:3], v4 offset:32080
    v_exp_f32 v49, v49
    v_fma_f32 v48, v48, v12, v12
    v_fma_f32 v49, v49, v12, v12
    v_mfma_f32_32x32x16_bf16 a[112:127], a[16:19], v[116:119], a[112:127]
    s_waitcnt lgkmcnt(6)
    s_add_u32 m0, m0, 1024
    s_add_u32 s30, s40, 1536000
    ds_read_b64_tr_b16 a[4:5], v4 offset:30840
    ds_read_b64_tr_b16 a[6:7], v4 offset:32120
    buffer_load_dwordx4 v8, s[8:11], s30 offen lds
    v_rcp_f32 v48, v48
    v_mfma_f32_32x32x16_bf16 a[128:143], a[20:23], v[116:119], a[128:143]
    s_waitcnt lgkmcnt(6)
    ds_read_b64_tr_b16 a[8:9], v5 offset:30720
    ds_read_b64_tr_b16 a[10:11], v5 offset:32000
    v_rcp_f32 v49, v49
    v_mul_f32 v40, v40, v48
    v_mul_f32 v41, v41, v49
    v_mfma_f32_32x32x16_bf16 a[64:79], a[24:27], v[120:123], a[64:79]
    s_waitcnt lgkmcnt(6)
    ds_read_b64_tr_b16 a[12:13], v4 offset:35840
    ds_read_b64_tr_b16 a[14:15], v4 offset:37120
    v_mul_f32 v48, v42, v42
    v_mul_f32 v49, v43, v43
    v_fma_f32 v48, v48, v15, v14
    v_fma_f32 v49, v49, v15, v14
    v_mfma_f32_32x32x16_bf16 a[80:95], a[28:31], v[120:123], a[80:95]
    s_waitcnt lgkmcnt(6)
    s_add_u32 m0, m0, 1024
    s_add_u32 s30, s40, 1536000
    ds_read_b64_tr_b16 a[16:17], v4 offset:35880
    ds_read_b64_tr_b16 a[18:19], v4 offset:37160
    buffer_load_dwordx4 v9, s[8:11], s30 offen lds
    v_mul_f32 v48, v48, v42
    v_mul_f32 v49, v49, v43
    v_mfma_f32_32x32x16_bf16 a[96:111], a[0:3], v[120:123], a[96:111]
    s_waitcnt lgkmcnt(6)
    ds_read_b64_tr_b16 a[20:21], v4 offset:35920
    ds_read_b64_tr_b16 a[22:23], v4 offset:37200
    v_exp_f32 v48, v48
    v_exp_f32 v49, v49
    v_mfma_f32_32x32x16_bf16 a[112:127], a[4:7], v[120:123], a[112:127]
    s_waitcnt lgkmcnt(6)
    ds_read_b64_tr_b16 a[24:25], v4 offset:35960
    ds_read_b64_tr_b16 a[26:27], v4 offset:37240
    v_fma_f32 v48, v48, v12, v12
    v_fma_f32 v49, v49, v12, v12
    v_rcp_f32 v48, v48
    v_mfma_f32_32x32x16_bf16 a[128:143], a[8:11], v[120:123], a[128:143]
    s_waitcnt lgkmcnt(6)
    s_add_u32 m0, m0, 1024
    s_add_u32 s30, s40, 1536000
    ds_read_b64_tr_b16 a[28:29], v5 offset:35840
    ds_read_b64_tr_b16 a[30:31], v5 offset:37120
    buffer_load_dwordx4 v10, s[8:11], s30 offen lds
    v_rcp_f32 v49, v49
    v_mfma_f32_32x32x16_bf16 a[64:79], a[12:15], v[124:127], a[64:79]
    s_waitcnt vmcnt(20) lgkmcnt(6)
    s_barrier
    v_add_u32 v4, 40960, v4
    v_add_u32 v5, 40960, v5
    ds_read_b64_tr_b16 a[0:1], v4 offset:0
    ds_read_b64_tr_b16 a[2:3], v4 offset:1280
    v_mul_f32 v42, v42, v48
    v_mul_f32 v43, v43, v49
    v_mul_f32 v48, v44, v44
    v_mul_f32 v49, v45, v45
    v_mfma_f32_32x32x16_bf16 a[80:95], a[16:19], v[124:127], a[80:95]
    s_waitcnt lgkmcnt(6)
    ds_read_b64_tr_b16 a[4:5], v4 offset:40
    ds_read_b64_tr_b16 a[6:7], v4 offset:1320
    v_fma_f32 v48, v48, v15, v14
    v_fma_f32 v49, v49, v15, v14
    v_mul_f32 v48, v48, v44
    v_mul_f32 v49, v49, v45
    v_mfma_f32_32x32x16_bf16 a[96:111], a[20:23], v[124:127], a[96:111]
    s_waitcnt lgkmcnt(6)
    ds_read_b64_tr_b16 a[8:9], v4 offset:80
    ds_read_b64_tr_b16 a[10:11], v4 offset:1360
    v_exp_f32 v48, v48
    v_exp_f32 v49, v49
    v_mfma_f32_32x32x16_bf16 a[112:127], a[24:27], v[124:127], a[112:127]
    s_waitcnt lgkmcnt(6)
    ds_read_b64_tr_b16 a[12:13], v4 offset:120
    ds_read_b64_tr_b16 a[14:15], v4 offset:1400
    v_fma_f32 v48, v48, v12, v12
    v_fma_f32 v49, v49, v12, v12
    v_rcp_f32 v48, v48
    v_mfma_f32_32x32x16_bf16 a[128:143], a[28:31], v[124:127], a[128:143]
    s_waitcnt lgkmcnt(6)
    ds_read_b64_tr_b16 a[16:17], v5 offset:0
    ds_read_b64_tr_b16 a[18:19], v5 offset:1280
    v_rcp_f32 v49, v49
    v_mul_f32 v44, v44, v48
    v_mul_f32 v45, v45, v49
    v_mfma_f32_32x32x16_bf16 a[64:79], a[0:3], v[128:131], a[64:79]
    s_waitcnt lgkmcnt(6)
    ds_read_b64_tr_b16 a[20:21], v4 offset:5120
    ds_read_b64_tr_b16 a[22:23], v4 offset:6400
    v_mul_f32 v48, v46, v46
    v_mul_f32 v49, v47, v47
    v_fma_f32 v48, v48, v15, v14
    v_fma_f32 v49, v49, v15, v14
    v_mfma_f32_32x32x16_bf16 a[80:95], a[4:7], v[128:131], a[80:95]
    s_waitcnt lgkmcnt(6)
    s_add_u32 m0, s27, 81920
    s_add_u32 s30, s40, 1966080
    ds_read_b64_tr_b16 a[24:25], v4 offset:5160
    ds_read_b64_tr_b16 a[26:27], v4 offset:6440
    buffer_load_dwordx4 v6, s[8:11], s30 offen lds
    v_mul_f32 v48, v48, v46
    v_mul_f32 v49, v49, v47
    v_mfma_f32_32x32x16_bf16 a[96:111], a[8:11], v[128:131], a[96:111]
    s_waitcnt lgkmcnt(6)
    ds_read_b64_tr_b16 a[28:29], v4 offset:5200
    ds_read_b64_tr_b16 a[30:31], v4 offset:6480
    v_exp_f32 v48, v48
    v_exp_f32 v49, v49
    v_mfma_f32_32x32x16_bf16 a[112:127], a[12:15], v[128:131], a[112:127]
    s_waitcnt lgkmcnt(6)
    ds_read_b64_tr_b16 a[0:1], v4 offset:5240
    ds_read_b64_tr_b16 a[2:3], v4 offset:6520
    v_fma_f32 v48, v48, v12, v12
    v_fma_f32 v49, v49, v12, v12
    v_rcp_f32 v48, v48
    v_mfma_f32_32x32x16_bf16 a[128:143], a[16:19], v[128:131], a[128:143]
    s_waitcnt lgkmcnt(6)
    s_add_u32 m0, m0, 1024
    s_add_u32 s30, s40, 1966080
    ds_read_b64_tr_b16 a[4:5], v5 offset:5120
    ds_read_b64_tr_b16 a[6:7], v5 offset:6400
    buffer_load_dwordx4 v7, s[8:11], s30 offen lds
    v_rcp_f32 v49, v49
    v_mfma_f32_32x32x16_bf16 a[64:79], a[20:23], v[132:135], a[64:79]
    s_waitcnt lgkmcnt(6)
    ds_read_b64_tr_b16 a[8:9], v4 offset:10240
    ds_read_b64_tr_b16 a[10:11], v4 offset:11520
    v_mul_f32 v46, v46, v48
    v_mul_f32 v47, v47, v49
    v_mov_b32 v50, v16
    v_mul_f32 v51, v16, v16
    v_mfma_f32_32x32x16_bf16 a[80:95], a[24:27], v[132:135], a[80:95]
    s_waitcnt lgkmcnt(6)
    ds_read_b64_tr_b16 a[12:13], v4 offset:10280
    ds_read_b64_tr_b16 a[14:15], v4 offset:11560
    v_add_f32 v50, v50, v17
    v_fma_f32 v51, v17, v17, v51
    v_add_f32 v50, v50, v18
    v_fma_f32 v51, v18, v18, v51
    v_mfma_f32_32x32x16_bf16 a[96:111], a[28:31], v[132:135], a[96:111]
    s_waitcnt lgkmcnt(6)
    s_add_u32 m0, m0, 1024
    s_add_u32 s30, s40, 1966080
    ds_read_b64_tr_b16 a[16:17], v4 offset:10320
    ds_read_b64_tr_b16 a[18:19], v4 offset:11600
    buffer_load_dwordx4 v8, s[8:11], s30 offen lds
    v_add_f32 v50, v50, v19
    v_fma_f32 v51, v19, v19, v51
    v_mfma_f32_32x32x16_bf16 a[112:127], a[0:3], v[132:135], a[112:127]
    s_waitcnt lgkmcnt(6)
    ds_read_b64_tr_b16 a[20:21], v4 offset:10360
    ds_read_b64_tr_b16 a[22:23], v4 offset:11640
    v_add_f32 v50, v50, v20
    v_fma_f32 v51, v20, v20, v51
    v_add_f32 v50, v50, v21
    v_fma_f32 v51, v21, v21, v51
    v_mfma_f32_32x32x16_bf16 a[128:143], a[4:7], v[132:135], a[128:143]
    s_waitcnt lgkmcnt(6)
    ds_read_b64_tr_b16 a[24:25], v5 offset:10240
    ds_read_b64_tr_b16 a[26:27], v5 offset:11520
    v_add_f32 v50, v50, v22
    v_fma_f32 v51, v22, v22, v51
    v_add_f32 v50, v50, v23
    v_fma_f32 v51, v23, v23, v51
    v_mfma_f32_32x32x16_bf16 a[64:79], a[8:11], v[136:139], a[64:79]
    s_waitcnt lgkmcnt(6)
    s_add_u32 m0, m0, 1024
    s_add_u32 s30, s40, 1966080
    ds_read_b64_tr_b16 a[28:29], v4 offset:15360
    ds_read_b64_tr_b16 a[30:31], v4 offset:16640
    buffer_load_dwordx4 v9, s[8:11], s30 offen lds
    v_add_f32 v50, v50, v24
    v_fma_f32 v51, v24, v24, v51
    v_mfma_f32_32x32x16_bf16 a[80:95], a[12:15], v[136:139], a[80:95]
    s_waitcnt lgkmcnt(6)
    ds_read_b64_tr_b16 a[0:1], v4 offset:15400
    ds_read_b64_tr_b16 a[2:3], v4 offset:16680
    v_add_f32 v50, v50, v25
    v_fma_f32 v51, v25, v25, v51
    v_add_f32 v50, v50, v26
    v_fma_f32 v51, v26, v26, v51
    v_mfma_f32_32x32x16_bf16 a[96:111], a[16:19], v[136:139], a[96:111]
    s_waitcnt lgkmcnt(6)
    ds_read_b64_tr_b16 a[4:5], v4 offset:15440
    ds_read_b64_tr_b16 a[6:7], v4 offset:16720
    v_add_f32 v50, v50, v27
    v_fma_f32 v51, v27, v27, v51
    v_add_f32 v50, v50, v28
    v_fma_f32 v51, v28, v28, v51
    v_mfma_f32_32x32x16_bf16 a[112:127], a[20:23], v[136:139], a[112:127]
    s_waitcnt lgkmcnt(6)
    s_add_u32 m0, m0, 1024
    s_add_u32 s30, s40, 1966080
    ds_read_b64_tr_b16 a[8:9], v4 offset:15480
    ds_read_b64_tr_b16 a[10:11], v4 offset:16760
    buffer_load_dwordx4 v10, s[8:11], s30 offen lds
    v_add_f32 v50, v50, v29
    v_fma_f32 v51, v29, v29, v51
    v_mfma_f32_32x32x16_bf16 a[128:143], a[24:27], v[136:139], a[128:143]
    s_waitcnt lgkmcnt(6)
    ds_read_b64_tr_b16 a[12:13], v5 offset:15360
    ds_read_b64_tr_b16 a[14:15], v5 offset:16640
    v_add_f32 v50, v50, v30
    v_fma_f32 v51, v30, v30, v51
    v_add_f32 v50, v50, v31
    v_fma_f32 v51, v31, v31, v51
    v_mfma_f32_32x32x16_bf16 a[64:79], a[28:31], v[140:143], a[64:79]
    s_waitcnt lgkmcnt(6)
    ds_read_b64_tr_b16 a[16:17], v4 offset:20480
    ds_read_b64_tr_b16 a[18:19], v4 offset:21760
    v_add_f32 v50, v50, v32
    v_fma_f32 v51, v32, v32, v51
    v_add_f32 v50, v50, v33
    v_fma_f32 v51, v33, v33, v51
    v_mfma_f32_32x32x16_bf16 a[80:95], a[0:3], v[140:143], a[80:95]
    s_waitcnt lgkmcnt(6)
    s_add_u32 m0, m0, 1024
    s_add_u32 s30, s40, 2027520
    ds_read_b64_tr_b16 a[20:21], v4 offset:20520
    ds_read_b64_tr_b16 a[22:23], v4 offset:21800
    buffer_load_dwordx4 v6, s[8:11], s30 offen lds
    v_add_f32 v50, v50, v34
    v_fma_f32 v51, v34, v34, v51
    v_mfma_f32_32x32x16_bf16 a[96:111], a[4:7], v[140:143], a[96:111]
    s_waitcnt lgkmcnt(6)
    ds_read_b64_tr_b16 a[24:25], v4 offset:20560
    ds_read_b64_tr_b16 a[26:27], v4 offset:21840
    v_add_f32 v50, v50, v35
    v_fma_f32 v51, v35, v35, v51
    v_add_f32 v50, v50, v36
    v_fma_f32 v51, v36, v36, v51
    v_mfma_f32_32x32x16_bf16 a[112:127], a[8:11], v[140:143], a[112:127]
    s_waitcnt lgkmcnt(6)
    ds_read_b64_tr_b16 a[28:29], v4 offset:20600
    ds_read_b64_tr_b16 a[30:31], v4 offset:21880
    v_add_f32 v50, v50, v37
    v_fma_f32 v51, v37, v37, v51
    v_add_f32 v50, v50, v38
    v_fma_f32 v51, v38, v38, v51
    v_mfma_f32_32x32x16_bf16 a[128:143], a[12:15], v[140:143], a[128:143]
    s_waitcnt lgkmcnt(6)
    s_add_u32 m0, m0, 1024
    s_add_u32 s30, s40, 2027520
    ds_read_b64_tr_b16 a[0:1], v5 offset:20480
    ds_read_b64_tr_b16 a[2:3], v5 offset:21760
    buffer_load_dwordx4 v7, s[8:11], s30 offen lds
    v_add_f32 v50, v50, v39
    v_fma_f32 v51, v39, v39, v51
    v_mfma_f32_32x32x16_bf16 a[64:79], a[16:19], v[144:147], a[64:79]
    s_waitcnt lgkmcnt(6)
    ds_read_b64_tr_b16 a[4:5], v4 offset:25600
    ds_read_b64_tr_b16 a[6:7], v4 offset:26880
    v_add_f32 v50, v50, v40
    v_fma_f32 v51, v40, v40, v51
    v_add_f32 v50, v50, v41
    v_fma_f32 v51, v41, v41, v51
    v_mfma_f32_32x32x16_bf16 a[80:95], a[20:23], v[144:147], a[80:95]
    s_waitcnt lgkmcnt(6)
    ds_read_b64_tr_b16 a[8:9], v4 offset:25640
    ds_read_b64_tr_b16 a[10:11], v4 offset:26920
    v_add_f32 v50, v50, v42
    v_fma_f32 v51, v42, v42, v51
    v_add_f32 v50, v50, v43
    v_fma_f32 v51, v43, v43, v51
    v_mfma_f32_32x32x16_bf16 a[96:111], a[24:27], v[144:147], a[96:111]
    s_waitcnt lgkmcnt(6)
    s_add_u32 m0, m0, 1024
    s_add_u32 s30, s40, 2027520
    ds_read_b64_tr_b16 a[12:13], v4 offset:25680
    ds_read_b64_tr_b16 a[14:15], v4 offset:26960
    buffer_load_dwordx4 v8, s[8:11], s30 offen lds
    v_add_f32 v50, v50, v44
    v_fma_f32 v51, v44, v44, v51
    v_mfma_f32_32x32x16_bf16 a[112:127], a[28:31], v[144:147], a[112:127]
    s_waitcnt lgkmcnt(6)
    ds_read_b64_tr_b16 a[16:17], v4 offset:25720
    ds_read_b64_tr_b16 a[18:19], v4 offset:27000
    v_add_f32 v50, v50, v45
    v_fma_f32 v51, v45, v45, v51
    v_add_f32 v50, v50, v46
    v_fma_f32 v51, v46, v46, v51
    v_mfma_f32_32x32x16_bf16 a[128:143], a[0:3], v[144:147], a[128:143]
    s_waitcnt lgkmcnt(6)
    ds_read_b64_tr_b16 a[20:21], v5 offset:25600
    ds_read_b64_tr_b16 a[22:23], v5 offset:26880
    v_add_f32 v50, v50, v47
    v_fma_f32 v51, v47, v47, v51
    v_mov_b32 v52, v50
    v_mov_b32 v53, v51
    v_mfma_f32_32x32x16_bf16 a[64:79], a[4:7], v[148:151], a[64:79]
    s_waitcnt lgkmcnt(6)
    s_add_u32 m0, m0, 1024
    s_add_u32 s30, s40, 2027520
    ds_read_b64_tr_b16 a[24:25], v4 offset:30720
    ds_read_b64_tr_b16 a[26:27], v4 offset:32000
    buffer_load_dwordx4 v9, s[8:11], s30 offen lds
    v_and_b32 v54, 0x1ff, v1
    v_mfma_f32_32x32x16_bf16 a[80:95], a[8:11], v[148:151], a[80:95]
    s_waitcnt lgkmcnt(6)
    ds_read_b64_tr_b16 a[28:29], v4 offset:30760
    ds_read_b64_tr_b16 a[30:31], v4 offset:32040
    v_readfirstlane_b32 s48, v92
    s_cmp_lg_u32 s48, 0
    s_cbranch_scc0 k1_na_sp
k1_na_bk:
    v_permlane32_swap_b32 v50, v52
    v_permlane32_swap_b32 v51, v53
    v_mfma_f32_32x32x16_bf16 a[96:111], a[12:15], v[148:151], a[96:111]
    s_waitcnt lgkmcnt(6)
    ds_read_b64_tr_b16 a[0:1], v4 offset:30800
    ds_read_b64_tr_b16 a[2:3], v4 offset:32080
    s_lshl_b32 s28, s37, 11
    s_add_u32 s28, s28, s47
    s_not_b32 s49, s48
    v_add_f32 v50, v50, v52
    v_mfma_f32_32x32x16_bf16 a[112:127], a[16:19], v[148:151], a[112:127]
    s_waitcnt lgkmcnt(6)
    s_add_u32 m0, m0, 1024
    s_add_u32 s30, s40, 2027520
    ds_read_b64_tr_b16 a[4:5], v4 offset:30840
    ds_read_b64_tr_b16 a[6:7], v4 offset:32120
    buffer_load_dwordx4 v10, s[8:11], s30 offen lds
    v_add_f32 v51, v51, v53
    v_mov_b32 v52, s48
    v_mfma_f32_32x32x16_bf16 a[128:143], a[20:23], v[148:151], a[128:143]
    s_waitcnt lgkmcnt(6)
    ds_read_b64_tr_b16 a[8:9], v5 offset:30720
    ds_read_b64_tr_b16 a[10:11], v5 offset:32000
    v_mov_b32 v53, s49
    buffer_store_dwordx4 v[50:53], v54, s[16:19], s28 offen sc1
    v_mfma_f32_32x32x16_bf16 a[64:79], a[24:27], v[152:155], a[64:79]
    s_waitcnt lgkmcnt(6)
    ds_read_b64_tr_b16 a[12:13], v4 offset:35840
    ds_read_b64_tr_b16 a[14:15], v4 offset:37120
    v_mfma_f32_32x32x16_bf16 a[80:95], a[28:31], v[152:155], a[80:95]
    s_waitcnt lgkmcnt(6)
    ds_read_b64_tr_b16 a[16:17], v4 offset:35880
    ds_read_b64_tr_b16 a[18:19], v4 offset:37160
    v_mfma_f32_32x32x16_bf16 a[96:111], a[0:3], v[152:155], a[96:111]
    s_waitcnt lgkmcnt(6)
    ds_read_b64_tr_b16 a[20:21], v4 offset:35920
    ds_read_b64_tr_b16 a[22:23], v4 offset:37200
    v_mfma_f32_32x32x16_bf16 a[112:127], a[4:7], v[152:155], a[112:127]
    s_waitcnt lgkmcnt(6)
    ds_read_b64_tr_b16 a[24:25], v4 offset:35960
    ds_read_b64_tr_b16 a[26:27], v4 offset:37240
    v_mfma_f32_32x32x16_bf16 a[128:143], a[8:11], v[152:155], a[128:143]
    s_waitcnt lgkmcnt(6)
    ds_read_b64_tr_b16 a[28:29], v5 offset:35840
    ds_read_b64_tr_b16 a[30:31], v5 offset:37120
    v_mfma_f32_32x32x16_bf16 a[64:79], a[12:15], v[156:159], a[64:79]
    s_waitcnt vmcnt(20) lgkmcnt(6)
    s_barrier
    v_add_u32 v4, -122880, v4
    v_add_u32 v5, -122880, v5
    v_lshrrev_b32 v61, 2, v0
    v_mul_u32_u24 v61, 3584, v61
    v_add_u32 v61, v61, v93
    s_mul_i32 s28, s51, 12288
    s_bfm_b64 exec, 12, 0
    buffer_load_dword v94, v61, s[52:55], s28 offen
    s_mov_b64 exec, -1
    s_mul_i32 s50, s24, 192
    s_add_u32 s50, s50, s2
    s_cmp_ge_u32 s50, 470
    s_cbranch_scc1 k1_nou
    s_cmp_lt_u32 s50, 200
    s_cselect_b64 s[52:53], s[56:57], s[58:59]
    s_cselect_b32 s54, 20, 27
    s_mul_i32 s54, s54, 40960
    v_lshrrev_b32 v60, 5, v0
    s_mul_i32 s28, s50, 6554
    s_lshr_b32 s28, s28, 16
    s_mul_i32 s29, s28, 10
    s_sub_u32 s29, s50, s29
    s_mul_i32 s60, s28, 40
    s_mov_b32 s61, 4
    s_mov_b32 s62, 20
    s_mov_b32 s63, 8
    s_cmp_lt_u32 s28, 16
    s_cbranch_scc1 k1_u
    s_lshl_b32 s60, s28, 5
    s_sub_u32 s60, s60, 640
    s_mov_b32 s62, 16
    s_cmp_ge_u32 s28, 20
    s_cbranch_scc1 k1_u
    s_mul_i32 s60, s28, 160
    s_sub_u32 s60, s60, 2544
    s_mov_b32 s61, 40
    s_mov_b32 s62, 80
    s_mov_b32 s63, 20
k1_u:
    s_mul_i32 s60, s60, 1280
    s_mul_i32 s61, s61, 1280
    s_mul_i32 s62, s62, 1280
    s_lshl_b32 s29, s29, 7
    s_add_u32 s60, s60, s29
    v_mul_u32_u24 v61, s63, v60
    v_bfe_u32 v62, v0, 3, 2
    v_add_u32 v61, v61, v62
    v_mul_u32_u24 v61, 1280, v61
    v_and_b32 v62, 7, v0
    v_lshl_add_u32 v61, v62, 4, v61
    s_add_u32 m0, s27, 122880
    s_add_u32 s64, s60, s61
    buffer_load_dwordx4 v61, s[52:55], s60 offen lds
    s_add_u32 m0, m0, 1024
    s_add_u32 s60, s60, s62
    buffer_load_dwordx4 v61, s[52:55], s64 offen lds
    s_add_u32 m0, m0, 1024
    s_add_u32 s64, s60, s61
    buffer_load_dwordx4 v61, s[52:55], s60 offen lds
    s_add_u32 m0, m0, 1024
    s_nop 0
    buffer_load_dwordx4 v61, s[52:55], s64 offen lds
k1_nou:
    ds_read_b64_tr_b16 a[0:1], v4 offset:0
    ds_read_b64_tr_b16 a[2:3], v4 offset:1280
    v_mfma_f32_32x32x16_bf16 a[80:95], a[16:19], v[156:159], a[80:95]
    s_waitcnt lgkmcnt(6)
    ds_read_b64_tr_b16 a[4:5], v4 offset:40
    ds_read_b64_tr_b16 a[6:7], v4 offset:1320
    v_mfma_f32_32x32x16_bf16 a[96:111], a[20:23], v[156:159], a[96:111]
    s_waitcnt lgkmcnt(6)
    ds_read_b64_tr_b16 a[8:9], v4 offset:80
    ds_read_b64_tr_b16 a[10:11], v4 offset:1360
    v_mfma_f32_32x32x16_bf16 a[112:127], a[24:27], v[156:159], a[112:127]
    s_waitcnt lgkmcnt(6)
    ds_read_b64_tr_b16 a[12:13], v4 offset:120
    ds_read_b64_tr_b16 a[14:15], v4 offset:1400
    v_mfma_f32_32x32x16_bf16 a[128:143], a[28:31], v[156:159], a[128:143]
    s_waitcnt lgkmcnt(6)
    ds_read_b64_tr_b16 a[16:17], v5 offset:0
    ds_read_b64_tr_b16 a[18:19], v5 offset:1280
    v_mfma_f32_32x32x16_bf16 a[64:79], a[0:3], v[160:163], a[64:79]
    s_waitcnt lgkmcnt(6)
    ds_read_b64_tr_b16 a[20:21], v4 offset:5120
    ds_read_b64_tr_b16 a[22:23], v4 offset:6400
    s_lshr_b32 s41, s26, 2
    s_cmp_eq_u32 s41, 0
    s_cselect_b32 s44, 0x3ea52b5c, 1.0
    s_mov_b32 s40, 0
    v_mfma_f32_32x32x16_bf16 a[80:95], a[4:7], v[160:163], a[80:95]
    s_waitcnt lgkmcnt(6)
    ds_read_b64_tr_b16 a[24:25], v4 offset:5160
    ds_read_b64_tr_b16 a[26:27], v4 offset:6440
    s_and_b32 s28, s26, 3
    s_mul_i32 s28, s28, 1703936
    s_add_u32 s40, s40, s28
    v_mfma_f32_32x32x16_bf16 a[96:111], a[8:11], v[160:163], a[96:111]
    s_waitcnt lgkmcnt(6)
    ds_read_b64_tr_b16 a[28:29], v4 offset:5200
    ds_read_b64_tr_b16 a[30:31], v4 offset:6480
    s_lshr_b32 s28, s32, 1
    s_mul_i32 s28, s28, 6656
    s_add_u32 s40, s40, s28
    v_mfma_f32_32x32x16_bf16 a[112:127], a[12:15], v[160:163], a[112:127]
    s_waitcnt lgkmcnt(6)
    ds_read_b64_tr_b16 a[0:1], v4 offset:5240
    ds_read_b64_tr_b16 a[2:3], v4 offset:6520
    s_and_b32 s38, s24, 1
    s_lshl_b32 s39, s50, 12
    s_add_u32 s39, s39, 29360128
    v_mul_f32 v63, s44, v13
    v_add_u32 v6, 81920, v4
    v_add_u32 v7, 81920, v5
    v_mfma_f32_32x32x16_bf16 a[128:143], a[16:19], v[160:163], a[128:143]
    s_waitcnt lgkmcnt(6)
    ds_read_b64_tr_b16 a[4:5], v5 offset:5120
    ds_read_b64_tr_b16 a[6:7], v5 offset:6400
    v_lshrrev_b32 v60, 4, v0
    v_bfe_u32 v61, v0, 2, 2
    v_lshl_add_u32 v60, v60, 3, v61
    v_and_b32 v61, 3, v0
    v_mfma_f32_32x32x16_bf16 a[64:79], a[20:23], v[164:167], a[64:79]
    s_waitcnt lgkmcnt(6)
    ds_read_b64_tr_b16 a[8:9], v4 offset:10240
    ds_read_b64_tr_b16 a[10:11], v4 offset:11520
    v_lshlrev_b32 v61, 3, v61
    v_lshl_add_u32 v60, v60, 7, v61
    s_add_u32 s28, s27, 122880
    v_add_u32 v62, s28, v60
    v_mfma_f32_32x32x16_bf16 a[80:95], a[24:27], v[164:167], a[80:95]
    s_waitcnt lgkmcnt(6)
    ds_read_b64_tr_b16 a[12:13], v4 offset:10280
    ds_read_b64_tr_b16 a[14:15], v4 offset:11560
    v_and_b32 v60, 31, v0
    v_lshrrev_b32 v61, 5, v0
    v_mfma_f32_32x32x16_bf16 a[96:111], a[28:31], v[164:167], a[96:111]
    s_waitcnt lgkmcnt(6)
    ds_read_b64_tr_b16 a[16:17], v4 offset:10320
    ds_read_b64_tr_b16 a[18:19], v4 offset:11600
    v_mfma_f32_32x32x16_bf16 a[112:127], a[0:3], v[164:167], a[112:127]
    s_waitcnt lgkmcnt(6)
    ds_read_b64_tr_b16 a[20:21], v4 offset:10360
    ds_read_b64_tr_b16 a[22:23], v4 offset:11640
    v_mfma_f32_32x32x16_bf16 a[128:143], a[4:7], v[164:167], a[128:143]
    s_waitcnt lgkmcnt(6)
    ds_read_b64_tr_b16 a[24:25], v5 offset:10240
    ds_read_b64_tr_b16 a[26:27], v5 offset:11520
    v_mfma_f32_32x32x16_bf16 a[64:79], a[8:11], v[168:171], a[64:79]
    s_waitcnt lgkmcnt(6)
    ds_read_b64_tr_b16 a[28:29], v4 offset:15360
    ds_read_b64_tr_b16 a[30:31], v4 offset:16640
    v_mfma_f32_32x32x16_bf16 a[80:95], a[12:15], v[168:171], a[80:95]
    s_waitcnt lgkmcnt(6)
    ds_read_b64_tr_b16 a[0:1], v4 offset:15400
    ds_read_b64_tr_b16 a[2:3], v4 offset:16680
    v_mfma_f32_32x32x16_bf16 a[96:111], a[16:19], v[168:171], a[96:111]
    s_waitcnt lgkmcnt(6)
    ds_read_b64_tr_b16 a[4:5], v4 offset:15440
    ds_read_b64_tr_b16 a[6:7], v4 offset:16720
    v_mfma_f32_32x32x16_bf16 a[112:127], a[20:23], v[168:171], a[112:127]
    s_waitcnt lgkmcnt(6)
    ds_read_b64_tr_b16 a[8:9], v4 offset:15480
    ds_read_b64_tr_b16 a[10:11], v4 offset:16760
    v_mfma_f32_32x32x16_bf16 a[128:143], a[24:27], v[168:171], a[128:143]
    s_waitcnt lgkmcnt(6)
    ds_read_b64_tr_b16 a[12:13], v5 offset:15360
    ds_read_b64_tr_b16 a[14:15], v5 offset:16640
    v_mfma_f32_32x32x16_bf16 a[64:79], a[28:31], v[172:175], a[64:79]
    s_waitcnt lgkmcnt(6)
    ds_read_b64_tr_b16 a[16:17], v4 offset:20480
    ds_read_b64_tr_b16 a[18:19], v4 offset:21760
    v_mfma_f32_32x32x16_bf16 a[80:95], a[0:3], v[172:175], a[80:95]
    s_waitcnt lgkmcnt(6)
    ds_read_b64_tr_b16 a[20:21], v4 offset:20520
    ds_read_b64_tr_b16 a[22:23], v4 offset:21800
    v_mfma_f32_32x32x16_bf16 a[96:111], a[4:7], v[172:175], a[96:111]
    s_waitcnt lgkmcnt(6)
    ds_read_b64_tr_b16 a[24:25], v4 offset:20560
    ds_read_b64_tr_b16 a[26:27], v4 offset:21840
    v_mfma_f32_32x32x16_bf16 a[112:127], a[8:11], v[172:175], a[112:127]
    s_waitcnt lgkmcnt(6)
    ds_read_b64_tr_b16 a[28:29], v4 offset:20600
    ds_read_b64_tr_b16 a[30:31], v4 offset:21880
    v_mfma_f32_32x32x16_bf16 a[128:143], a[12:15], v[172:175], a[128:143]
    s_waitcnt lgkmcnt(6)
    ds_read_b64_tr_b16 a[0:1], v5 offset:20480
    ds_read_b64_tr_b16 a[2:3], v5 offset:21760
    v_mfma_f32_32x32x16_bf16 a[64:79], a[16:19], v[176:179], a[64:79]
    s_waitcnt lgkmcnt(6)
    ds_read_b64_tr_b16 a[4:5], v4 offset:25600
    ds_read_b64_tr_b16 a[6:7], v4 offset:26880
    v_mfma_f32_32x32x16_bf16 a[80:95], a[20:23], v[176:179], a[80:95]
    s_waitcnt lgkmcnt(6)
    ds_read_b64_tr_b16 a[8:9], v4 offset:25640
    ds_read_b64_tr_b16 a[10:11], v4 offset:26920
    v_mfma_f32_32x32x16_bf16 a[96:111], a[24:27], v[176:179], a[96:111]
    s_waitcnt lgkmcnt(6)
    ds_read_b64_tr_b16 a[12:13], v4 offset:25680
    ds_read_b64_tr_b16 a[14:15], v4 offset:26960
    v_mfma_f32_32x32x16_bf16 a[112:127], a[28:31], v[176:179], a[112:127]
    s_waitcnt lgkmcnt(6)
    ds_read_b64_tr_b16 a[16:17], v4 offset:25720
    ds_read_b64_tr_b16 a[18:19], v4 offset:27000
    v_mfma_f32_32x32x16_bf16 a[128:143], a[0:3], v[176:179], a[128:143]
    s_waitcnt lgkmcnt(6)
    ds_read_b64_tr_b16 a[20:21], v5 offset:25600
    ds_read_b64_tr_b16 a[22:23], v5 offset:26880
    v_mfma_f32_32x32x16_bf16 a[64:79], a[4:7], v[180:183], a[64:79]
    s_waitcnt lgkmcnt(6)
    ds_read_b64_tr_b16 a[24:25], v4 offset:30720
    ds_read_b64_tr_b16 a[26:27], v4 offset:32000
    v_mfma_f32_32x32x16_bf16 a[80:95], a[8:11], v[180:183], a[80:95]
    s_waitcnt lgkmcnt(6)
    ds_read_b64_tr_b16 a[28:29], v4 offset:30760
    ds_read_b64_tr_b16 a[30:31], v4 offset:32040
    v_mfma_f32_32x32x16_bf16 a[96:111], a[12:15], v[180:183], a[96:111]
    s_waitcnt lgkmcnt(6)
    ds_read_b64_tr_b16 a[0:1], v4 offset:30800
    ds_read_b64_tr_b16 a[2:3], v4 offset:32080
    v_mfma_f32_32x32x16_bf16 a[112:127], a[16:19], v[180:183], a[112:127]
    s_waitcnt lgkmcnt(6)
    ds_read_b64_tr_b16 a[4:5], v4 offset:30840
    ds_read_b64_tr_b16 a[6:7], v4 offset:32120
    v_mfma_f32_32x32x16_bf16 a[128:143], a[20:23], v[180:183], a[128:143]
    s_waitcnt lgkmcnt(6)
    ds_read_b64_tr_b16 a[8:9], v5 offset:30720
    ds_read_b64_tr_b16 a[10:11], v5 offset:32000
    v_mfma_f32_32x32x16_bf16 a[64:79], a[24:27], v[184:187], a[64:79]
    s_waitcnt lgkmcnt(6)
    ds_read_b64_tr_b16 a[12:13], v4 offset:35840
    ds_read_b64_tr_b16 a[14:15], v4 offset:37120
    v_mfma_f32_32x32x16_bf16 a[80:95], a[28:31], v[184:187], a[80:95]
    s_waitcnt lgkmcnt(6)
    ds_read_b64_tr_b16 a[16:17], v4 offset:35880
    ds_read_b64_tr_b16 a[18:19], v4 offset:37160
    v_mfma_f32_32x32x16_bf16 a[96:111], a[0:3], v[184:187], a[96:111]
    s_waitcnt lgkmcnt(6)
    ds_read_b64_tr_b16 a[20:21], v4 offset:35920
    ds_read_b64_tr_b16 a[22:23], v4 offset:37200
    v_mfma_f32_32x32x16_bf16 a[112:127], a[4:7], v[184:187], a[112:127]
    s_waitcnt lgkmcnt(6)
    ds_read_b64_tr_b16 a[24:25], v4 offset:35960
    ds_read_b64_tr_b16 a[26:27], v4 offset:37240
    v_mfma_f32_32x32x16_bf16 a[128:143], a[8:11], v[184:187], a[128:143]
    s_waitcnt lgkmcnt(6)
    ds_read_b64_tr_b16 a[28:29], v5 offset:35840
    ds_read_b64_tr_b16 a[30:31], v5 offset:37120
    v_mfma_f32_32x32x16_bf16 a[64:79], a[12:15], v[188:191], a[64:79]
    s_waitcnt vmcnt(0) lgkmcnt(6)
    s_barrier
    v_add_u32 v4, 40960, v4
    v_add_u32 v5, 40960, v5
    ds_read_b64_tr_b16 a[0:1], v5 offset:0
    ds_read_b64_tr_b16 a[2:3], v5 offset:1280
    v_mfma_f32_32x32x16_bf16 a[80:95], a[16:19], v[188:191], a[80:95]
    s_waitcnt lgkmcnt(6)
    ds_read_b64_tr_b16 a[4:5], v5 offset:5120
    ds_read_b64_tr_b16 a[6:7], v5 offset:6400
    v_mfma_f32_32x32x16_bf16 a[96:111], a[20:23], v[188:191], a[96:111]
    s_waitcnt lgkmcnt(6)
    ds_read_b64_tr_b16 a[8:9], v5 offset:10240
    ds_read_b64_tr_b16 a[10:11], v5 offset:11520
    v_mfma_f32_32x32x16_bf16 a[112:127], a[24:27], v[188:191], a[112:127]
    s_waitcnt lgkmcnt(6)
    ds_read_b64_tr_b16 a[12:13], v5 offset:15360
    ds_read_b64_tr_b16 a[14:15], v5 offset:16640
    v_mfma_f32_32x32x16_bf16 a[128:143], a[28:31], v[188:191], a[128:143]
    s_waitcnt lgkmcnt(6)
    ds_read_b64_tr_b16 a[16:17], v5 offset:20480
    ds_read_b64_tr_b16 a[18:19], v5 offset:21760
    s_cmp_eq_u32 s41, 2
    s_cbranch_scc1 k1_V
    v_mfma_f32_32x32x16_bf16 a[128:143], a[0:3], v[192:195], a[128:143]
    s_waitcnt lgkmcnt(6)
    ds_read_b64_tr_b16 a[20:21], v5 offset:25600
    ds_read_b64_tr_b16 a[22:23], v5 offset:26880
    s_cmp_ge_u32 s50, 470
    s_cbranch_scc1 k1_qa
    ds_read_b64_tr_b16 v[144:145], v62 offset:0
    ds_read_b64_tr_b16 v[146:147], v62 offset:512
    ds_read_b64_tr_b16 v[148:149], v62 offset:32
    ds_read_b64_tr_b16 v[150:151], v62 offset:544
    ds_read_b64_tr_b16 v[152:153], v62 offset:64
    ds_read_b64_tr_b16 v[154:155], v62 offset:576
    ds_read_b64_tr_b16 v[156:157], v62 offset:96
    ds_read_b64_tr_b16 v[158:159], v62 offset:608
k1_qa:
    v_mfma_f32_32x32x16_bf16 a[128:143], a[4:7], v[196:199], a[128:143]
    s_waitcnt lgkmcnt(6)
    ds_read_b64_tr_b16 a[24:25], v5 offset:30720
    ds_read_b64_tr_b16 a[26:27], v5 offset:32000
    v_mfma_f32_32x32x16_bf16 a[128:143], a[8:11], v[200:203], a[128:143]
    s_waitcnt lgkmcnt(6)
    ds_read_b64_tr_b16 a[28:29], v5 offset:35840
    ds_read_b64_tr_b16 a[30:31], v5 offset:37120
    v_mfma_f32_32x32x16_bf16 a[128:143], a[12:15], v[204:207], a[128:143]
    s_waitcnt lgkmcnt(6)
    ds_read_b64_tr_b16 a[0:1], v7 offset:0
    ds_read_b64_tr_b16 a[2:3], v7 offset:1280
    v_mfma_f32_32x32x16_bf16 a[128:143], a[16:19], v[208:211], a[128:143]
    s_waitcnt lgkmcnt(6)
    ds_read_b64_tr_b16 a[4:5], v7 offset:5120
    ds_read_b64_tr_b16 a[6:7], v7 offset:6400
    s_lshl_b32 s28, s38, 8
    s_add_u32 s31, s28, s40
    s_lshl_b32 s28, s38, 10
    s_add_u32 s40, s28, s40
    v_mfma_f32_32x32x16_bf16 a[128:143], a[20:23], v[212:215], a[128:143]
    s_waitcnt lgkmcnt(6)
    ds_read_b64_tr_b16 a[8:9], v7 offset:10240
    ds_read_b64_tr_b16 a[10:11], v7 offset:11520
    v_mul_u32_u24 v61, 212992, v61
    v_lshl_add_u32 v61, v60, 3, v61
    v_mfma_f32_32x32x16_bf16 a[128:143], a[24:27], v[216:219], a[128:143]
    s_waitcnt lgkmcnt(6)
    ds_read_b64_tr_b16 a[12:13], v7 offset:15360
    ds_read_b64_tr_b16 a[14:15], v7 offset:16640
    s_add_u32 s31, s31, 6144
    s_mov_b32 s34, 212992
    s_mov_b32 s33, 425984
    s_cmp_lg_u32 s41, 0
    s_cbranch_scc1 k1_k
    s_lshl_b32 s28, s26, 12
    s_add_u32 s40, s35, s28
    s_lshr_b32 s28, s28, 2
    s_add_u32 s31, s35, s28
    s_add_u32 s31, s31, 16384
    s_mov_b32 s34, 512
    s_mov_b32 s33, 256
    v_lshrrev_b32 v61, 5, v0
    v_mul_u32_u24 v61, 248, v61
    v_sub_u32 v61, v95, v61
    s_branch k1_k2
k1_k:
    v_mov_b32 v95, v1
k1_k2:
    v_mfma_f32_32x32x16_bf16 a[128:143], a[28:31], v[220:223], a[128:143]
    s_waitcnt lgkmcnt(6)
    ds_read_b64_tr_b16 a[16:17], v7 offset:20480
    ds_read_b64_tr_b16 a[18:19], v7 offset:21760
    v_mfma_f32_32x32x16_bf16 a[128:143], a[0:3], v[224:227], a[128:143]
    s_waitcnt lgkmcnt(6)
    ds_read_b64_tr_b16 a[20:21], v7 offset:25600
    ds_read_b64_tr_b16 a[22:23], v7 offset:26880
    v_mfma_f32_32x32x16_bf16 a[128:143], a[4:7], v[228:231], a[128:143]
    s_waitcnt lgkmcnt(6)
    ds_read_b64_tr_b16 a[24:25], v7 offset:30720
    ds_read_b64_tr_b16 a[26:27], v7 offset:32000
    v_mfma_f32_32x32x16_bf16 a[128:143], a[8:11], v[232:235], a[128:143]
    s_waitcnt lgkmcnt(6)
    ds_read_b64_tr_b16 a[28:29], v7 offset:35840
    ds_read_b64_tr_b16 a[30:31], v7 offset:37120
    s_cmp_ge_u32 s50, 470
    s_cbranch_scc1 k1_qb
    buffer_store_dwordx4 v[144:147], v1, s[16:19], s39 offen offset:0 sc1
    buffer_store_dwordx4 v[148:151], v1, s[16:19], s39 offen offset:1024 sc1
    buffer_store_dwordx4 v[152:155], v1, s[16:19], s39 offen offset:2048 sc1
    buffer_store_dwordx4 v[156:159], v1, s[16:19], s39 offen offset:3072 sc1
k1_qb:
    v_mfma_f32_32x32x16_bf16 a[128:143], a[12:15], v[236:239], a[128:143]
    s_waitcnt lgkmcnt(6)
    ds_read_b64_tr_b16 a[0:1], v4 offset:0
    ds_read_b64_tr_b16 a[2:3], v4 offset:1280
    v_mfma_f32_32x32x16_bf16 a[128:143], a[16:19], v[240:243], a[128:143]
    s_waitcnt lgkmcnt(6)
    ds_read_b64_tr_b16 a[4:5], v4 offset:5120
    ds_read_b64_tr_b16 a[6:7], v4 offset:6400
    v_mfma_f32_32x32x16_bf16 a[128:143], a[20:23], v[244:247], a[128:143]
    s_waitcnt lgkmcnt(6)
    ds_read_b64_tr_b16 a[8:9], v4 offset:10240
    ds_read_b64_tr_b16 a[10:11], v4 offset:11520
    v_mfma_f32_32x32x16_bf16 a[128:143], a[24:27], v[248:251], a[128:143]
    s_waitcnt lgkmcnt(6)
    ds_read_b64_tr_b16 a[12:13], v4 offset:15360
    ds_read_b64_tr_b16 a[14:15], v4 offset:16640
    s_add_u32 s29, s47, 0
    buffer_load_dwordx4 v[160:163], v57, s[16:19], s29 offen offset:0 sc1
    buffer_load_dwordx4 v[164:167], v57, s[16:19], s29 offen offset:2048 sc1
    v_mfma_f32_32x32x16_bf16 a[128:143], a[28:31], v[252:255], a[128:143]
    s_waitcnt lgkmcnt(6)
    ds_read_b64_tr_b16 a[16:17], v4 offset:20480
    ds_read_b64_tr_b16 a[18:19], v4 offset:21760
    s_add_u32 s29, s47, 4096
    buffer_load_dwordx4 v[168:171], v57, s[16:19], s29 offen offset:0 sc1
    buffer_load_dwordx4 v[172:175], v57, s[16:19], s29 offen offset:2048 sc1
    v_mfma_f32_32x32x16_bf16 a[64:79], a[0:3], v[192:195], a[64:79]
    s_waitcnt lgkmcnt(6)
    ds_read_b64_tr_b16 a[20:21], v4 offset:25600
    ds_read_b64_tr_b16 a[22:23], v4 offset:26880
    s_add_u32 s29, s47, 8192
    buffer_load_dwordx4 v[176:179], v57, s[16:19], s29 offen offset:0 sc1
    buffer_load_dwordx4 v[180:183], v57, s[16:19], s29 offen offset:2048 sc1
    v_mfma_f32_32x32x16_bf16 a[64:79], a[4:7], v[196:199], a[64:79]
    s_waitcnt lgkmcnt(6)
    ds_read_b64_tr_b16 a[24:25], v4 offset:30720
    ds_read_b64_tr_b16 a[26:27], v4 offset:32000
    s_add_u32 s29, s47, 12288
    buffer_load_dwordx4 v[184:187], v57, s[16:19], s29 offen offset:0 sc1
    v_mfma_f32_32x32x16_bf16 a[64:79], a[8:11], v[200:203], a[64:79]
    s_waitcnt lgkmcnt(6)
    ds_read_b64_tr_b16 a[28:29], v4 offset:35840
    ds_read_b64_tr_b16 a[30:31], v4 offset:37120
    v_mfma_f32_32x32x16_bf16 a[64:79], a[12:15], v[204:207], a[64:79]
    s_waitcnt lgkmcnt(6)
    ds_read_b64_tr_b16 a[0:1], v6 offset:0
    ds_read_b64_tr_b16 a[2:3], v6 offset:1280
    v_accvgpr_read_b32 v96, a128
    v_accvgpr_read_b32 v97, a129
    v_accvgpr_read_b32 v98, a130
    v_accvgpr_read_b32 v99, a131
    v_accvgpr_read_b32 v100, a132
    v_accvgpr_read_b32 v101, a133
    v_mfma_f32_32x32x16_bf16 a[64:79], a[16:19], v[208:211], a[64:79]
    s_waitcnt lgkmcnt(6)
    ds_read_b64_tr_b16 a[4:5], v6 offset:5120
    ds_read_b64_tr_b16 a[6:7], v6 offset:6400
    v_accvgpr_read_b32 v102, a134
    v_accvgpr_read_b32 v103, a135
    v_accvgpr_read_b32 v104, a136
    v_accvgpr_read_b32 v105, a137
    v_accvgpr_read_b32 v106, a138
    v_mfma_f32_32x32x16_bf16 a[64:79], a[20:23], v[212:215], a[64:79]
    s_waitcnt lgkmcnt(6)
    ds_read_b64_tr_b16 a[8:9], v6 offset:10240
    ds_read_b64_tr_b16 a[10:11], v6 offset:11520
    v_accvgpr_read_b32 v107, a139
    v_accvgpr_read_b32 v108, a140
    v_accvgpr_read_b32 v109, a141
    v_accvgpr_read_b32 v110, a142
    v_mfma_f32_32x32x16_bf16 a[64:79], a[24:27], v[216:219], a[64:79]
    s_waitcnt lgkmcnt(6)
    ds_read_b64_tr_b16 a[12:13], v6 offset:15360
    ds_read_b64_tr_b16 a[14:15], v6 offset:16640
    v_accvgpr_read_b32 v111, a143
    v_mul_f32 v96, v96, v63
    v_mul_f32 v97, v97, v63
    v_cvt_pk_bf16_f32 v112, v96, v97
    v_mul_f32 v98, v98, v63
    v_mfma_f32_32x32x16_bf16 a[64:79], a[28:31], v[220:223], a[64:79]
    s_waitcnt lgkmcnt(6)
    ds_read_b64_tr_b16 a[16:17], v6 offset:20480
    ds_read_b64_tr_b16 a[18:19], v6 offset:21760
    v_mul_f32 v99, v99, v63
    v_cvt_pk_bf16_f32 v113, v98, v99
    v_mul_f32 v100, v100, v63
    v_mul_f32 v101, v101, v63
    v_mfma_f32_32x32x16_bf16 a[64:79], a[0:3], v[224:227], a[64:79]
    s_waitcnt lgkmcnt(6)
    ds_read_b64_tr_b16 a[20:21], v6 offset:25600
    ds_read_b64_tr_b16 a[22:23], v6 offset:26880
    v_cvt_pk_bf16_f32 v114, v100, v101
    v_mul_f32 v102, v102, v63
    v_mul_f32 v103, v103, v63
    v_cvt_pk_bf16_f32 v115, v102, v103
    v_mul_f32 v104, v104, v63
    v_mfma_f32_32x32x16_bf16 a[64:79], a[4:7], v[228:231], a[64:79]
    s_waitcnt lgkmcnt(6)
    ds_read_b64_tr_b16 a[24:25], v6 offset:30720
    ds_read_b64_tr_b16 a[26:27], v6 offset:32000
    v_mul_f32 v105, v105, v63
    v_cvt_pk_bf16_f32 v116, v104, v105
    v_mul_f32 v106, v106, v63
    v_mul_f32 v107, v107, v63
    v_mfma_f32_32x32x16_bf16 a[64:79], a[8:11], v[232:235], a[64:79]
    s_waitcnt lgkmcnt(6)
    ds_read_b64_tr_b16 a[28:29], v6 offset:35840
    ds_read_b64_tr_b16 a[30:31], v6 offset:37120
    v_cvt_pk_bf16_f32 v117, v106, v107
    v_mul_f32 v108, v108, v63
    v_mul_f32 v109, v109, v63
    v_cvt_pk_bf16_f32 v118, v108, v109
    v_mul_f32 v110, v110, v63
    v_mfma_f32_32x32x16_bf16 a[64:79], a[12:15], v[236:239], a[64:79]
    s_waitcnt lgkmcnt(6)
    ds_read_b64_tr_b16 a[0:1], v4 offset:40
    ds_read_b64_tr_b16 a[2:3], v4 offset:1320
    v_mul_f32 v111, v111, v63
    v_cvt_pk_bf16_f32 v119, v110, v111
    v_mfma_f32_32x32x16_bf16 a[64:79], a[16:19], v[240:243], a[64:79]
    s_waitcnt lgkmcnt(6)
    ds_read_b64_tr_b16 a[4:5], v4 offset:5160
    ds_read_b64_tr_b16 a[6:7], v4 offset:6440
    s_mul_i32 s30, s33, 0
    s_add_u32 s30, s31, s30
    buffer_store_dwordx2 v[112:113], v61, s[16:19], s30 offen sc1
    v_mfma_f32_32x32x16_bf16 a[64:79], a[20:23], v[244:247], a[64:79]
    s_waitcnt lgkmcnt(6)
    ds_read_b64_tr_b16 a[8:9], v4 offset:10280
    ds_read_b64_tr_b16 a[10:11], v4 offset:11560
    s_mul_i32 s30, s33, 1
    s_add_u32 s30, s31, s30
    buffer_store_dwordx2 v[114:115], v61, s[16:19], s30 offen sc1
    v_mfma_f32_32x32x16_bf16 a[64:79], a[24:27], v[248:251], a[64:79]
    s_waitcnt lgkmcnt(6)
    ds_read_b64_tr_b16 a[12:13], v4 offset:15400
    ds_read_b64_tr_b16 a[14:15], v4 offset:16680
    s_mul_i32 s30, s33, 2
    s_add_u32 s30, s31, s30
    buffer_store_dwordx2 v[116:117], v61, s[16:19], s30 offen sc1
    v_mfma_f32_32x32x16_bf16 a[64:79], a[28:31], v[252:255], a[64:79]
    s_waitcnt lgkmcnt(6)
    ds_read_b64_tr_b16 a[16:17], v4 offset:20520
    ds_read_b64_tr_b16 a[18:19], v4 offset:21800
    s_mul_i32 s30, s33, 3
    s_add_u32 s30, s31, s30
    buffer_store_dwordx2 v[118:119], v61, s[16:19], s30 offen sc1
    v_mfma_f32_32x32x16_bf16 a[80:95], a[0:3], v[192:195], a[80:95]
    s_waitcnt lgkmcnt(6)
    ds_read_b64_tr_b16 a[20:21], v4 offset:25640
    ds_read_b64_tr_b16 a[22:23], v4 offset:26920
    v_mfma_f32_32x32x16_bf16 a[80:95], a[4:7], v[196:199], a[80:95]
    s_waitcnt lgkmcnt(6)
    ds_read_b64_tr_b16 a[24:25], v4 offset:30760
    ds_read_b64_tr_b16 a[26:27], v4 offset:32040
    v_mfma_f32_32x32x16_bf16 a[80:95], a[8:11], v[200:203], a[80:95]
    s_waitcnt lgkmcnt(6)
    ds_read_b64_tr_b16 a[28:29], v4 offset:35880
    ds_read_b64_tr_b16 a[30:31], v4 offset:37160
    v_mfma_f32_32x32x16_bf16 a[80:95], a[12:15], v[204:207], a[80:95]
    s_waitcnt lgkmcnt(6)
    ds_read_b64_tr_b16 a[0:1], v6 offset:40
    ds_read_b64_tr_b16 a[2:3], v6 offset:1320
    v_accvgpr_read_b32 v96, a64
    v_accvgpr_read_b32 v97, a65
    v_accvgpr_read_b32 v98, a66
    v_accvgpr_read_b32 v99, a67
    v_accvgpr_read_b32 v100, a68
    v_accvgpr_read_b32 v101, a69
    v_mfma_f32_32x32x16_bf16 a[80:95], a[16:19], v[208:211], a[80:95]
    s_waitcnt lgkmcnt(6)
    ds_read_b64_tr_b16 a[4:5], v6 offset:5160
    ds_read_b64_tr_b16 a[6:7], v6 offset:6440
    v_accvgpr_read_b32 v102, a70
    v_accvgpr_read_b32 v103, a71
    v_accvgpr_read_b32 v104, a72
    v_accvgpr_read_b32 v105, a73
    v_accvgpr_read_b32 v106, a74
    v_mfma_f32_32x32x16_bf16 a[80:95], a[20:23], v[212:215], a[80:95]
    s_waitcnt lgkmcnt(6)
    ds_read_b64_tr_b16 a[8:9], v6 offset:10280
    ds_read_b64_tr_b16 a[10:11], v6 offset:11560
    v_accvgpr_read_b32 v107, a75
    v_accvgpr_read_b32 v108, a76
    v_accvgpr_read_b32 v109, a77
    v_accvgpr_read_b32 v110, a78
    v_mfma_f32_32x32x16_bf16 a[80:95], a[24:27], v[216:219], a[80:95]
    s_waitcnt lgkmcnt(6)
    ds_read_b64_tr_b16 a[12:13], v6 offset:15400
    ds_read_b64_tr_b16 a[14:15], v6 offset:16680
    v_accvgpr_read_b32 v111, a79
    v_mul_f32 v96, v96, v63
    v_mul_f32 v97, v97, v63
    v_cvt_pk_bf16_f32 v120, v96, v97
    v_mul_f32 v98, v98, v63
    v_mfma_f32_32x32x16_bf16 a[80:95], a[28:31], v[220:223], a[80:95]
    s_waitcnt lgkmcnt(6)
    ds_read_b64_tr_b16 a[16:17], v6 offset:20520
    ds_read_b64_tr_b16 a[18:19], v6 offset:21800
    v_mul_f32 v99, v99, v63
    v_cvt_pk_bf16_f32 v121, v98, v99
    v_mul_f32 v100, v100, v63
    v_mul_f32 v101, v101, v63
    v_mfma_f32_32x32x16_bf16 a[80:95], a[0:3], v[224:227], a[80:95]
    s_waitcnt lgkmcnt(6)
    ds_read_b64_tr_b16 a[20:21], v6 offset:25640
    ds_read_b64_tr_b16 a[22:23], v6 offset:26920
    v_cvt_pk_bf16_f32 v122, v100, v101
    v_mul_f32 v102, v102, v63
    v_mul_f32 v103, v103, v63
    v_cvt_pk_bf16_f32 v123, v102, v103
    v_mul_f32 v104, v104, v63
    v_mfma_f32_32x32x16_bf16 a[80:95], a[4:7], v[228:231], a[80:95]
    s_waitcnt lgkmcnt(6)
    ds_read_b64_tr_b16 a[24:25], v6 offset:30760
    ds_read_b64_tr_b16 a[26:27], v6 offset:32040
    v_mul_f32 v105, v105, v63
    v_cvt_pk_bf16_f32 v124, v104, v105
    v_mul_f32 v106, v106, v63
    v_mul_f32 v107, v107, v63
    v_mfma_f32_32x32x16_bf16 a[80:95], a[8:11], v[232:235], a[80:95]
    s_waitcnt lgkmcnt(6)
    ds_read_b64_tr_b16 a[28:29], v6 offset:35880
    ds_read_b64_tr_b16 a[30:31], v6 offset:37160
    v_cvt_pk_bf16_f32 v125, v106, v107
    v_mul_f32 v108, v108, v63
    v_mul_f32 v109, v109, v63
    v_cvt_pk_bf16_f32 v126, v108, v109
    v_mul_f32 v110, v110, v63
    v_mfma_f32_32x32x16_bf16 a[80:95], a[12:15], v[236:239], a[80:95]
    s_waitcnt lgkmcnt(6)
    ds_read_b64_tr_b16 a[0:1], v4 offset:80
    ds_read_b64_tr_b16 a[2:3], v4 offset:1360
    v_mul_f32 v111, v111, v63
    v_cvt_pk_bf16_f32 v127, v110, v111
    v_mfma_f32_32x32x16_bf16 a[80:95], a[16:19], v[240:243], a[80:95]
    s_waitcnt lgkmcnt(6)
    ds_read_b64_tr_b16 a[4:5], v4 offset:5200
    ds_read_b64_tr_b16 a[6:7], v4 offset:6480
    s_mul_i32 s30, s34, 0
    s_add_u32 s30, s40, s30
    buffer_store_dwordx4 v[120:123], v95, s[16:19], s30 offen sc1
    v_mfma_f32_32x32x16_bf16 a[80:95], a[20:23], v[244:247], a[80:95]
    s_waitcnt lgkmcnt(6)
    ds_read_b64_tr_b16 a[8:9], v4 offset:10320
    ds_read_b64_tr_b16 a[10:11], v4 offset:11600
    s_mul_i32 s30, s34, 4
    s_add_u32 s30, s40, s30
    buffer_store_dwordx4 v[124:127], v95, s[16:19], s30 offen sc1
    s_waitcnt vmcnt(6)
    v_mfma_f32_32x32x16_bf16 a[80:95], a[24:27], v[248:251], a[80:95]
    s_waitcnt lgkmcnt(6)
    ds_read_b64_tr_b16 a[12:13], v4 offset:15440
    ds_read_b64_tr_b16 a[14:15], v4 offset:16720
    v_cmp_eq_u64 s[54:55], s[48:49], v[162:163]
    s_and_b64 s[56:57], s[54:55], exec
    v_cmp_eq_u64 s[54:55], s[48:49], v[166:167]
    s_and_b64 s[56:57], s[54:55], s[56:57]
    v_cmp_eq_u64 s[54:55], s[48:49], v[170:171]
    s_and_b64 s[56:57], s[54:55], s[56:57]
    v_mfma_f32_32x32x16_bf16 a[80:95], a[28:31], v[252:255], a[80:95]
    s_waitcnt lgkmcnt(6)
    ds_read_b64_tr_b16 a[16:17], v4 offset:20560
    ds_read_b64_tr_b16 a[18:19], v4 offset:21840
    v_cmp_eq_u64 s[54:55], s[48:49], v[174:175]
    s_and_b64 s[56:57], s[54:55], s[56:57]
    v_cmp_eq_u64 s[54:55], s[48:49], v[178:179]
    s_and_b64 s[56:57], s[54:55], s[56:57]
    v_mfma_f32_32x32x16_bf16 a[96:111], a[0:3], v[192:195], a[96:111]
    s_waitcnt lgkmcnt(6)
    ds_read_b64_tr_b16 a[20:21], v4 offset:25680
    ds_read_b64_tr_b16 a[22:23], v4 offset:26960
    v_cmp_eq_u64 s[54:55], s[48:49], v[182:183]
    s_and_b64 s[56:57], s[54:55], s[56:57]
    v_cmp_eq_u64 s[54:55], s[48:49], v[186:187]
    s_and_b64 s[56:57], s[54:55], s[56:57]
    v_mfma_f32_32x32x16_bf16 a[96:111], a[4:7], v[196:199], a[96:111]
    s_waitcnt lgkmcnt(6)
    ds_read_b64_tr_b16 a[24:25], v4 offset:30800
    ds_read_b64_tr_b16 a[26:27], v4 offset:32080
    s_andn2_b64 s[56:57], exec, s[56:57]
    s_cbranch_scc1 k1_q_re
k1_q_got:
    v_add_f32 v160, v160, v164
    v_add_f32 v161, v161, v165
    v_add_f32 v160, v160, v168
    v_mfma_f32_32x32x16_bf16 a[96:111], a[8:11], v[200:203], a[96:111]
    s_waitcnt lgkmcnt(6)
    ds_read_b64_tr_b16 a[28:29], v4 offset:35920
    ds_read_b64_tr_b16 a[30:31], v4 offset:37200
    v_add_f32 v161, v161, v169
    v_add_f32 v160, v160, v172
    v_add_f32 v161, v161, v173
    v_add_f32 v160, v160, v176
    v_add_f32 v161, v161, v177
    v_mfma_f32_32x32x16_bf16 a[96:111], a[12:15], v[204:207], a[96:111]
    s_waitcnt lgkmcnt(6)
    ds_read_b64_tr_b16 a[0:1], v6 offset:80
    ds_read_b64_tr_b16 a[2:3], v6 offset:1360
    v_add_f32 v160, v160, v180
    v_add_f32 v161, v161, v181
    v_add_f32 v160, v160, v184
    v_add_f32 v161, v161, v185
    v_mfma_f32_32x32x16_bf16 a[96:111], a[16:19], v[208:211], a[96:111]
    s_waitcnt lgkmcnt(6)
    ds_read_b64_tr_b16 a[4:5], v6 offset:5200
    ds_read_b64_tr_b16 a[6:7], v6 offset:6480
    v_mov_b32 v162, v160
    v_mov_b32 v163, v161
    s_nop 1
    v_permlane32_swap_b32 v160, v162
    v_permlane32_swap_b32 v161, v163
    v_mfma_f32_32x32x16_bf16 a[96:111], a[20:23], v[212:215], a[96:111]
    s_waitcnt lgkmcnt(6)
    ds_read_b64_tr_b16 a[8:9], v6 offset:10320
    ds_read_b64_tr_b16 a[10:11], v6 offset:11600
    s_nop 0
    v_add_f32 v160, v160, v162
    v_add_f32 v161, v161, v163
    v_mul_f32 v160, 0x3a97b426, v160
    v_mfma_f32_32x32x16_bf16 a[96:111], a[24:27], v[216:219], a[96:111]
    s_waitcnt lgkmcnt(6)
    ds_read_b64_tr_b16 a[12:13], v6 offset:15440
    ds_read_b64_tr_b16 a[14:15], v6 offset:16720
    v_mul_f32 v161, 0x3a97b426, v161
    v_fma_f32 v161, -v160, v160, v161
    v_max_f32 v161, 0, v161
    v_cvt_pk_bf16_f32 v160, v160, v160
    v_lshlrev_b32 v160, 16, v160
    v_mfma_f32_32x32x16_bf16 a[96:111], a[28:31], v[220:223], a[96:111]
    s_waitcnt lgkmcnt(6)
    ds_read_b64_tr_b16 a[16:17], v6 offset:20560
    ds_read_b64_tr_b16 a[18:19], v6 offset:21840
    v_cvt_pk_bf16_f32 v161, v161, v161
    v_lshlrev_b32 v161, 16, v161
    v_add_f32 v161, 0x3727c5ac, v161
    v_cvt_pk_bf16_f32 v161, v161, v161
    v_mfma_f32_32x32x16_bf16 a[96:111], a[0:3], v[224:227], a[96:111]
    s_waitcnt lgkmcnt(6)
    ds_read_b64_tr_b16 a[20:21], v6 offset:25680
    ds_read_b64_tr_b16 a[22:23], v6 offset:26960
    v_lshlrev_b32 v161, 16, v161
    v_sqrt_f32 v161, v161
    s_nop 0
    v_cvt_pk_bf16_f32 v161, v161, v161
    v_mfma_f32_32x32x16_bf16 a[96:111], a[4:7], v[228:231], a[96:111]
    s_waitcnt lgkmcnt(6)
    ds_read_b64_tr_b16 a[24:25], v6 offset:30800
    ds_read_b64_tr_b16 a[26:27], v6 offset:32080
    v_lshlrev_b32 v161, 16, v161
    v_rcp_f32 v161, v161
    s_nop 0
    v_mfma_f32_32x32x16_bf16 a[96:111], a[8:11], v[232:235], a[96:111]
    s_waitcnt lgkmcnt(6)
    ds_read_b64_tr_b16 a[28:29], v6 offset:35920
    ds_read_b64_tr_b16 a[30:31], v6 offset:37200
    v_mul_f32 v160, v160, v161
    v_accvgpr_read_b32 v96, a80
    v_accvgpr_read_b32 v97, a81
    v_accvgpr_read_b32 v98, a82
    v_accvgpr_read_b32 v99, a83
    v_mfma_f32_32x32x16_bf16 a[96:111], a[12:15], v[236:239], a[96:111]
    s_waitcnt lgkmcnt(6)
    ds_read_b64_tr_b16 a[0:1], v4 offset:120
    ds_read_b64_tr_b16 a[2:3], v4 offset:1400
    v_accvgpr_read_b32 v100, a84
    v_accvgpr_read_b32 v101, a85
    v_accvgpr_read_b32 v102, a86
    v_accvgpr_read_b32 v103, a87
    v_mfma_f32_32x32x16_bf16 a[96:111], a[16:19], v[240:243], a[96:111]
    s_waitcnt lgkmcnt(6)
    ds_read_b64_tr_b16 a[4:5], v4 offset:5240
    ds_read_b64_tr_b16 a[6:7], v4 offset:6520
    v_accvgpr_read_b32 v104, a88
    v_accvgpr_read_b32 v105, a89
    v_accvgpr_read_b32 v106, a90
    v_accvgpr_read_b32 v107, a91
    v_accvgpr_read_b32 v108, a92
    v_mfma_f32_32x32x16_bf16 a[96:111], a[20:23], v[244:247], a[96:111]
    s_waitcnt lgkmcnt(6)
    ds_read_b64_tr_b16 a[8:9], v4 offset:10360
    ds_read_b64_tr_b16 a[10:11], v4 offset:11640
    v_accvgpr_read_b32 v109, a93
    v_accvgpr_read_b32 v110, a94
    v_accvgpr_read_b32 v111, a95
    v_mul_f32 v96, v96, v63
    v_mfma_f32_32x32x16_bf16 a[96:111], a[24:27], v[248:251], a[96:111]
    s_waitcnt lgkmcnt(6)
    ds_read_b64_tr_b16 a[12:13], v4 offset:15480
    ds_read_b64_tr_b16 a[14:15], v4 offset:16760
    v_mul_f32 v97, v97, v63
    v_cvt_pk_bf16_f32 v112, v96, v97
    v_mul_f32 v98, v98, v63
    v_mul_f32 v99, v99, v63
    v_cvt_pk_bf16_f32 v113, v98, v99
    v_mfma_f32_32x32x16_bf16 a[96:111], a[28:31], v[252:255], a[96:111]
    s_waitcnt lgkmcnt(6)
    ds_read_b64_tr_b16 a[16:17], v4 offset:20600
    ds_read_b64_tr_b16 a[18:19], v4 offset:21880
    v_mul_f32 v100, v100, v63
    v_mul_f32 v101, v101, v63
    v_cvt_pk_bf16_f32 v114, v100, v101
    v_mul_f32 v102, v102, v63
    v_mfma_f32_32x32x16_bf16 a[112:127], a[0:3], v[192:195], a[112:127]
    s_waitcnt lgkmcnt(6)
    ds_read_b64_tr_b16 a[20:21], v4 offset:25720
    ds_read_b64_tr_b16 a[22:23], v4 offset:27000
    v_mul_f32 v103, v103, v63
    v_cvt_pk_bf16_f32 v115, v102, v103
    v_mul_f32 v104, v104, v63
    v_mul_f32 v105, v105, v63
    v_cvt_pk_bf16_f32 v116, v104, v105
    v_mfma_f32_32x32x16_bf16 a[112:127], a[4:7], v[196:199], a[112:127]
    s_waitcnt lgkmcnt(6)
    ds_read_b64_tr_b16 a[24:25], v4 offset:30840
    ds_read_b64_tr_b16 a[26:27], v4 offset:32120
    v_mul_f32 v106, v106, v63
    v_mul_f32 v107, v107, v63
    v_cvt_pk_bf16_f32 v117, v106, v107
    v_mul_f32 v108, v108, v63
    v_mfma_f32_32x32x16_bf16 a[112:127], a[8:11], v[200:203], a[112:127]
    s_waitcnt lgkmcnt(6)
    ds_read_b64_tr_b16 a[28:29], v4 offset:35960
    ds_read_b64_tr_b16 a[30:31], v4 offset:37240
    v_mul_f32 v109, v109, v63
    v_cvt_pk_bf16_f32 v118, v108, v109
    v_mul_f32 v110, v110, v63
    v_mul_f32 v111, v111, v63
    v_cvt_pk_bf16_f32 v119, v110, v111
    v_mfma_f32_32x32x16_bf16 a[112:127], a[12:15], v[204:207], a[112:127]
    s_waitcnt lgkmcnt(6)
    ds_read_b64_tr_b16 a[0:1], v6 offset:120
    ds_read_b64_tr_b16 a[2:3], v6 offset:1400
    s_mul_i32 s30, s34, 1
    s_add_u32 s30, s40, s30
    buffer_store_dwordx4 v[112:115], v95, s[16:19], s30 offen sc1
    v_mfma_f32_32x32x16_bf16 a[112:127], a[16:19], v[208:211], a[112:127]
    s_waitcnt lgkmcnt(6)
    ds_read_b64_tr_b16 a[4:5], v6 offset:5240
    ds_read_b64_tr_b16 a[6:7], v6 offset:6520
    s_mul_i32 s30, s34, 5
    s_add_u32 s30, s40, s30
    buffer_store_dwordx4 v[116:119], v95, s[16:19], s30 offen sc1
    v_fma_f32 v16, v16, v161, -v160
    v_mfma_f32_32x32x16_bf16 a[112:127], a[20:23], v[212:215], a[112:127]
    s_waitcnt lgkmcnt(6)
    ds_read_b64_tr_b16 a[8:9], v6 offset:10360
    ds_read_b64_tr_b16 a[10:11], v6 offset:11640
    v_fma_f32 v17, v17, v161, -v160
    v_fma_f32 v18, v18, v161, -v160
    v_fma_f32 v19, v19, v161, -v160
    v_cvt_pk_bf16_f32 v16, v16, v17
    v_mfma_f32_32x32x16_bf16 a[112:127], a[24:27], v[216:219], a[112:127]
    s_waitcnt lgkmcnt(6)
    ds_read_b64_tr_b16 a[12:13], v6 offset:15480
    ds_read_b64_tr_b16 a[14:15], v6 offset:16760
    v_cvt_pk_bf16_f32 v17, v18, v19
    ds_write_b64 v58, v[16:17] offset:0
    v_fma_f32 v20, v20, v161, -v160
    v_fma_f32 v21, v21, v161, -v160
    v_mfma_f32_32x32x16_bf16 a[112:127], a[28:31], v[220:223], a[112:127]
    s_waitcnt lgkmcnt(6)
    ds_read_b64_tr_b16 a[16:17], v6 offset:20600
    ds_read_b64_tr_b16 a[18:19], v6 offset:21880
    v_fma_f32 v22, v22, v161, -v160
    v_fma_f32 v23, v23, v161, -v160
    v_cvt_pk_bf16_f32 v20, v20, v21
    v_cvt_pk_bf16_f32 v21, v22, v23
    v_mfma_f32_32x32x16_bf16 a[112:127], a[0:3], v[224:227], a[112:127]
    s_waitcnt lgkmcnt(6)
    ds_read_b64_tr_b16 a[20:21], v6 offset:25720
    ds_read_b64_tr_b16 a[22:23], v6 offset:27000
    ds_write_b64 v58, v[20:21] offset:16
    v_fma_f32 v24, v24, v161, -v160
    v_fma_f32 v25, v25, v161, -v160
    v_fma_f32 v26, v26, v161, -v160
    v_mfma_f32_32x32x16_bf16 a[112:127], a[4:7], v[228:231], a[112:127]
    s_waitcnt lgkmcnt(6)
    ds_read_b64_tr_b16 a[24:25], v6 offset:30840
    ds_read_b64_tr_b16 a[26:27], v6 offset:32120
    v_fma_f32 v27, v27, v161, -v160
    v_cvt_pk_bf16_f32 v24, v24, v25
    v_cvt_pk_bf16_f32 v25, v26, v27
    v_mfma_f32_32x32x16_bf16 a[112:127], a[8:11], v[232:235], a[112:127]
    s_waitcnt lgkmcnt(6)
    ds_read_b64_tr_b16 a[28:29], v6 offset:35960
    ds_read_b64_tr_b16 a[30:31], v6 offset:37240
    ds_write_b64 v58, v[24:25] offset:32
    v_fma_f32 v28, v28, v161, -v160
    v_fma_f32 v29, v29, v161, -v160
    v_fma_f32 v30, v30, v161, -v160
    v_fma_f32 v31, v31, v161, -v160
    v_mfma_f32_32x32x16_bf16 a[112:127], a[12:15], v[236:239], a[112:127]
    s_waitcnt lgkmcnt(6)
    ds_read_b64_tr_b16 a[0:1], v6 offset:120
    ds_read_b64_tr_b16 a[2:3], v6 offset:1400
    v_cvt_pk_bf16_f32 v28, v28, v29
    v_cvt_pk_bf16_f32 v29, v30, v31
    ds_write_b64 v58, v[28:29] offset:48
    v_mfma_f32_32x32x16_bf16 a[112:127], a[16:19], v[240:243], a[112:127]
    s_waitcnt lgkmcnt(6)
    ds_read_b64_tr_b16 a[4:5], v6 offset:5240
    ds_read_b64_tr_b16 a[6:7], v6 offset:6520
    ds_read_b64_tr_b16 v[168:169], v59 offset:0
    ds_read_b64_tr_b16 v[170:171], v59 offset:544
    v_mfma_f32_32x32x16_bf16 a[112:127], a[20:23], v[244:247], a[112:127]
    s_waitcnt lgkmcnt(6)
    ds_read_b64_tr_b16 a[8:9], v6 offset:10360
    ds_read_b64_tr_b16 a[10:11], v6 offset:11640
    ds_read_b64_tr_b16 v[172:173], v59 offset:2176
    ds_read_b64_tr_b16 v[174:175], v59 offset:2720
    v_accvgpr_read_b32 v96, a96
    v_mfma_f32_32x32x16_bf16 a[112:127], a[24:27], v[248:251], a[112:127]
    s_waitcnt lgkmcnt(6)
    ds_read_b64_tr_b16 a[12:13], v6 offset:15480
    ds_read_b64_tr_b16 a[14:15], v6 offset:16760
    v_accvgpr_read_b32 v97, a97
    v_accvgpr_read_b32 v98, a98
    v_accvgpr_read_b32 v99, a99
    v_accvgpr_read_b32 v100, a100
    v_accvgpr_read_b32 v101, a101
    v_mfma_f32_32x32x16_bf16 a[112:127], a[28:31], v[252:255], a[112:127]
    s_waitcnt lgkmcnt(6)
    ds_read_b64_tr_b16 a[16:17], v6 offset:20600
    ds_read_b64_tr_b16 a[18:19], v6 offset:21880
    v_accvgpr_read_b32 v102, a102
    v_accvgpr_read_b32 v103, a103
    v_accvgpr_read_b32 v104, a104
    v_accvgpr_read_b32 v105, a105
    v_accvgpr_read_b32 v106, a106
    v_accvgpr_read_b32 v107, a107
    v_accvgpr_read_b32 v108, a108
    v_accvgpr_read_b32 v109, a109
    v_accvgpr_read_b32 v110, a110
    v_accvgpr_read_b32 v111, a111
    buffer_store_dwordx4 v[168:171], v1, s[16:19], s42 offen offset:0 sc1
    buffer_store_dwordx4 v[172:175], v1, s[16:19], s42 offen offset:1024 sc1
    v_mul_f32 v96, v96, v63
    v_mul_f32 v97, v97, v63
    v_cvt_pk_bf16_f32 v120, v96, v97
    v_mul_f32 v98, v98, v63
    v_mul_f32 v99, v99, v63
    v_cvt_pk_bf16_f32 v121, v98, v99
    v_mul_f32 v100, v100, v63
    v_mul_f32 v101, v101, v63
    v_cvt_pk_bf16_f32 v122, v100, v101
    v_mul_f32 v102, v102, v63
    v_mul_f32 v103, v103, v63
    v_cvt_pk_bf16_f32 v123, v102, v103
    v_mul_f32 v104, v104, v63
    v_mul_f32 v105, v105, v63
    v_cvt_pk_bf16_f32 v124, v104, v105
    v_mul_f32 v106, v106, v63
    v_mul_f32 v107, v107, v63
    v_cvt_pk_bf16_f32 v125, v106, v107
    v_mul_f32 v108, v108, v63
    v_mul_f32 v109, v109, v63
    v_cvt_pk_bf16_f32 v126, v108, v109
    v_mul_f32 v110, v110, v63
    v_mul_f32 v111, v111, v63
    v_cvt_pk_bf16_f32 v127, v110, v111
    s_mul_i32 s30, s34, 2
    s_add_u32 s30, s40, s30
    buffer_store_dwordx4 v[120:123], v95, s[16:19], s30 offen sc1
    s_mul_i32 s30, s34, 6
    s_add_u32 s30, s40, s30
    buffer_store_dwordx4 v[124:127], v95, s[16:19], s30 offen sc1
    v_fma_f32 v32, v32, v161, -v160
    v_fma_f32 v33, v33, v161, -v160
    v_fma_f32 v34, v34, v161, -v160
    v_fma_f32 v35, v35, v161, -v160
    v_cvt_pk_bf16_f32 v32, v32, v33
    v_cvt_pk_bf16_f32 v33, v34, v35
    ds_write_b64 v58, v[32:33] offset:64
    v_fma_f32 v36, v36, v161, -v160
    v_fma_f32 v37, v37, v161, -v160
    v_fma_f32 v38, v38, v161, -v160
    v_fma_f32 v39, v39, v161, -v160
    v_cvt_pk_bf16_f32 v36, v36, v37
    v_cvt_pk_bf16_f32 v37, v38, v39
    ds_write_b64 v58, v[36:37] offset:80
    v_fma_f32 v40, v40, v161, -v160
    v_fma_f32 v41, v41, v161, -v160
    v_fma_f32 v42, v42, v161, -v160
    v_fma_f32 v43, v43, v161, -v160
    v_cvt_pk_bf16_f32 v40, v40, v41
    v_cvt_pk_bf16_f32 v41, v42, v43
    ds_write_b64 v58, v[40:41] offset:96
    v_fma_f32 v44, v44, v161, -v160
    v_fma_f32 v45, v45, v161, -v160
    v_fma_f32 v46, v46, v161, -v160
    v_fma_f32 v47, v47, v161, -v160
    v_cvt_pk_bf16_f32 v44, v44, v45
    v_cvt_pk_bf16_f32 v45, v46, v47
    ds_write_b64 v58, v[44:45] offset:112
    ds_read_b64_tr_b16 v[176:177], v59 offset:64
    ds_read_b64_tr_b16 v[178:179], v59 offset:608
    ds_read_b64_tr_b16 v[180:181], v59 offset:2240
    ds_read_b64_tr_b16 v[182:183], v59 offset:2784
    s_nop 7
    v_accvgpr_read_b32 v96, a112
    v_accvgpr_read_b32 v97, a113
    v_accvgpr_read_b32 v98, a114
    v_accvgpr_read_b32 v99, a115
    v_accvgpr_read_b32 v100, a116
    v_accvgpr_read_b32 v101, a117
    v_accvgpr_read_b32 v102, a118
    v_accvgpr_read_b32 v103, a119
    v_accvgpr_read_b32 v104, a120
    v_accvgpr_read_b32 v105, a121
    v_accvgpr_read_b32 v106, a122
    v_accvgpr_read_b32 v107, a123
    v_accvgpr_read_b32 v108, a124
    v_accvgpr_read_b32 v109, a125
    v_accvgpr_read_b32 v110, a126
    v_accvgpr_read_b32 v111, a127
    s_waitcnt lgkmcnt(0)
    buffer_store_dwordx4 v[176:179], v1, s[16:19], s43 offen offset:0 sc1
    buffer_store_dwordx4 v[180:183], v1, s[16:19], s43 offen offset:1024 sc1
    v_mul_f32 v96, v96, v63
    v_mul_f32 v97, v97, v63
    v_cvt_pk_bf16_f32 v112, v96, v97
    v_mul_f32 v98, v98, v63
    v_mul_f32 v99, v99, v63
    v_cvt_pk_bf16_f32 v113, v98, v99
    v_mul_f32 v100, v100, v63
    v_mul_f32 v101, v101, v63
    v_cvt_pk_bf16_f32 v114, v100, v101
    v_mul_f32 v102, v102, v63
    v_mul_f32 v103, v103, v63
    v_cvt_pk_bf16_f32 v115, v102, v103
    v_mul_f32 v104, v104, v63
    v_mul_f32 v105, v105, v63
    v_cvt_pk_bf16_f32 v116, v104, v105
    v_mul_f32 v106, v106, v63
    v_mul_f32 v107, v107, v63
    v_cvt_pk_bf16_f32 v117, v106, v107
    v_mul_f32 v108, v108, v63
    v_mul_f32 v109, v109, v63
    v_cvt_pk_bf16_f32 v118, v108, v109
    v_mul_f32 v110, v110, v63
    v_mul_f32 v111, v111, v63
    v_cvt_pk_bf16_f32 v119, v110, v111
    s_mul_i32 s30, s34, 3
    s_add_u32 s30, s40, s30
    buffer_store_dwordx4 v[112:115], v95, s[16:19], s30 offen sc1
    s_mul_i32 s30, s34, 7
    s_add_u32 s30, s40, s30
    buffer_store_dwordx4 v[116:119], v95, s[16:19], s30 offen sc1
    s_waitcnt lgkmcnt(0)
    s_branch k1_fin
k1_V:
    v_mfma_f32_32x32x16_bf16 a[128:143], a[0:3], v[192:195], a[128:143]
    s_waitcnt lgkmcnt(6)
    ds_read_b64_tr_b16 a[20:21], v5 offset:25600
    ds_read_b64_tr_b16 a[22:23], v5 offset:26880
    s_cmp_ge_u32 s50, 470
    s_cbranch_scc1 k1_va
    ds_read_b64_tr_b16 v[144:145], v62 offset:0
    ds_read_b64_tr_b16 v[146:147], v62 offset:512
    ds_read_b64_tr_b16 v[148:149], v62 offset:32
    ds_read_b64_tr_b16 v[150:151], v62 offset:544
    ds_read_b64_tr_b16 v[152:153], v62 offset:64
    ds_read_b64_tr_b16 v[154:155], v62 offset:576
    ds_read_b64_tr_b16 v[156:157], v62 offset:96
    ds_read_b64_tr_b16 v[158:159], v62 offset:608
k1_va:
    v_mfma_f32_32x32x16_bf16 a[128:143], a[4:7], v[196:199], a[128:143]
    s_waitcnt lgkmcnt(6)
    ds_read_b64_tr_b16 a[24:25], v5 offset:30720
    ds_read_b64_tr_b16 a[26:27], v5 offset:32000
    v_mfma_f32_32x32x16_bf16 a[128:143], a[8:11], v[200:203], a[128:143]
    s_waitcnt lgkmcnt(6)
    ds_read_b64_tr_b16 a[28:29], v5 offset:35840
    ds_read_b64_tr_b16 a[30:31], v5 offset:37120
    v_mfma_f32_32x32x16_bf16 a[128:143], a[12:15], v[204:207], a[128:143]
    s_waitcnt lgkmcnt(6)
    ds_read_b64_tr_b16 a[0:1], v7 offset:0
    ds_read_b64_tr_b16 a[2:3], v7 offset:1280
    v_mfma_f32_32x32x16_bf16 a[128:143], a[16:19], v[208:211], a[128:143]
    s_waitcnt lgkmcnt(6)
    ds_read_b64_tr_b16 a[4:5], v7 offset:5120
    ds_read_b64_tr_b16 a[6:7], v7 offset:6400
    s_lshl_b32 s28, s38, 11
    s_add_u32 s40, s28, s40
    v_lshlrev_b32 v61, 9, v61
    v_bfe_u32 v64, v0, 4, 1
    v_mfma_f32_32x32x16_bf16 a[128:143], a[20:23], v[212:215], a[128:143]
    s_waitcnt lgkmcnt(6)
    ds_read_b64_tr_b16 a[8:9], v7 offset:10240
    ds_read_b64_tr_b16 a[10:11], v7 offset:11520
    v_mul_u32_u24 v64, 851968, v64
    v_and_b32 v65, 15, v0
    v_lshl_add_u32 v64, v65, 4, v64
    v_add_u32 v64, v64, v61
    v_lshrrev_b32 v65, 2, v60
    v_mfma_f32_32x32x16_bf16 a[128:143], a[24:27], v[216:219], a[128:143]
    s_waitcnt lgkmcnt(6)
    ds_read_b64_tr_b16 a[12:13], v7 offset:15360
    ds_read_b64_tr_b16 a[14:15], v7 offset:16640
    v_mul_u32_u24 v65, 212992, v65
    v_and_b32 v60, 3, v0
    v_lshl_add_u32 v65, v60, 4, v65
    v_add_u32 v65, v65, v61
    v_mfma_f32_32x32x16_bf16 a[128:143], a[28:31], v[220:223], a[128:143]
    s_waitcnt lgkmcnt(6)
    ds_read_b64_tr_b16 a[16:17], v7 offset:20480
    ds_read_b64_tr_b16 a[18:19], v7 offset:21760
    v_lshrrev_b32 v56, 4, v0
    v_lshlrev_b32 v56, 8, v56
    v_add_u32 v56, v56, v1
    v_and_b32 v68, 11, v0
    v_mfma_f32_32x32x16_bf16 a[128:143], a[0:3], v[224:227], a[128:143]
    s_waitcnt lgkmcnt(6)
    ds_read_b64_tr_b16 a[20:21], v7 offset:25600
    ds_read_b64_tr_b16 a[22:23], v7 offset:26880
    v_cmp_eq_u32 vcc, 8, v68
    v_mov_b32 v69, 0x3f803f80
    s_nop 0
    v_cndmask_b32 v68, 0, v69, vcc
    v_mov_b32 v69, v68
    v_mfma_f32_32x32x16_bf16 a[128:143], a[4:7], v[228:231], a[128:143]
    s_waitcnt lgkmcnt(6)
    ds_read_b64_tr_b16 a[24:25], v7 offset:30720
    ds_read_b64_tr_b16 a[26:27], v7 offset:32000
    v_mov_b32 v70, v68
    v_mov_b32 v71, v68
    v_mfma_f32_32x32x16_bf16 a[128:143], a[8:11], v[232:235], a[128:143]
    s_waitcnt lgkmcnt(6)
    ds_read_b64_tr_b16 a[28:29], v7 offset:35840
    ds_read_b64_tr_b16 a[30:31], v7 offset:37120
    s_add_u32 s28, s40, 2304
    s_mov_b32 exec_lo, 0xfff0fff0
    s_mov_b32 exec_hi, 0xfff0fff0
    buffer_store_dwordx4 v[68:71], v56, s[16:19], s28 offen sc1
    s_mov_b64 exec, -1
    v_mfma_f32_32x32x16_bf16 a[128:143], a[12:15], v[236:239], a[128:143]
    s_waitcnt lgkmcnt(6)
    ds_read_b64_tr_b16 a[0:1], v4 offset:0
    ds_read_b64_tr_b16 a[2:3], v4 offset:1280
    s_add_u32 s28, s40, 215296
    s_mov_b32 exec_lo, 0xfff0fff0
    s_mov_b32 exec_hi, 0xfff0fff0
    buffer_store_dwordx4 v[68:71], v56, s[16:19], s28 offen sc1
    s_mov_b64 exec, -1
    v_mfma_f32_32x32x16_bf16 a[128:143], a[16:19], v[240:243], a[128:143]
    s_waitcnt lgkmcnt(6)
    ds_read_b64_tr_b16 a[4:5], v4 offset:5120
    ds_read_b64_tr_b16 a[6:7], v4 offset:6400
    v_mfma_f32_32x32x16_bf16 a[128:143], a[20:23], v[244:247], a[128:143]
    s_waitcnt lgkmcnt(6)
    ds_read_b64_tr_b16 a[8:9], v4 offset:10240
    ds_read_b64_tr_b16 a[10:11], v4 offset:11520
    s_add_u32 s28, s40, 428288
    s_mov_b32 exec_lo, 0xfff0fff0
    s_mov_b32 exec_hi, 0xfff0fff0
    buffer_store_dwordx4 v[68:71], v56, s[16:19], s28 offen sc1
    s_mov_b64 exec, -1
    v_mfma_f32_32x32x16_bf16 a[128:143], a[24:27], v[248:251], a[128:143]
    s_waitcnt lgkmcnt(6)
    ds_read_b64_tr_b16 a[12:13], v4 offset:15360
    ds_read_b64_tr_b16 a[14:15], v4 offset:16640
    s_add_u32 s28, s40, 641280
    s_mov_b32 exec_lo, 0xfff0fff0
    s_mov_b32 exec_hi, 0xfff0fff0
    buffer_store_dwordx4 v[68:71], v56, s[16:19], s28 offen sc1
    s_mov_b64 exec, -1
    v_mfma_f32_32x32x16_bf16 a[128:143], a[28:31], v[252:255], a[128:143]
    s_waitcnt lgkmcnt(6)
    ds_read_b64_tr_b16 a[16:17], v4 offset:20480
    ds_read_b64_tr_b16 a[18:19], v4 offset:21760
    v_mfma_f32_32x32x16_bf16 a[64:79], a[0:3], v[192:195], a[64:79]
    s_waitcnt lgkmcnt(6)
    ds_read_b64_tr_b16 a[20:21], v4 offset:25600
    ds_read_b64_tr_b16 a[22:23], v4 offset:26880
    s_add_u32 s28, s40, 854272
    s_mov_b32 exec_lo, 0xfff0fff0
    s_mov_b32 exec_hi, 0xfff0fff0
    buffer_store_dwordx4 v[68:71], v56, s[16:19], s28 offen sc1
    s_mov_b64 exec, -1
    v_mfma_f32_32x32x16_bf16 a[64:79], a[4:7], v[196:199], a[64:79]
    s_waitcnt lgkmcnt(6)
    ds_read_b64_tr_b16 a[24:25], v4 offset:30720
    ds_read_b64_tr_b16 a[26:27], v4 offset:32000
    s_add_u32 s28, s40, 1067264
    s_mov_b32 exec_lo, 0xfff0fff0
    s_mov_b32 exec_hi, 0xfff0fff0
    buffer_store_dwordx4 v[68:71], v56, s[16:19], s28 offen sc1
    s_mov_b64 exec, -1
    v_mfma_f32_32x32x16_bf16 a[64:79], a[8:11], v[200:203], a[64:79]
    s_waitcnt lgkmcnt(6)
    ds_read_b64_tr_b16 a[28:29], v4 offset:35840
    ds_read_b64_tr_b16 a[30:31], v4 offset:37120
    v_mfma_f32_32x32x16_bf16 a[64:79], a[12:15], v[204:207], a[64:79]
    s_waitcnt lgkmcnt(6)
    ds_read_b64_tr_b16 a[0:1], v6 offset:0
    ds_read_b64_tr_b16 a[2:3], v6 offset:1280
    s_add_u32 s28, s40, 1280256
    s_mov_b32 exec_lo, 0xfff0fff0
    s_mov_b32 exec_hi, 0xfff0fff0
    buffer_store_dwordx4 v[68:71], v56, s[16:19], s28 offen sc1
    s_mov_b64 exec, -1
    v_mfma_f32_32x32x16_bf16 a[64:79], a[16:19], v[208:211], a[64:79]
    s_waitcnt lgkmcnt(6)
    ds_read_b64_tr_b16 a[4:5], v6 offset:5120
    ds_read_b64_tr_b16 a[6:7], v6 offset:6400
    s_add_u32 s28, s40, 1493248
    s_mov_b32 exec_lo, 0xfff0fff0
    s_mov_b32 exec_hi, 0xfff0fff0
    buffer_store_dwordx4 v[68:71], v56, s[16:19], s28 offen sc1
    s_mov_b64 exec, -1
    v_mfma_f32_32x32x16_bf16 a[64:79], a[20:23], v[212:215], a[64:79]
    s_waitcnt lgkmcnt(6)
    ds_read_b64_tr_b16 a[8:9], v6 offset:10240
    ds_read_b64_tr_b16 a[10:11], v6 offset:11520
    v_mfma_f32_32x32x16_bf16 a[64:79], a[24:27], v[216:219], a[64:79]
    s_waitcnt lgkmcnt(6)
    ds_read_b64_tr_b16 a[12:13], v6 offset:15360
    ds_read_b64_tr_b16 a[14:15], v6 offset:16640
    s_cmp_ge_u32 s50, 470
    s_cbranch_scc1 k1_vb
    buffer_store_dwordx4 v[144:147], v1, s[16:19], s39 offen offset:0 sc1
    buffer_store_dwordx4 v[148:151], v1, s[16:19], s39 offen offset:1024 sc1
    buffer_store_dwordx4 v[152:155], v1, s[16:19], s39 offen offset:2048 sc1
    buffer_store_dwordx4 v[156:159], v1, s[16:19], s39 offen offset:3072 sc1
k1_vb:
    v_mfma_f32_32x32x16_bf16 a[64:79], a[28:31], v[220:223], a[64:79]
    s_waitcnt lgkmcnt(6)
    ds_read_b64_tr_b16 a[16:17], v6 offset:20480
    ds_read_b64_tr_b16 a[18:19], v6 offset:21760
    v_mfma_f32_32x32x16_bf16 a[64:79], a[0:3], v[224:227], a[64:79]
    s_waitcnt lgkmcnt(6)
    ds_read_b64_tr_b16 a[20:21], v6 offset:25600
    ds_read_b64_tr_b16 a[22:23], v6 offset:26880
    s_add_u32 s29, s47, 0
    buffer_load_dwordx4 v[160:163], v57, s[16:19], s29 offen offset:0 sc1
    buffer_load_dwordx4 v[164:167], v57, s[16:19], s29 offen offset:2048 sc1
    v_mfma_f32_32x32x16_bf16 a[64:79], a[4:7], v[228:231], a[64:79]
    s_waitcnt lgkmcnt(6)
    ds_read_b64_tr_b16 a[24:25], v6 offset:30720
    ds_read_b64_tr_b16 a[26:27], v6 offset:32000
    s_add_u32 s29, s47, 4096
    buffer_load_dwordx4 v[168:171], v57, s[16:19], s29 offen offset:0 sc1
    buffer_load_dwordx4 v[172:175], v57, s[16:19], s29 offen offset:2048 sc1
    v_mfma_f32_32x32x16_bf16 a[64:79], a[8:11], v[232:235], a[64:79]
    s_waitcnt lgkmcnt(6)
    ds_read_b64_tr_b16 a[28:29], v6 offset:35840
    ds_read_b64_tr_b16 a[30:31], v6 offset:37120
    s_add_u32 s29, s47, 8192
    buffer_load_dwordx4 v[176:179], v57, s[16:19], s29 offen offset:0 sc1
    v_mfma_f32_32x32x16_bf16 a[64:79], a[12:15], v[236:239], a[64:79]
    s_waitcnt lgkmcnt(6)
    ds_read_b64_tr_b16 a[0:1], v4 offset:40
    ds_read_b64_tr_b16 a[2:3], v4 offset:1320
    buffer_load_dwordx4 v[180:183], v57, s[16:19], s29 offen offset:2048 sc1
    s_add_u32 s29, s47, 12288
    buffer_load_dwordx4 v[184:187], v57, s[16:19], s29 offen offset:0 sc1
    v_accvgpr_read_b32 v96, a128
    v_mfma_f32_32x32x16_bf16 a[64:79], a[16:19], v[240:243], a[64:79]
    s_waitcnt lgkmcnt(6)
    ds_read_b64_tr_b16 a[4:5], v4 offset:5160
    ds_read_b64_tr_b16 a[6:7], v4 offset:6440
    v_accvgpr_read_b32 v97, a129
    v_accvgpr_read_b32 v98, a130
    v_accvgpr_read_b32 v99, a131
    v_accvgpr_read_b32 v100, a132
    v_mfma_f32_32x32x16_bf16 a[64:79], a[20:23], v[244:247], a[64:79]
    s_waitcnt lgkmcnt(6)
    ds_read_b64_tr_b16 a[8:9], v4 offset:10280
    ds_read_b64_tr_b16 a[10:11], v4 offset:11560
    v_accvgpr_read_b32 v101, a133
    v_accvgpr_read_b32 v102, a134
    v_accvgpr_read_b32 v103, a135
    v_accvgpr_read_b32 v104, a136
    v_accvgpr_read_b32 v105, a137
    v_mfma_f32_32x32x16_bf16 a[64:79], a[24:27], v[248:251], a[64:79]
    s_waitcnt lgkmcnt(6)
    ds_read_b64_tr_b16 a[12:13], v4 offset:15400
    ds_read_b64_tr_b16 a[14:15], v4 offset:16680
    v_accvgpr_read_b32 v106, a138
    v_accvgpr_read_b32 v107, a139
    v_accvgpr_read_b32 v108, a140
    v_accvgpr_read_b32 v109, a141
    v_mfma_f32_32x32x16_bf16 a[64:79], a[28:31], v[252:255], a[64:79]
    s_waitcnt lgkmcnt(6)
    ds_read_b64_tr_b16 a[16:17], v4 offset:20520
    ds_read_b64_tr_b16 a[18:19], v4 offset:21800
    v_accvgpr_read_b32 v110, a142
    v_accvgpr_read_b32 v111, a143
    v_mul_f32 v96, v96, v63
    v_mul_f32 v97, v97, v63
    v_cvt_pk_bf16_f32 v112, v96, v97
    v_mfma_f32_32x32x16_bf16 a[80:95], a[0:3], v[192:195], a[80:95]
    s_waitcnt lgkmcnt(6)
    ds_read_b64_tr_b16 a[20:21], v4 offset:25640
    ds_read_b64_tr_b16 a[22:23], v4 offset:26920
    v_mul_f32 v98, v98, v63
    v_mul_f32 v99, v99, v63
    v_cvt_pk_bf16_f32 v113, v98, v99
    v_mul_f32 v100, v100, v63
    v_mfma_f32_32x32x16_bf16 a[80:95], a[4:7], v[196:199], a[80:95]
    s_waitcnt lgkmcnt(6)
    ds_read_b64_tr_b16 a[24:25], v4 offset:30760
    ds_read_b64_tr_b16 a[26:27], v4 offset:32040
    v_mul_f32 v101, v101, v63
    v_cvt_pk_bf16_f32 v114, v100, v101
    v_mul_f32 v102, v102, v63
    v_mul_f32 v103, v103, v63
    v_cvt_pk_bf16_f32 v115, v102, v103
    v_mfma_f32_32x32x16_bf16 a[80:95], a[8:11], v[200:203], a[80:95]
    s_waitcnt lgkmcnt(6)
    ds_read_b64_tr_b16 a[28:29], v4 offset:35880
    ds_read_b64_tr_b16 a[30:31], v4 offset:37160
    v_mul_f32 v104, v104, v63
    v_mul_f32 v105, v105, v63
    v_cvt_pk_bf16_f32 v116, v104, v105
    v_mul_f32 v106, v106, v63
    v_mfma_f32_32x32x16_bf16 a[80:95], a[12:15], v[204:207], a[80:95]
    s_waitcnt lgkmcnt(6)
    ds_read_b64_tr_b16 a[0:1], v6 offset:40
    ds_read_b64_tr_b16 a[2:3], v6 offset:1320
    v_mul_f32 v107, v107, v63
    v_cvt_pk_bf16_f32 v117, v106, v107
    v_mul_f32 v108, v108, v63
    v_mul_f32 v109, v109, v63
    v_cvt_pk_bf16_f32 v118, v108, v109
    v_mfma_f32_32x32x16_bf16 a[80:95], a[16:19], v[208:211], a[80:95]
    s_waitcnt lgkmcnt(6)
    ds_read_b64_tr_b16 a[4:5], v6 offset:5160
    ds_read_b64_tr_b16 a[6:7], v6 offset:6440
    v_mul_f32 v110, v110, v63
    v_mul_f32 v111, v111, v63
    v_cvt_pk_bf16_f32 v119, v110, v111
    v_mfma_f32_32x32x16_bf16 a[80:95], a[20:23], v[212:215], a[80:95]
    s_waitcnt lgkmcnt(6)
    ds_read_b64_tr_b16 a[8:9], v6 offset:10280
    ds_read_b64_tr_b16 a[10:11], v6 offset:11560
    ds_write_b64 v58, v[112:113] offset:4352
    ds_write_b64 v58, v[114:115] offset:4368
    ds_write_b64 v58, v[116:117] offset:4384
    v_mfma_f32_32x32x16_bf16 a[80:95], a[24:27], v[216:219], a[80:95]
    s_waitcnt lgkmcnt(6)
    ds_read_b64_tr_b16 a[12:13], v6 offset:15400
    ds_read_b64_tr_b16 a[14:15], v6 offset:16680
    ds_write_b64 v58, v[118:119] offset:4400
    ds_read_b64_tr_b16 v[128:129], v59 offset:4352
    v_mfma_f32_32x32x16_bf16 a[80:95], a[28:31], v[220:223], a[80:95]
    s_waitcnt lgkmcnt(6)
    ds_read_b64_tr_b16 a[16:17], v6 offset:20520
    ds_read_b64_tr_b16 a[18:19], v6 offset:21800
    ds_read_b64_tr_b16 v[130:131], v59 offset:4896
    ds_read_b64_tr_b16 v[132:133], v59 offset:6528
    v_mfma_f32_32x32x16_bf16 a[80:95], a[0:3], v[224:227], a[80:95]
    s_waitcnt lgkmcnt(6)
    ds_read_b64_tr_b16 a[20:21], v6 offset:25640
    ds_read_b64_tr_b16 a[22:23], v6 offset:26920
    ds_read_b64_tr_b16 v[134:135], v59 offset:7072
    v_accvgpr_read_b32 v96, a64
    v_accvgpr_read_b32 v97, a65
    v_accvgpr_read_b32 v98, a66
    v_mfma_f32_32x32x16_bf16 a[80:95], a[4:7], v[228:231], a[80:95]
    s_waitcnt lgkmcnt(6)
    ds_read_b64_tr_b16 a[24:25], v6 offset:30760
    ds_read_b64_tr_b16 a[26:27], v6 offset:32040
    v_accvgpr_read_b32 v99, a67
    v_accvgpr_read_b32 v100, a68
    v_accvgpr_read_b32 v101, a69
    v_accvgpr_read_b32 v102, a70
    v_accvgpr_read_b32 v103, a71
    v_mfma_f32_32x32x16_bf16 a[80:95], a[8:11], v[232:235], a[80:95]
    s_waitcnt lgkmcnt(6)
    ds_read_b64_tr_b16 a[28:29], v6 offset:35880
    ds_read_b64_tr_b16 a[30:31], v6 offset:37160
    v_accvgpr_read_b32 v104, a72
    v_accvgpr_read_b32 v105, a73
    v_accvgpr_read_b32 v106, a74
    v_accvgpr_read_b32 v107, a75
    v_mfma_f32_32x32x16_bf16 a[80:95], a[12:15], v[236:239], a[80:95]
    s_waitcnt lgkmcnt(6)
    ds_read_b64_tr_b16 a[0:1], v4 offset:80
    ds_read_b64_tr_b16 a[2:3], v4 offset:1360
    v_accvgpr_read_b32 v108, a76
    v_accvgpr_read_b32 v109, a77
    v_accvgpr_read_b32 v110, a78
    v_accvgpr_read_b32 v111, a79
    s_add_u32 s30, s40, 2304
    v_mfma_f32_32x32x16_bf16 a[80:95], a[16:19], v[240:243], a[80:95]
    s_waitcnt lgkmcnt(6)
    ds_read_b64_tr_b16 a[4:5], v4 offset:5200
    ds_read_b64_tr_b16 a[6:7], v4 offset:6480
    buffer_store_dwordx4 v[128:131], v65, s[16:19], s30 offen offset:0 sc1
    buffer_store_dwordx4 v[132:135], v65, s[16:19], s30 offen offset:1024 sc1
    v_mfma_f32_32x32x16_bf16 a[80:95], a[20:23], v[244:247], a[80:95]
    s_waitcnt lgkmcnt(6)
    ds_read_b64_tr_b16 a[8:9], v4 offset:10320
    ds_read_b64_tr_b16 a[10:11], v4 offset:11600
    v_mul_f32 v96, v96, v63
    v_mul_f32 v97, v97, v63
    v_cvt_pk_bf16_f32 v120, v96, v97
    v_mul_f32 v98, v98, v63
    v_mul_f32 v99, v99, v63
    v_mfma_f32_32x32x16_bf16 a[80:95], a[24:27], v[248:251], a[80:95]
    s_waitcnt lgkmcnt(6)
    ds_read_b64_tr_b16 a[12:13], v4 offset:15440
    ds_read_b64_tr_b16 a[14:15], v4 offset:16720
    v_cvt_pk_bf16_f32 v121, v98, v99
    v_mul_f32 v100, v100, v63
    v_mul_f32 v101, v101, v63
    v_cvt_pk_bf16_f32 v122, v100, v101
    v_mfma_f32_32x32x16_bf16 a[80:95], a[28:31], v[252:255], a[80:95]
    s_waitcnt lgkmcnt(6)
    ds_read_b64_tr_b16 a[16:17], v4 offset:20560
    ds_read_b64_tr_b16 a[18:19], v4 offset:21840
    v_mul_f32 v102, v102, v63
    v_mul_f32 v103, v103, v63
    v_cvt_pk_bf16_f32 v123, v102, v103
    v_mul_f32 v104, v104, v63
    v_mul_f32 v105, v105, v63
    v_mfma_f32_32x32x16_bf16 a[96:111], a[0:3], v[192:195], a[96:111]
    s_waitcnt lgkmcnt(6)
    ds_read_b64_tr_b16 a[20:21], v4 offset:25680
    ds_read_b64_tr_b16 a[22:23], v4 offset:26960
    v_cvt_pk_bf16_f32 v124, v104, v105
    v_mul_f32 v106, v106, v63
    v_mul_f32 v107, v107, v63
    v_cvt_pk_bf16_f32 v125, v106, v107
    v_mfma_f32_32x32x16_bf16 a[96:111], a[4:7], v[196:199], a[96:111]
    s_waitcnt lgkmcnt(6)
    ds_read_b64_tr_b16 a[24:25], v4 offset:30800
    ds_read_b64_tr_b16 a[26:27], v4 offset:32080
    v_mul_f32 v108, v108, v63
    v_mul_f32 v109, v109, v63
    v_cvt_pk_bf16_f32 v126, v108, v109
    v_mul_f32 v110, v110, v63
    v_mul_f32 v111, v111, v63
    v_mfma_f32_32x32x16_bf16 a[96:111], a[8:11], v[200:203], a[96:111]
    s_waitcnt lgkmcnt(6)
    ds_read_b64_tr_b16 a[28:29], v4 offset:35920
    ds_read_b64_tr_b16 a[30:31], v4 offset:37200
    v_cvt_pk_bf16_f32 v127, v110, v111
    ds_write_b64 v58, v[120:121] offset:4416
    v_mfma_f32_32x32x16_bf16 a[96:111], a[12:15], v[204:207], a[96:111]
    s_waitcnt lgkmcnt(6)
    ds_read_b64_tr_b16 a[0:1], v6 offset:80
    ds_read_b64_tr_b16 a[2:3], v6 offset:1360
    ds_write_b64 v58, v[122:123] offset:4432
    ds_write_b64 v58, v[124:125] offset:4448
    ds_write_b64 v58, v[126:127] offset:4464
    v_mfma_f32_32x32x16_bf16 a[96:111], a[16:19], v[208:211], a[96:111]
    s_waitcnt lgkmcnt(6)
    ds_read_b64_tr_b16 a[4:5], v6 offset:5200
    ds_read_b64_tr_b16 a[6:7], v6 offset:6480
    ds_read_b64_tr_b16 v[136:137], v59 offset:4416
    ds_read_b64_tr_b16 v[138:139], v59 offset:4960
    v_mfma_f32_32x32x16_bf16 a[96:111], a[20:23], v[212:215], a[96:111]
    s_waitcnt lgkmcnt(6)
    ds_read_b64_tr_b16 a[8:9], v6 offset:10320
    ds_read_b64_tr_b16 a[10:11], v6 offset:11600
    ds_read_b64_tr_b16 v[140:141], v59 offset:6592
    ds_read_b64_tr_b16 v[142:143], v59 offset:7136
    s_waitcnt vmcnt(2)
    v_mfma_f32_32x32x16_bf16 a[96:111], a[24:27], v[216:219], a[96:111]
    s_waitcnt lgkmcnt(6)
    ds_read_b64_tr_b16 a[12:13], v6 offset:15440
    ds_read_b64_tr_b16 a[14:15], v6 offset:16720
    v_cmp_eq_u64 s[54:55], s[48:49], v[162:163]
    s_and_b64 s[56:57], s[54:55], exec
    v_cmp_eq_u64 s[54:55], s[48:49], v[166:167]
    s_and_b64 s[56:57], s[54:55], s[56:57]
    v_mfma_f32_32x32x16_bf16 a[96:111], a[28:31], v[220:223], a[96:111]
    s_waitcnt lgkmcnt(6)
    ds_read_b64_tr_b16 a[16:17], v6 offset:20560
    ds_read_b64_tr_b16 a[18:19], v6 offset:21840
    v_cmp_eq_u64 s[54:55], s[48:49], v[170:171]
    s_and_b64 s[56:57], s[54:55], s[56:57]
    v_cmp_eq_u64 s[54:55], s[48:49], v[174:175]
    s_and_b64 s[56:57], s[54:55], s[56:57]
    v_mfma_f32_32x32x16_bf16 a[96:111], a[0:3], v[224:227], a[96:111]
    s_waitcnt lgkmcnt(6)
    ds_read_b64_tr_b16 a[20:21], v6 offset:25680
    ds_read_b64_tr_b16 a[22:23], v6 offset:26960
    v_cmp_eq_u64 s[54:55], s[48:49], v[178:179]
    s_and_b64 s[56:57], s[54:55], s[56:57]
    v_cmp_eq_u64 s[54:55], s[48:49], v[182:183]
    s_and_b64 s[56:57], s[54:55], s[56:57]
    v_mfma_f32_32x32x16_bf16 a[96:111], a[4:7], v[228:231], a[96:111]
    s_waitcnt lgkmcnt(6)
    ds_read_b64_tr_b16 a[24:25], v6 offset:30800
    ds_read_b64_tr_b16 a[26:27], v6 offset:32080
    v_cmp_eq_u64 s[54:55], s[48:49], v[186:187]
    s_and_b64 s[56:57], s[54:55], s[56:57]
    s_andn2_b64 s[56:57], exec, s[56:57]
    s_cbranch_scc1 k1_v_re
k1_v_got:
    v_add_f32 v160, v160, v164
    v_add_f32 v161, v161, v165
    v_mfma_f32_32x32x16_bf16 a[96:111], a[8:11], v[232:235], a[96:111]
    s_waitcnt lgkmcnt(6)
    ds_read_b64_tr_b16 a[28:29], v6 offset:35920
    ds_read_b64_tr_b16 a[30:31], v6 offset:37200
    v_add_f32 v160, v160, v168
    v_add_f32 v161, v161, v169
    v_add_f32 v160, v160, v172
    v_add_f32 v161, v161, v173
    v_mfma_f32_32x32x16_bf16 a[96:111], a[12:15], v[236:239], a[96:111]
    s_waitcnt lgkmcnt(6)
    ds_read_b64_tr_b16 a[0:1], v4 offset:120
    ds_read_b64_tr_b16 a[2:3], v4 offset:1400
    v_add_f32 v160, v160, v176
    v_add_f32 v161, v161, v177
    v_add_f32 v160, v160, v180
    v_add_f32 v161, v161, v181
    v_add_f32 v160, v160, v184
    v_mfma_f32_32x32x16_bf16 a[96:111], a[16:19], v[240:243], a[96:111]
    s_waitcnt lgkmcnt(6)
    ds_read_b64_tr_b16 a[4:5], v4 offset:5240
    ds_read_b64_tr_b16 a[6:7], v4 offset:6520
    v_add_f32 v161, v161, v185
    v_mov_b32 v162, v160
    v_mov_b32 v163, v161
    s_nop 1
    v_mfma_f32_32x32x16_bf16 a[96:111], a[20:23], v[244:247], a[96:111]
    s_waitcnt lgkmcnt(6)
    ds_read_b64_tr_b16 a[8:9], v4 offset:10360
    ds_read_b64_tr_b16 a[10:11], v4 offset:11640
    v_permlane32_swap_b32 v160, v162
    v_permlane32_swap_b32 v161, v163
    s_nop 0
    v_add_f32 v160, v160, v162
    v_add_f32 v161, v161, v163
    v_mfma_f32_32x32x16_bf16 a[96:111], a[24:27], v[248:251], a[96:111]
    s_waitcnt lgkmcnt(6)
    ds_read_b64_tr_b16 a[12:13], v4 offset:15480
    ds_read_b64_tr_b16 a[14:15], v4 offset:16760
    v_mul_f32 v160, 0x3a97b426, v160
    v_mul_f32 v161, 0x3a97b426, v161
    v_fma_f32 v161, -v160, v160, v161
    v_max_f32 v161, 0, v161
    v_mfma_f32_32x32x16_bf16 a[96:111], a[28:31], v[252:255], a[96:111]
    s_waitcnt lgkmcnt(6)
    ds_read_b64_tr_b16 a[16:17], v4 offset:20600
    ds_read_b64_tr_b16 a[18:19], v4 offset:21880
    v_cvt_pk_bf16_f32 v160, v160, v160
    v_lshlrev_b32 v160, 16, v160
    v_cvt_pk_bf16_f32 v161, v161, v161
    v_lshlrev_b32 v161, 16, v161
    v_add_f32 v161, 0x3727c5ac, v161
    v_mfma_f32_32x32x16_bf16 a[112:127], a[0:3], v[192:195], a[112:127]
    s_waitcnt lgkmcnt(6)
    ds_read_b64_tr_b16 a[20:21], v4 offset:25720
    ds_read_b64_tr_b16 a[22:23], v4 offset:27000
    v_cvt_pk_bf16_f32 v161, v161, v161
    v_lshlrev_b32 v161, 16, v161
    v_sqrt_f32 v161, v161
    v_mfma_f32_32x32x16_bf16 a[112:127], a[4:7], v[196:199], a[112:127]
    s_waitcnt lgkmcnt(6)
    ds_read_b64_tr_b16 a[24:25], v4 offset:30840
    ds_read_b64_tr_b16 a[26:27], v4 offset:32120
    s_nop 0
    v_cvt_pk_bf16_f32 v161, v161, v161
    v_lshlrev_b32 v161, 16, v161
    v_rcp_f32 v161, v161
    v_mfma_f32_32x32x16_bf16 a[112:127], a[8:11], v[200:203], a[112:127]
    s_waitcnt lgkmcnt(6)
    ds_read_b64_tr_b16 a[28:29], v4 offset:35960
    ds_read_b64_tr_b16 a[30:31], v4 offset:37240
    s_nop 0
    v_mul_f32 v160, v160, v161
    v_accvgpr_read_b32 v96, a80
    v_accvgpr_read_b32 v97, a81
    v_mfma_f32_32x32x16_bf16 a[112:127], a[12:15], v[204:207], a[112:127]
    s_waitcnt lgkmcnt(6)
    ds_read_b64_tr_b16 a[0:1], v6 offset:120
    ds_read_b64_tr_b16 a[2:3], v6 offset:1400
    v_accvgpr_read_b32 v98, a82
    v_accvgpr_read_b32 v99, a83
    v_accvgpr_read_b32 v100, a84
    v_accvgpr_read_b32 v101, a85
    v_accvgpr_read_b32 v102, a86
    v_mfma_f32_32x32x16_bf16 a[112:127], a[16:19], v[208:211], a[112:127]
    s_waitcnt lgkmcnt(6)
    ds_read_b64_tr_b16 a[4:5], v6 offset:5240
    ds_read_b64_tr_b16 a[6:7], v6 offset:6520
    v_accvgpr_read_b32 v103, a87
    v_accvgpr_read_b32 v104, a88
    v_accvgpr_read_b32 v105, a89
    v_accvgpr_read_b32 v106, a90
    v_mfma_f32_32x32x16_bf16 a[112:127], a[20:23], v[212:215], a[112:127]
    s_waitcnt lgkmcnt(6)
    ds_read_b64_tr_b16 a[8:9], v6 offset:10360
    ds_read_b64_tr_b16 a[10:11], v6 offset:11640
    v_accvgpr_read_b32 v107, a91
    v_accvgpr_read_b32 v108, a92
    v_accvgpr_read_b32 v109, a93
    v_accvgpr_read_b32 v110, a94
    v_accvgpr_read_b32 v111, a95
    v_mfma_f32_32x32x16_bf16 a[112:127], a[24:27], v[216:219], a[112:127]
    s_waitcnt lgkmcnt(6)
    ds_read_b64_tr_b16 a[12:13], v6 offset:15480
    ds_read_b64_tr_b16 a[14:15], v6 offset:16760
    s_add_u32 s30, s40, 2048
    buffer_store_dwordx4 v[136:139], v64, s[16:19], s30 offen offset:0 sc1
    v_mfma_f32_32x32x16_bf16 a[112:127], a[28:31], v[220:223], a[112:127]
    s_waitcnt lgkmcnt(6)
    ds_read_b64_tr_b16 a[16:17], v6 offset:20600
    ds_read_b64_tr_b16 a[18:19], v6 offset:21880
    buffer_store_dwordx4 v[140:143], v64, s[16:19], s30 offen offset:1024 sc1
    v_mul_f32 v96, v96, v63
    v_mul_f32 v97, v97, v63
    v_cvt_pk_bf16_f32 v112, v96, v97
    v_mul_f32 v98, v98, v63
    v_mfma_f32_32x32x16_bf16 a[112:127], a[0:3], v[224:227], a[112:127]
    s_waitcnt lgkmcnt(6)
    ds_read_b64_tr_b16 a[20:21], v6 offset:25720
    ds_read_b64_tr_b16 a[22:23], v6 offset:27000
    v_mul_f32 v99, v99, v63
    v_cvt_pk_bf16_f32 v113, v98, v99
    v_mul_f32 v100, v100, v63
    v_mul_f32 v101, v101, v63
    v_mfma_f32_32x32x16_bf16 a[112:127], a[4:7], v[228:231], a[112:127]
    s_waitcnt lgkmcnt(6)
    ds_read_b64_tr_b16 a[24:25], v6 offset:30840
    ds_read_b64_tr_b16 a[26:27], v6 offset:32120
    v_cvt_pk_bf16_f32 v114, v100, v101
    v_mul_f32 v102, v102, v63
    v_mul_f32 v103, v103, v63
    v_cvt_pk_bf16_f32 v115, v102, v103
    v_mul_f32 v104, v104, v63
    v_mfma_f32_32x32x16_bf16 a[112:127], a[8:11], v[232:235], a[112:127]
    s_waitcnt lgkmcnt(6)
    ds_read_b64_tr_b16 a[28:29], v6 offset:35960
    ds_read_b64_tr_b16 a[30:31], v6 offset:37240
    v_mul_f32 v105, v105, v63
    v_cvt_pk_bf16_f32 v116, v104, v105
    v_mul_f32 v106, v106, v63
    v_mul_f32 v107, v107, v63
    v_mfma_f32_32x32x16_bf16 a[112:127], a[12:15], v[236:239], a[112:127]
    s_waitcnt lgkmcnt(6)
    ds_read_b64_tr_b16 a[0:1], v6 offset:120
    ds_read_b64_tr_b16 a[2:3], v6 offset:1400
    v_cvt_pk_bf16_f32 v117, v106, v107
    v_mul_f32 v108, v108, v63
    v_mul_f32 v109, v109, v63
    v_cvt_pk_bf16_f32 v118, v108, v109
    v_mul_f32 v110, v110, v63
    v_mfma_f32_32x32x16_bf16 a[112:127], a[16:19], v[240:243], a[112:127]
    s_waitcnt lgkmcnt(6)
    ds_read_b64_tr_b16 a[4:5], v6 offset:5240
    ds_read_b64_tr_b16 a[6:7], v6 offset:6520
    v_mul_f32 v111, v111, v63
    v_cvt_pk_bf16_f32 v119, v110, v111
    ds_write_b64 v58, v[112:113] offset:4352
    v_mfma_f32_32x32x16_bf16 a[112:127], a[20:23], v[244:247], a[112:127]
    s_waitcnt lgkmcnt(6)
    ds_read_b64_tr_b16 a[8:9], v6 offset:10360
    ds_read_b64_tr_b16 a[10:11], v6 offset:11640
    ds_write_b64 v58, v[114:115] offset:4368
    ds_write_b64 v58, v[116:117] offset:4384
    v_mfma_f32_32x32x16_bf16 a[112:127], a[24:27], v[248:251], a[112:127]
    s_waitcnt lgkmcnt(6)
    ds_read_b64_tr_b16 a[12:13], v6 offset:15480
    ds_read_b64_tr_b16 a[14:15], v6 offset:16760
    ds_write_b64 v58, v[118:119] offset:4400
    ds_read_b64_tr_b16 v[128:129], v59 offset:4352
    v_mfma_f32_32x32x16_bf16 a[112:127], a[28:31], v[252:255], a[112:127]
    s_waitcnt lgkmcnt(6)
    ds_read_b64_tr_b16 a[16:17], v6 offset:20600
    ds_read_b64_tr_b16 a[18:19], v6 offset:21880
    ds_read_b64_tr_b16 v[130:131], v59 offset:4896
    ds_read_b64_tr_b16 v[132:133], v59 offset:6528
    ds_read_b64_tr_b16 v[134:135], v59 offset:7072
    v_fma_f32 v16, v16, v161, -v160
    v_fma_f32 v17, v17, v161, -v160
    v_fma_f32 v18, v18, v161, -v160
    v_fma_f32 v19, v19, v161, -v160
    v_cvt_pk_bf16_f32 v16, v16, v17
    v_cvt_pk_bf16_f32 v17, v18, v19
    ds_write_b64 v58, v[16:17] offset:0
    v_fma_f32 v20, v20, v161, -v160
    v_fma_f32 v21, v21, v161, -v160
    v_fma_f32 v22, v22, v161, -v160
    v_fma_f32 v23, v23, v161, -v160
    v_cvt_pk_bf16_f32 v20, v20, v21
    v_cvt_pk_bf16_f32 v21, v22, v23
    ds_write_b64 v58, v[20:21] offset:16
    v_fma_f32 v24, v24, v161, -v160
    v_fma_f32 v25, v25, v161, -v160
    v_fma_f32 v26, v26, v161, -v160
    v_fma_f32 v27, v27, v161, -v160
    v_cvt_pk_bf16_f32 v24, v24, v25
    v_cvt_pk_bf16_f32 v25, v26, v27
    ds_write_b64 v58, v[24:25] offset:32
    v_fma_f32 v28, v28, v161, -v160
    v_fma_f32 v29, v29, v161, -v160
    v_fma_f32 v30, v30, v161, -v160
    v_fma_f32 v31, v31, v161, -v160
    v_cvt_pk_bf16_f32 v28, v28, v29
    v_cvt_pk_bf16_f32 v29, v30, v31
    ds_write_b64 v58, v[28:29] offset:48
    ds_read_b64_tr_b16 v[168:169], v59 offset:0
    ds_read_b64_tr_b16 v[170:171], v59 offset:544
    ds_read_b64_tr_b16 v[172:173], v59 offset:2176
    ds_read_b64_tr_b16 v[174:175], v59 offset:2720
    s_nop 7
    v_accvgpr_read_b32 v96, a96
    v_accvgpr_read_b32 v97, a97
    v_accvgpr_read_b32 v98, a98
    v_accvgpr_read_b32 v99, a99
    v_accvgpr_read_b32 v100, a100
    v_accvgpr_read_b32 v101, a101
    v_accvgpr_read_b32 v102, a102
    v_accvgpr_read_b32 v103, a103
    v_accvgpr_read_b32 v104, a104
    v_accvgpr_read_b32 v105, a105
    v_accvgpr_read_b32 v106, a106
    v_accvgpr_read_b32 v107, a107
    v_accvgpr_read_b32 v108, a108
    v_accvgpr_read_b32 v109, a109
    v_accvgpr_read_b32 v110, a110
    v_accvgpr_read_b32 v111, a111
    s_add_u32 s30, s40, 215040
    buffer_store_dwordx4 v[128:131], v64, s[16:19], s30 offen offset:0 sc1
    buffer_store_dwordx4 v[132:135], v64, s[16:19], s30 offen offset:1024 sc1
    buffer_store_dwordx4 v[168:171], v1, s[16:19], s42 offen offset:0 sc1
    buffer_store_dwordx4 v[172:175], v1, s[16:19], s42 offen offset:1024 sc1
    v_mul_f32 v96, v96, v63
    v_mul_f32 v97, v97, v63
    v_cvt_pk_bf16_f32 v120, v96, v97
    v_mul_f32 v98, v98, v63
    v_mul_f32 v99, v99, v63
    v_cvt_pk_bf16_f32 v121, v98, v99
    v_mul_f32 v100, v100, v63
    v_mul_f32 v101, v101, v63
    v_cvt_pk_bf16_f32 v122, v100, v101
    v_mul_f32 v102, v102, v63
    v_mul_f32 v103, v103, v63
    v_cvt_pk_bf16_f32 v123, v102, v103
    v_mul_f32 v104, v104, v63
    v_mul_f32 v105, v105, v63
    v_cvt_pk_bf16_f32 v124, v104, v105
    v_mul_f32 v106, v106, v63
    v_mul_f32 v107, v107, v63
    v_cvt_pk_bf16_f32 v125, v106, v107
    v_mul_f32 v108, v108, v63
    v_mul_f32 v109, v109, v63
    v_cvt_pk_bf16_f32 v126, v108, v109
    v_mul_f32 v110, v110, v63
    v_mul_f32 v111, v111, v63
    v_cvt_pk_bf16_f32 v127, v110, v111
    ds_write_b64 v58, v[120:121] offset:4416
    ds_write_b64 v58, v[122:123] offset:4432
    ds_write_b64 v58, v[124:125] offset:4448
    ds_write_b64 v58, v[126:127] offset:4464
    ds_read_b64_tr_b16 v[136:137], v59 offset:4416
    ds_read_b64_tr_b16 v[138:139], v59 offset:4960
    ds_read_b64_tr_b16 v[140:141], v59 offset:6592
    ds_read_b64_tr_b16 v[142:143], v59 offset:7136
    v_fma_f32 v32, v32, v161, -v160
    v_fma_f32 v33, v33, v161, -v160
    v_fma_f32 v34, v34, v161, -v160
    v_fma_f32 v35, v35, v161, -v160
    v_cvt_pk_bf16_f32 v32, v32, v33
    v_cvt_pk_bf16_f32 v33, v34, v35
    ds_write_b64 v58, v[32:33] offset:64
    v_fma_f32 v36, v36, v161, -v160
    v_fma_f32 v37, v37, v161, -v160
    v_fma_f32 v38, v38, v161, -v160
    v_fma_f32 v39, v39, v161, -v160
    v_cvt_pk_bf16_f32 v36, v36, v37
    v_cvt_pk_bf16_f32 v37, v38, v39
    ds_write_b64 v58, v[36:37] offset:80
    v_fma_f32 v40, v40, v161, -v160
    v_fma_f32 v41, v41, v161, -v160
    v_fma_f32 v42, v42, v161, -v160
    v_fma_f32 v43, v43, v161, -v160
    v_cvt_pk_bf16_f32 v40, v40, v41
    v_cvt_pk_bf16_f32 v41, v42, v43
    ds_write_b64 v58, v[40:41] offset:96
    v_fma_f32 v44, v44, v161, -v160
    v_fma_f32 v45, v45, v161, -v160
    v_fma_f32 v46, v46, v161, -v160
    v_fma_f32 v47, v47, v161, -v160
    v_cvt_pk_bf16_f32 v44, v44, v45
    v_cvt_pk_bf16_f32 v45, v46, v47
    ds_write_b64 v58, v[44:45] offset:112
    ds_read_b64_tr_b16 v[176:177], v59 offset:64
    ds_read_b64_tr_b16 v[178:179], v59 offset:608
    ds_read_b64_tr_b16 v[180:181], v59 offset:2240
    ds_read_b64_tr_b16 v[182:183], v59 offset:2784
    s_nop 7
    v_accvgpr_read_b32 v96, a112
    v_accvgpr_read_b32 v97, a113
    v_accvgpr_read_b32 v98, a114
    v_accvgpr_read_b32 v99, a115
    v_accvgpr_read_b32 v100, a116
    v_accvgpr_read_b32 v101, a117
    v_accvgpr_read_b32 v102, a118
    v_accvgpr_read_b32 v103, a119
    v_accvgpr_read_b32 v104, a120
    v_accvgpr_read_b32 v105, a121
    v_accvgpr_read_b32 v106, a122
    v_accvgpr_read_b32 v107, a123
    v_accvgpr_read_b32 v108, a124
    v_accvgpr_read_b32 v109, a125
    v_accvgpr_read_b32 v110, a126
    v_accvgpr_read_b32 v111, a127
    s_waitcnt lgkmcnt(0)
    s_add_u32 s30, s40, 428032
    buffer_store_dwordx4 v[136:139], v64, s[16:19], s30 offen offset:0 sc1
    buffer_store_dwordx4 v[140:143], v64, s[16:19], s30 offen offset:1024 sc1
    buffer_store_dwordx4 v[176:179], v1, s[16:19], s43 offen offset:0 sc1
    buffer_store_dwordx4 v[180:183], v1, s[16:19], s43 offen offset:1024 sc1
    v_mul_f32 v96, v96, v63
    v_mul_f32 v97, v97, v63
    v_cvt_pk_bf16_f32 v112, v96, v97
    v_mul_f32 v98, v98, v63
    v_mul_f32 v99, v99, v63
    v_cvt_pk_bf16_f32 v113, v98, v99
    v_mul_f32 v100, v100, v63
    v_mul_f32 v101, v101, v63
    v_cvt_pk_bf16_f32 v114, v100, v101
    v_mul_f32 v102, v102, v63
    v_mul_f32 v103, v103, v63
    v_cvt_pk_bf16_f32 v115, v102, v103
    v_mul_f32 v104, v104, v63
    v_mul_f32 v105, v105, v63
    v_cvt_pk_bf16_f32 v116, v104, v105
    v_mul_f32 v106, v106, v63
    v_mul_f32 v107, v107, v63
    v_cvt_pk_bf16_f32 v117, v106, v107
    v_mul_f32 v108, v108, v63
    v_mul_f32 v109, v109, v63
    v_cvt_pk_bf16_f32 v118, v108, v109
    v_mul_f32 v110, v110, v63
    v_mul_f32 v111, v111, v63
    v_cvt_pk_bf16_f32 v119, v110, v111
    ds_write_b64 v58, v[112:113] offset:4352
    ds_write_b64 v58, v[114:115] offset:4368
    ds_write_b64 v58, v[116:117] offset:4384
    ds_write_b64 v58, v[118:119] offset:4400
    ds_read_b64_tr_b16 v[128:129], v59 offset:4352
    ds_read_b64_tr_b16 v[130:131], v59 offset:4896
    ds_read_b64_tr_b16 v[132:133], v59 offset:6528
    ds_read_b64_tr_b16 v[134:135], v59 offset:7072
    s_waitcnt lgkmcnt(0)
    s_add_u32 s30, s40, 641024
    buffer_store_dwordx4 v[128:131], v64, s[16:19], s30 offen offset:0 sc1
    buffer_store_dwordx4 v[132:135], v64, s[16:19], s30 offen offset:1024 sc1
k1_fin:
    s_cmp_ge_u32 s51, 32
    s_cbranch_scc1 k1_f2
    s_lshl_b32 s28, s51, 12
    s_add_u32 s28, s28, 0x1E80000
    v_lshlrev_b32 v2, 6, v0
    v_mov_b32 v3, 0
    buffer_store_dword v3, v2, s[16:19], s28 offen
k1_f2:
k1_end:
    s_endpgm
k1_q_re:
    s_mov_b32 s46, 0x100000
k1_q_r2:
    s_add_u32 s29, s47, 0
    buffer_load_dwordx4 v[160:163], v57, s[16:19], s29 offen offset:0 sc1
    buffer_load_dwordx4 v[164:167], v57, s[16:19], s29 offen offset:2048 sc1
    s_add_u32 s29, s47, 4096
    buffer_load_dwordx4 v[168:171], v57, s[16:19], s29 offen offset:0 sc1
    buffer_load_dwordx4 v[172:175], v57, s[16:19], s29 offen offset:2048 sc1
    s_add_u32 s29, s47, 8192
    buffer_load_dwordx4 v[176:179], v57, s[16:19], s29 offen offset:0 sc1
    buffer_load_dwordx4 v[180:183], v57, s[16:19], s29 offen offset:2048 sc1
    s_add_u32 s29, s47, 12288
    buffer_load_dwordx4 v[184:187], v57, s[16:19], s29 offen offset:0 sc1
    s_waitcnt vmcnt(0)
    v_cmp_eq_u64 s[54:55], s[48:49], v[162:163]
    s_and_b64 s[56:57], s[54:55], exec
    v_cmp_eq_u64 s[54:55], s[48:49], v[166:167]
    s_and_b64 s[56:57], s[54:55], s[56:57]
    v_cmp_eq_u64 s[54:55], s[48:49], v[170:171]
    s_and_b64 s[56:57], s[54:55], s[56:57]
    v_cmp_eq_u64 s[54:55], s[48:49], v[174:175]
    s_and_b64 s[56:57], s[54:55], s[56:57]
    v_cmp_eq_u64 s[54:55], s[48:49], v[178:179]
    s_and_b64 s[56:57], s[54:55], s[56:57]
    v_cmp_eq_u64 s[54:55], s[48:49], v[182:183]
    s_and_b64 s[56:57], s[54:55], s[56:57]
    v_cmp_eq_u64 s[54:55], s[48:49], v[186:187]
    s_and_b64 s[56:57], s[54:55], s[56:57]
    s_andn2_b64 s[56:57], exec, s[56:57]
    s_cbranch_scc0 k1_q_got
    s_sub_u32 s46, s46, 1
    s_cbranch_scc0 k1_q_r2
    s_branch k1_q_got
k1_v_re:
    s_mov_b32 s46, 0x100000
k1_v_r2:
    s_add_u32 s29, s47, 0
    buffer_load_dwordx4 v[160:163], v57, s[16:19], s29 offen offset:0 sc1
    buffer_load_dwordx4 v[164:167], v57, s[16:19], s29 offen offset:2048 sc1
    s_add_u32 s29, s47, 4096
    buffer_load_dwordx4 v[168:171], v57, s[16:19], s29 offen offset:0 sc1
    buffer_load_dwordx4 v[172:175], v57, s[16:19], s29 offen offset:2048 sc1
    s_add_u32 s29, s47, 8192
    buffer_load_dwordx4 v[176:179], v57, s[16:19], s29 offen offset:0 sc1
    buffer_load_dwordx4 v[180:183], v57, s[16:19], s29 offen offset:2048 sc1
    s_add_u32 s29, s47, 12288
    buffer_load_dwordx4 v[184:187], v57, s[16:19], s29 offen offset:0 sc1
    s_waitcnt vmcnt(0)
    v_cmp_eq_u64 s[54:55], s[48:49], v[162:163]
    s_and_b64 s[56:57], s[54:55], exec
    v_cmp_eq_u64 s[54:55], s[48:49], v[166:167]
    s_and_b64 s[56:57], s[54:55], s[56:57]
    v_cmp_eq_u64 s[54:55], s[48:49], v[170:171]
    s_and_b64 s[56:57], s[54:55], s[56:57]
    v_cmp_eq_u64 s[54:55], s[48:49], v[174:175]
    s_and_b64 s[56:57], s[54:55], s[56:57]
    v_cmp_eq_u64 s[54:55], s[48:49], v[178:179]
    s_and_b64 s[56:57], s[54:55], s[56:57]
    v_cmp_eq_u64 s[54:55], s[48:49], v[182:183]
    s_and_b64 s[56:57], s[54:55], s[56:57]
    v_cmp_eq_u64 s[54:55], s[48:49], v[186:187]
    s_and_b64 s[56:57], s[54:55], s[56:57]
    s_andn2_b64 s[56:57], exec, s[56:57]
    s_cbranch_scc0 k1_v_got
    s_sub_u32 s46, s46, 1
    s_cbranch_scc0 k1_v_r2
    s_branch k1_v_got
k1_b_re:
    s_mov_b32 s46, 0x100000
k1_b_r2:
    s_add_u32 s29, s47, 0
    buffer_load_dwordx4 v[160:163], v57, s[16:19], s29 offen offset:0 sc1
    buffer_load_dwordx4 v[164:167], v57, s[16:19], s29 offen offset:2048 sc1
    s_add_u32 s29, s47, 4096
    buffer_load_dwordx4 v[168:171], v57, s[16:19], s29 offen offset:0 sc1
    buffer_load_dwordx4 v[172:175], v57, s[16:19], s29 offen offset:2048 sc1
    s_add_u32 s29, s47, 8192
    buffer_load_dwordx4 v[176:179], v57, s[16:19], s29 offen offset:0 sc1
    buffer_load_dwordx4 v[180:183], v57, s[16:19], s29 offen offset:2048 sc1
    s_add_u32 s29, s47, 12288
    buffer_load_dwordx4 v[184:187], v57, s[16:19], s29 offen offset:0 sc1
    s_waitcnt vmcnt(0)
    v_cmp_eq_u64 s[54:55], s[48:49], v[162:163]
    s_and_b64 s[56:57], s[54:55], exec
    v_cmp_eq_u64 s[54:55], s[48:49], v[166:167]
    s_and_b64 s[56:57], s[54:55], s[56:57]
    v_cmp_eq_u64 s[54:55], s[48:49], v[170:171]
    s_and_b64 s[56:57], s[54:55], s[56:57]
    v_cmp_eq_u64 s[54:55], s[48:49], v[174:175]
    s_and_b64 s[56:57], s[54:55], s[56:57]
    v_cmp_eq_u64 s[54:55], s[48:49], v[178:179]
    s_and_b64 s[56:57], s[54:55], s[56:57]
    v_cmp_eq_u64 s[54:55], s[48:49], v[182:183]
    s_and_b64 s[56:57], s[54:55], s[56:57]
    v_cmp_eq_u64 s[54:55], s[48:49], v[186:187]
    s_and_b64 s[56:57], s[54:55], s[56:57]
    s_andn2_b64 s[56:57], exec, s[56:57]
    s_cbranch_scc0 k1_b_got
    s_sub_u32 s46, s46, 1
    s_cbranch_scc0 k1_b_r2
    s_branch k1_b_got
k1_na_sp:
    s_mov_b32 s46, 0x100000
k1_na_s2:
    s_lshl_b32 s29, s25, 4
    buffer_load_dword v92, off, s[20:23], s29 sc1
    s_waitcnt vmcnt(0)
    v_readfirstlane_b32 s48, v92
    s_cmp_lg_u32 s48, 0
    s_cbranch_scc1 k1_na_bk
    s_sub_u32 s46, s46, 1
    s_cbranch_scc0 k1_na_s2
    s_branch k1_na_bk
k1_nb_sp:
    s_mov_b32 s46, 0x100000
k1_nb_s2:
    s_lshl_b32 s29, s25, 4
    buffer_load_dword v92, off, s[20:23], s29 sc1
    s_waitcnt vmcnt(0)
    v_readfirstlane_b32 s48, v92
    s_cmp_lg_u32 s48, 0
    s_cbranch_scc1 k1_nb_bk
    s_sub_u32 s46, s46, 1
    s_cbranch_scc0 k1_nb_s2
    s_branch k1_nb_bk
k1_nc_sp:
    s_mov_b32 s46, 0x100000
k1_nc_s2:
    s_lshl_b32 s29, s25, 4
    buffer_load_dword v92, off, s[20:23], s29 sc1
    s_waitcnt vmcnt(0)
    v_readfirstlane_b32 s48, v92
    s_cmp_lg_u32 s48, 0
    s_cbranch_scc1 k1_nc_bk
    s_sub_u32 s46, s46, 1
    s_cbranch_scc0 k1_nc_s2
    s_branch k1_nc_bk
k1_B:
    s_lshl_b32 s26, s29, 1
    s_add_u32 s26, s26, s28
    s_sub_u32 s26, s26, 6
    s_mul_i32 s45, s26, 0x04040404
    s_sub_u32 s45, s45, 0x00010203
    s_cmp_eq_u32 s26, 0
    s_cselect_b32 s33, 2, 3
    s_cselect_b32 s45, 0x0d0e, s45
    s_add_u32 s41, s35, 20480
    s_mov_b32 s50, s38
    s_and_b32 s28, s45, 0xff
    s_lshl_b32 s28, s28, 7
    s_add_u32 s38, s50, s28
    s_add_u32 s39, s38, 1105920
    s_bfe_u32 s28, s45, 0x80008
    s_lshl_b32 s28, s28, 7
    s_add_u32 s40, s50, s28
    s_add_u32 s44, s40, 1105920
    v_and_b32 v24, 31, v0
    v_lshrrev_b32 v25, 5, v0
    v_and_b32 v26, 15, v0
    v_xor_b32 v26, v26, v25
    v_lshlrev_b32 v26, 4, v26
    v_lshl_add_u32 v26, v24, 8, v26
    v_add_u32 v16, s27, v26
    v_lshrrev_b32 v25, 3, v24
    v_mul_u32_u24 v25, 38912, v25
    v_add_u32 v25, 8192, v25
    v_mov_b32 v27, 0x3f803f80
    v_xor_b32 v17, 32, v16
    v_xor_b32 v18, 64, v16
    v_xor_b32 v19, 96, v16
    v_xor_b32 v20, 128, v16
    v_xor_b32 v21, 160, v16
    v_xor_b32 v22, 192, v16
    v_xor_b32 v23, 224, v16
    v_add_u32 v32, v25, v16
    v_add_u32 v40, 81920, v16
    v_add_u32 v33, v25, v17
    v_add_u32 v41, 81920, v17
    v_add_u32 v34, v25, v18
    v_add_u32 v42, 81920, v18
    v_add_u32 v35, v25, v19
    v_add_u32 v43, 81920, v19
    v_add_u32 v36, v25, v20
    v_add_u32 v44, 81920, v20
    v_add_u32 v37, v25, v21
    v_add_u32 v45, 81920, v21
    v_add_u32 v38, v25, v22
    v_add_u32 v46, 81920, v22
    v_add_u32 v39, v25, v23
    v_add_u32 v47, 81920, v23
    v_lshrrev_b32 v48, 2, v0
    v_lshrrev_b32 v49, 5, v0
    v_xor_b32 v48, v48, v49
    v_and_b32 v48, 1, v48
    v_lshlrev_b32 v48, 4, v48
    v_bfe_u32 v49, v0, 1, 1
    v_bfe_u32 v50, v0, 3, 2
    v_lshl_add_u32 v49, v50, 1, v49
    v_add_u32 v48, v48, v49
    v_and_b32 v49, 1, v0
    v_lshlrev_b32 v49, 4, v49
    v_mov_b32 v50, 0x3f80
    v_lshlrev_b32 v49, v49, v50
    v_cmp_eq_u32 s[60:61], 0, v48
    v_cmp_eq_u32 s[62:63], 1, v48
    v_cmp_eq_u32 s[64:65], 2, v48
    v_cmp_eq_u32 s[66:67], 3, v48
    v_cmp_eq_u32 s[68:69], 4, v48
    v_cmp_eq_u32 s[70:71], 5, v48
    v_cmp_eq_u32 s[72:73], 6, v48
    v_cmp_eq_u32 s[74:75], 7, v48
    v_mov_b32 v88, 0
    v_mov_b32 v89, 0
    v_mov_b32 v90, 0
    v_mov_b32 v91, 0
    v_cndmask_b32 v80, 0, v49, s[60:61]
    v_cndmask_b32 v81, 0, v49, s[62:63]
    v_cndmask_b32 v82, 0, v49, s[64:65]
    v_cndmask_b32 v83, 0, v49, s[66:67]
    v_cndmask_b32 v84, 0, v49, s[68:69]
    v_cndmask_b32 v85, 0, v49, s[70:71]
    v_cndmask_b32 v86, 0, v49, s[72:73]
    v_cndmask_b32 v87, 0, v49, s[74:75]
    s_add_u32 m0, s27, 0
    s_add_u32 s30, s34, 0
    buffer_load_dwordx4 v28, s[4:7], s30 offen lds
    s_add_u32 m0, s27, 1024
    s_add_u32 s30, s34, 5120
    buffer_load_dwordx4 v29, s[4:7], s30 offen lds
    s_add_u32 m0, s27, 2048
    s_add_u32 s30, s34, 10240
    buffer_load_dwordx4 v30, s[4:7], s30 offen lds
    s_add_u32 m0, s27, 3072
    s_add_u32 s30, s34, 15360
    buffer_load_dwordx4 v31, s[4:7], s30 offen lds
    s_add_u32 m0, s27, 4096
    s_add_u32 s30, s34, 20480
    buffer_load_dwordx4 v28, s[4:7], s30 offen lds
    s_add_u32 m0, s27, 5120
    s_add_u32 s30, s34, 25600
    buffer_load_dwordx4 v29, s[4:7], s30 offen lds
    s_add_u32 m0, s27, 6144
    s_add_u32 s30, s34, 30720
    buffer_load_dwordx4 v30, s[4:7], s30 offen lds
    s_add_u32 m0, s27, 7168
    s_add_u32 s30, s34, 35840
    buffer_load_dwordx4 v31, s[4:7], s30 offen lds
    s_waitcnt vmcnt(8)
    ds_read_b128 v[224:227], v32 offset:0
    ds_read_b128 v[228:231], v33 offset:0
    ds_read_b128 v[232:235], v34 offset:0
    ds_read_b128 v[236:239], v35 offset:0
    ds_read_b128 v[240:243], v36 offset:0
    ds_read_b128 v[244:247], v37 offset:0
    ds_read_b128 v[248:251], v38 offset:0
    ds_read_b128 v[252:255], v39 offset:0
    s_waitcnt lgkmcnt(0)
    s_add_u32 m0, s27, 40960
    s_add_u32 s30, s34, 256
    buffer_load_dwordx4 v28, s[4:7], s30 offen lds
    v_dot2_f32_bf16 v88, v224, v27, v88
    v_dot2_f32_bf16 v89, v224, v224, v89
    v_dot2_f32_bf16 v90, v225, v27, v90
    v_dot2_f32_bf16 v91, v225, v225, v91
    v_dot2_f32_bf16 v88, v226, v27, v88
    v_dot2_f32_bf16 v89, v226, v226, v89
    v_dot2_f32_bf16 v90, v227, v27, v90
    v_dot2_f32_bf16 v91, v227, v227, v91
    s_add_u32 m0, s27, 41984
    s_add_u32 s30, s34, 5376
    buffer_load_dwordx4 v29, s[4:7], s30 offen lds
    v_dot2_f32_bf16 v88, v228, v27, v88
    v_dot2_f32_bf16 v89, v228, v228, v89
    v_dot2_f32_bf16 v90, v229, v27, v90
    v_dot2_f32_bf16 v91, v229, v229, v91
    v_dot2_f32_bf16 v88, v230, v27, v88
    v_dot2_f32_bf16 v89, v230, v230, v89
    v_dot2_f32_bf16 v90, v231, v27, v90
    v_dot2_f32_bf16 v91, v231, v231, v91
    s_add_u32 m0, s27, 43008
    s_add_u32 s30, s34, 10496
    buffer_load_dwordx4 v30, s[4:7], s30 offen lds
    v_dot2_f32_bf16 v88, v232, v27, v88
    v_dot2_f32_bf16 v89, v232, v232, v89
    v_dot2_f32_bf16 v90, v233, v27, v90
    v_dot2_f32_bf16 v91, v233, v233, v91
    v_dot2_f32_bf16 v88, v234, v27, v88
    v_dot2_f32_bf16 v89, v234, v234, v89
    v_dot2_f32_bf16 v90, v235, v27, v90
    v_dot2_f32_bf16 v91, v235, v235, v91
    s_add_u32 m0, s27, 44032
    s_add_u32 s30, s34, 15616
    buffer_load_dwordx4 v31, s[4:7], s30 offen lds
    v_dot2_f32_bf16 v88, v236, v27, v88
    v_dot2_f32_bf16 v89, v236, v236, v89
    v_dot2_f32_bf16 v90, v237, v27, v90
    v_dot2_f32_bf16 v91, v237, v237, v91
    v_dot2_f32_bf16 v88, v238, v27, v88
    v_dot2_f32_bf16 v89, v238, v238, v89
    v_dot2_f32_bf16 v90, v239, v27, v90
    v_dot2_f32_bf16 v91, v239, v239, v91
    s_add_u32 m0, s27, 45056
    s_add_u32 s30, s34, 20736
    buffer_load_dwordx4 v28, s[4:7], s30 offen lds
    v_dot2_f32_bf16 v88, v240, v27, v88
    v_dot2_f32_bf16 v89, v240, v240, v89
    v_dot2_f32_bf16 v90, v241, v27, v90
    v_dot2_f32_bf16 v91, v241, v241, v91
    v_dot2_f32_bf16 v88, v242, v27, v88
    v_dot2_f32_bf16 v89, v242, v242, v89
    v_dot2_f32_bf16 v90, v243, v27, v90
    v_dot2_f32_bf16 v91, v243, v243, v91
    s_add_u32 m0, s27, 46080
    s_add_u32 s30, s34, 25856
    buffer_load_dwordx4 v29, s[4:7], s30 offen lds
    v_dot2_f32_bf16 v88, v244, v27, v88
    v_dot2_f32_bf16 v89, v244, v244, v89
    v_dot2_f32_bf16 v90, v245, v27, v90
    v_dot2_f32_bf16 v91, v245, v245, v91
    v_dot2_f32_bf16 v88, v246, v27, v88
    v_dot2_f32_bf16 v89, v246, v246, v89
    v_dot2_f32_bf16 v90, v247, v27, v90
    v_dot2_f32_bf16 v91, v247, v247, v91
    s_add_u32 m0, s27, 47104
    s_add_u32 s30, s34, 30976
    buffer_load_dwordx4 v30, s[4:7], s30 offen lds
    v_dot2_f32_bf16 v88, v248, v27, v88
    v_dot2_f32_bf16 v89, v248, v248, v89
    v_dot2_f32_bf16 v90, v249, v27, v90
    v_dot2_f32_bf16 v91, v249, v249, v91
    v_dot2_f32_bf16 v88, v250, v27, v88
    v_dot2_f32_bf16 v89, v250, v250, v89
    v_dot2_f32_bf16 v90, v251, v27, v90
    v_dot2_f32_bf16 v91, v251, v251, v91
    s_add_u32 m0, s27, 48128
    s_add_u32 s30, s34, 36096
    buffer_load_dwordx4 v31, s[4:7], s30 offen lds
    v_dot2_f32_bf16 v88, v252, v27, v88
    v_dot2_f32_bf16 v89, v252, v252, v89
    v_dot2_f32_bf16 v90, v253, v27, v90
    v_dot2_f32_bf16 v91, v253, v253, v91
    v_dot2_f32_bf16 v88, v254, v27, v88
    v_dot2_f32_bf16 v89, v254, v254, v89
    v_dot2_f32_bf16 v90, v255, v27, v90
    v_dot2_f32_bf16 v91, v255, v255, v91
    s_waitcnt vmcnt(8)
    ds_read_b128 v[96:99], v16 offset:0
    ds_read_b128 v[100:103], v17 offset:0
    ds_read_b128 v[104:107], v18 offset:0
    ds_read_b128 v[108:111], v19 offset:0
    ds_read_b128 v[112:115], v20 offset:0
    ds_read_b128 v[116:119], v21 offset:0
    ds_read_b128 v[120:123], v22 offset:0
    ds_read_b128 v[124:127], v23 offset:0
    s_waitcnt lgkmcnt(0)
    s_add_u32 m0, s27, 81920
    s_add_u32 s30, s34, 512
    buffer_load_dwordx4 v28, s[4:7], s30 offen lds
    v_dot2_f32_bf16 v88, v96, v27, v88
    v_dot2_f32_bf16 v89, v96, v96, v89
    v_dot2_f32_bf16 v90, v97, v27, v90
    v_dot2_f32_bf16 v91, v97, v97, v91
    v_dot2_f32_bf16 v88, v98, v27, v88
    v_dot2_f32_bf16 v89, v98, v98, v89
    v_dot2_f32_bf16 v90, v99, v27, v90
    v_dot2_f32_bf16 v91, v99, v99, v91
    s_add_u32 m0, s27, 82944
    s_add_u32 s30, s34, 5632
    buffer_load_dwordx4 v29, s[4:7], s30 offen lds
    v_dot2_f32_bf16 v88, v100, v27, v88
    v_dot2_f32_bf16 v89, v100, v100, v89
    v_dot2_f32_bf16 v90, v101, v27, v90
    v_dot2_f32_bf16 v91, v101, v101, v91
    v_dot2_f32_bf16 v88, v102, v27, v88
    v_dot2_f32_bf16 v89, v102, v102, v89
    v_dot2_f32_bf16 v90, v103, v27, v90
    v_dot2_f32_bf16 v91, v103, v103, v91
    s_add_u32 m0, s27, 83968
    s_add_u32 s30, s34, 10752
    buffer_load_dwordx4 v30, s[4:7], s30 offen lds
    v_dot2_f32_bf16 v88, v104, v27, v88
    v_dot2_f32_bf16 v89, v104, v104, v89
    v_dot2_f32_bf16 v90, v105, v27, v90
    v_dot2_f32_bf16 v91, v105, v105, v91
    v_dot2_f32_bf16 v88, v106, v27, v88
    v_dot2_f32_bf16 v89, v106, v106, v89
    v_dot2_f32_bf16 v90, v107, v27, v90
    v_dot2_f32_bf16 v91, v107, v107, v91
    s_add_u32 m0, s27, 84992
    s_add_u32 s30, s34, 15872
    buffer_load_dwordx4 v31, s[4:7], s30 offen lds
    v_dot2_f32_bf16 v88, v108, v27, v88
    v_dot2_f32_bf16 v89, v108, v108, v89
    v_dot2_f32_bf16 v90, v109, v27, v90
    v_dot2_f32_bf16 v91, v109, v109, v91
    v_dot2_f32_bf16 v88, v110, v27, v88
    v_dot2_f32_bf16 v89, v110, v110, v89
    v_dot2_f32_bf16 v90, v111, v27, v90
    v_dot2_f32_bf16 v91, v111, v111, v91
    s_add_u32 m0, s27, 86016
    s_add_u32 s30, s34, 20992
    buffer_load_dwordx4 v28, s[4:7], s30 offen lds
    v_dot2_f32_bf16 v88, v112, v27, v88
    v_dot2_f32_bf16 v89, v112, v112, v89
    v_dot2_f32_bf16 v90, v113, v27, v90
    v_dot2_f32_bf16 v91, v113, v113, v91
    v_dot2_f32_bf16 v88, v114, v27, v88
    v_dot2_f32_bf16 v89, v114, v114, v89
    v_dot2_f32_bf16 v90, v115, v27, v90
    v_dot2_f32_bf16 v91, v115, v115, v91
    s_add_u32 m0, s27, 87040
    s_add_u32 s30, s34, 26112
    buffer_load_dwordx4 v29, s[4:7], s30 offen lds
    v_dot2_f32_bf16 v88, v116, v27, v88
    v_dot2_f32_bf16 v89, v116, v116, v89
    v_dot2_f32_bf16 v90, v117, v27, v90
    v_dot2_f32_bf16 v91, v117, v117, v91
    v_dot2_f32_bf16 v88, v118, v27, v88
    v_dot2_f32_bf16 v89, v118, v118, v89
    v_dot2_f32_bf16 v90, v119, v27, v90
    v_dot2_f32_bf16 v91, v119, v119, v91
    s_add_u32 m0, s27, 88064
    s_add_u32 s30, s34, 31232
    buffer_load_dwordx4 v30, s[4:7], s30 offen lds
    v_dot2_f32_bf16 v88, v120, v27, v88
    v_dot2_f32_bf16 v89, v120, v120, v89
    v_dot2_f32_bf16 v90, v121, v27, v90
    v_dot2_f32_bf16 v91, v121, v121, v91
    v_dot2_f32_bf16 v88, v122, v27, v88
    v_dot2_f32_bf16 v89, v122, v122, v89
    v_dot2_f32_bf16 v90, v123, v27, v90
    v_dot2_f32_bf16 v91, v123, v123, v91
    s_add_u32 m0, s27, 89088
    s_add_u32 s30, s34, 36352
    buffer_load_dwordx4 v31, s[4:7], s30 offen lds
    v_dot2_f32_bf16 v88, v124, v27, v88
    v_dot2_f32_bf16 v89, v124, v124, v89
    v_dot2_f32_bf16 v90, v125, v27, v90
    v_dot2_f32_bf16 v91, v125, v125, v91
    v_dot2_f32_bf16 v88, v126, v27, v88
    v_dot2_f32_bf16 v89, v126, v126, v89
    v_dot2_f32_bf16 v90, v127, v27, v90
    v_dot2_f32_bf16 v91, v127, v127, v91
    s_waitcnt vmcnt(8)
    ds_read_b128 v[128:131], v16 offset:40960
    ds_read_b128 v[132:135], v17 offset:40960
    ds_read_b128 v[136:139], v18 offset:40960
    ds_read_b128 v[140:143], v19 offset:40960
    ds_read_b128 v[144:147], v20 offset:40960
    ds_read_b128 v[148:151], v21 offset:40960
    ds_read_b128 v[152:155], v22 offset:40960
    ds_read_b128 v[156:159], v23 offset:40960
    s_waitcnt lgkmcnt(0)
    s_add_u32 m0, s27, 122880
    s_add_u32 s30, s34, 768
    buffer_load_dwordx4 v28, s[4:7], s30 offen lds
    v_dot2_f32_bf16 v88, v128, v27, v88
    v_dot2_f32_bf16 v89, v128, v128, v89
    v_dot2_f32_bf16 v90, v129, v27, v90
    v_dot2_f32_bf16 v91, v129, v129, v91
    v_dot2_f32_bf16 v88, v130, v27, v88
    v_dot2_f32_bf16 v89, v130, v130, v89
    v_dot2_f32_bf16 v90, v131, v27, v90
    v_dot2_f32_bf16 v91, v131, v131, v91
    s_add_u32 m0, s27, 123904
    s_add_u32 s30, s34, 5888
    buffer_load_dwordx4 v29, s[4:7], s30 offen lds
    v_dot2_f32_bf16 v88, v132, v27, v88
    v_dot2_f32_bf16 v89, v132, v132, v89
    v_dot2_f32_bf16 v90, v133, v27, v90
    v_dot2_f32_bf16 v91, v133, v133, v91
    v_dot2_f32_bf16 v88, v134, v27, v88
    v_dot2_f32_bf16 v89, v134, v134, v89
    v_dot2_f32_bf16 v90, v135, v27, v90
    v_dot2_f32_bf16 v91, v135, v135, v91
    s_add_u32 m0, s27, 124928
    s_add_u32 s30, s34, 11008
    buffer_load_dwordx4 v30, s[4:7], s30 offen lds
    v_dot2_f32_bf16 v88, v136, v27, v88
    v_dot2_f32_bf16 v89, v136, v136, v89
    v_dot2_f32_bf16 v90, v137, v27, v90
    v_dot2_f32_bf16 v91, v137, v137, v91
    v_dot2_f32_bf16 v88, v138, v27, v88
    v_dot2_f32_bf16 v89, v138, v138, v89
    v_dot2_f32_bf16 v90, v139, v27, v90
    v_dot2_f32_bf16 v91, v139, v139, v91
    s_add_u32 m0, s27, 125952
    s_add_u32 s30, s34, 16128
    buffer_load_dwordx4 v31, s[4:7], s30 offen lds
    v_dot2_f32_bf16 v88, v140, v27, v88
    v_dot2_f32_bf16 v89, v140, v140, v89
    v_dot2_f32_bf16 v90, v141, v27, v90
    v_dot2_f32_bf16 v91, v141, v141, v91
    v_dot2_f32_bf16 v88, v142, v27, v88
    v_dot2_f32_bf16 v89, v142, v142, v89
    v_dot2_f32_bf16 v90, v143, v27, v90
    v_dot2_f32_bf16 v91, v143, v143, v91
    s_add_u32 m0, s27, 126976
    s_add_u32 s30, s34, 21248
    buffer_load_dwordx4 v28, s[4:7], s30 offen lds
    v_dot2_f32_bf16 v88, v144, v27, v88
    v_dot2_f32_bf16 v89, v144, v144, v89
    v_dot2_f32_bf16 v90, v145, v27, v90
    v_dot2_f32_bf16 v91, v145, v145, v91
    v_dot2_f32_bf16 v88, v146, v27, v88
    v_dot2_f32_bf16 v89, v146, v146, v89
    v_dot2_f32_bf16 v90, v147, v27, v90
    v_dot2_f32_bf16 v91, v147, v147, v91
    s_add_u32 m0, s27, 128000
    s_add_u32 s30, s34, 26368
    buffer_load_dwordx4 v29, s[4:7], s30 offen lds
    v_dot2_f32_bf16 v88, v148, v27, v88
    v_dot2_f32_bf16 v89, v148, v148, v89
    v_dot2_f32_bf16 v90, v149, v27, v90
    v_dot2_f32_bf16 v91, v149, v149, v91
    v_dot2_f32_bf16 v88, v150, v27, v88
    v_dot2_f32_bf16 v89, v150, v150, v89
    v_dot2_f32_bf16 v90, v151, v27, v90
    v_dot2_f32_bf16 v91, v151, v151, v91
    s_add_u32 m0, s27, 129024
    s_add_u32 s30, s34, 31488
    buffer_load_dwordx4 v30, s[4:7], s30 offen lds
    v_dot2_f32_bf16 v88, v152, v27, v88
    v_dot2_f32_bf16 v89, v152, v152, v89
    v_dot2_f32_bf16 v90, v153, v27, v90
    v_dot2_f32_bf16 v91, v153, v153, v91
    v_dot2_f32_bf16 v88, v154, v27, v88
    v_dot2_f32_bf16 v89, v154, v154, v89
    v_dot2_f32_bf16 v90, v155, v27, v90
    v_dot2_f32_bf16 v91, v155, v155, v91
    s_add_u32 m0, s27, 130048
    s_add_u32 s30, s34, 36608
    buffer_load_dwordx4 v31, s[4:7], s30 offen lds
    v_dot2_f32_bf16 v88, v156, v27, v88
    v_dot2_f32_bf16 v89, v156, v156, v89
    v_dot2_f32_bf16 v90, v157, v27, v90
    v_dot2_f32_bf16 v91, v157, v157, v91
    v_dot2_f32_bf16 v88, v158, v27, v88
    v_dot2_f32_bf16 v89, v158, v158, v89
    v_dot2_f32_bf16 v90, v159, v27, v90
    v_dot2_f32_bf16 v91, v159, v159, v91
    s_waitcnt vmcnt(8)
    ds_read_b128 v[160:163], v40 offset:0
    ds_read_b128 v[164:167], v41 offset:0
    ds_read_b128 v[168:171], v42 offset:0
    ds_read_b128 v[172:175], v43 offset:0
    ds_read_b128 v[176:179], v44 offset:0
    ds_read_b128 v[180:183], v45 offset:0
    ds_read_b128 v[184:187], v46 offset:0
    ds_read_b128 v[188:191], v47 offset:0
    s_waitcnt lgkmcnt(0)
    s_add_u32 m0, s27, 0
    s_add_u32 s30, s38, 0
    buffer_load_dwordx4 v11, s[12:15], s30 offen lds
    v_dot2_f32_bf16 v88, v160, v27, v88
    v_dot2_f32_bf16 v89, v160, v160, v89
    v_dot2_f32_bf16 v90, v161, v27, v90
    v_dot2_f32_bf16 v91, v161, v161, v91
    v_dot2_f32_bf16 v88, v162, v27, v88
    v_dot2_f32_bf16 v89, v162, v162, v89
    v_dot2_f32_bf16 v90, v163, v27, v90
    v_dot2_f32_bf16 v91, v163, v163, v91
    s_add_u32 m0, m0, 1024
    s_add_u32 s30, s38, 27648
    buffer_load_dwordx4 v11, s[12:15], s30 offen lds
    v_dot2_f32_bf16 v88, v164, v27, v88
    v_dot2_f32_bf16 v89, v164, v164, v89
    v_dot2_f32_bf16 v90, v165, v27, v90
    v_dot2_f32_bf16 v91, v165, v165, v91
    v_dot2_f32_bf16 v88, v166, v27, v88
    v_dot2_f32_bf16 v89, v166, v166, v89
    v_dot2_f32_bf16 v90, v167, v27, v90
    v_dot2_f32_bf16 v91, v167, v167, v91
    s_add_u32 m0, m0, 1024
    s_add_u32 s30, s38, 55296
    buffer_load_dwordx4 v11, s[12:15], s30 offen lds
    v_dot2_f32_bf16 v88, v168, v27, v88
    v_dot2_f32_bf16 v89, v168, v168, v89
    v_dot2_f32_bf16 v90, v169, v27, v90
    v_dot2_f32_bf16 v91, v169, v169, v91
    v_dot2_f32_bf16 v88, v170, v27, v88
    v_dot2_f32_bf16 v89, v170, v170, v89
    v_dot2_f32_bf16 v90, v171, v27, v90
    v_dot2_f32_bf16 v91, v171, v171, v91
    s_add_u32 m0, m0, 1024
    s_add_u32 s30, s38, 82944
    buffer_load_dwordx4 v11, s[12:15], s30 offen lds
    v_dot2_f32_bf16 v88, v172, v27, v88
    v_dot2_f32_bf16 v89, v172, v172, v89
    v_dot2_f32_bf16 v90, v173, v27, v90
    v_dot2_f32_bf16 v91, v173, v173, v91
    v_dot2_f32_bf16 v88, v174, v27, v88
    v_dot2_f32_bf16 v89, v174, v174, v89
    v_dot2_f32_bf16 v90, v175, v27, v90
    v_dot2_f32_bf16 v91, v175, v175, v91
    s_add_u32 m0, m0, 1024
    s_add_u32 s30, s38, 110592
    buffer_load_dwordx4 v11, s[12:15], s30 offen lds
    v_dot2_f32_bf16 v88, v176, v27, v88
    v_dot2_f32_bf16 v89, v176, v176, v89
    v_dot2_f32_bf16 v90, v177, v27, v90
    v_dot2_f32_bf16 v91, v177, v177, v91
    v_dot2_f32_bf16 v88, v178, v27, v88
    v_dot2_f32_bf16 v89, v178, v178, v89
    v_dot2_f32_bf16 v90, v179, v27, v90
    v_dot2_f32_bf16 v91, v179, v179, v91
    s_add_u32 m0, m0, 1024
    s_add_u32 s30, s38, 138240
    buffer_load_dwordx4 v11, s[12:15], s30 offen lds
    v_dot2_f32_bf16 v88, v180, v27, v88
    v_dot2_f32_bf16 v89, v180, v180, v89
    v_dot2_f32_bf16 v90, v181, v27, v90
    v_dot2_f32_bf16 v91, v181, v181, v91
    v_dot2_f32_bf16 v88, v182, v27, v88
    v_dot2_f32_bf16 v89, v182, v182, v89
    v_dot2_f32_bf16 v90, v183, v27, v90
    v_dot2_f32_bf16 v91, v183, v183, v91
    s_add_u32 m0, m0, 1024
    s_add_u32 s30, s38, 165888
    buffer_load_dwordx4 v11, s[12:15], s30 offen lds
    v_dot2_f32_bf16 v88, v184, v27, v88
    v_dot2_f32_bf16 v89, v184, v184, v89
    v_dot2_f32_bf16 v90, v185, v27, v90
    v_dot2_f32_bf16 v91, v185, v185, v91
    v_dot2_f32_bf16 v88, v186, v27, v88
    v_dot2_f32_bf16 v89, v186, v186, v89
    v_dot2_f32_bf16 v90, v187, v27, v90
    v_dot2_f32_bf16 v91, v187, v187, v91
    s_add_u32 m0, m0, 1024
    s_add_u32 s30, s38, 193536
    buffer_load_dwordx4 v11, s[12:15], s30 offen lds
    v_dot2_f32_bf16 v88, v188, v27, v88
    v_dot2_f32_bf16 v89, v188, v188, v89
    v_dot2_f32_bf16 v90, v189, v27, v90
    v_dot2_f32_bf16 v91, v189, v189, v91
    v_dot2_f32_bf16 v88, v190, v27, v88
    v_dot2_f32_bf16 v89, v190, v190, v89
    v_dot2_f32_bf16 v90, v191, v27, v90
    v_dot2_f32_bf16 v91, v191, v191, v91
    s_waitcnt vmcnt(8)
    ds_read_b128 v[192:195], v40 offset:40960
    ds_read_b128 v[196:199], v41 offset:40960
    ds_read_b128 v[200:203], v42 offset:40960
    ds_read_b128 v[204:207], v43 offset:40960
    ds_read_b128 v[208:211], v44 offset:40960
    ds_read_b128 v[212:215], v45 offset:40960
    ds_read_b128 v[216:219], v46 offset:40960
    ds_read_b128 v[220:223], v47 offset:40960
    s_waitcnt lgkmcnt(0)
    s_add_u32 m0, m0, 1024
    s_add_u32 s30, s38, 221184
    buffer_load_dwordx4 v11, s[12:15], s30 offen lds
    v_dot2_f32_bf16 v88, v192, v27, v88
    v_dot2_f32_bf16 v89, v192, v192, v89
    v_dot2_f32_bf16 v90, v193, v27, v90
    v_dot2_f32_bf16 v91, v193, v193, v91
    v_dot2_f32_bf16 v88, v194, v27, v88
    v_dot2_f32_bf16 v89, v194, v194, v89
    v_dot2_f32_bf16 v90, v195, v27, v90
    v_dot2_f32_bf16 v91, v195, v195, v91
    v_dot2_f32_bf16 v88, v196, v27, v88
    v_dot2_f32_bf16 v89, v196, v196, v89
    v_dot2_f32_bf16 v90, v197, v27, v90
    v_dot2_f32_bf16 v91, v197, v197, v91
    v_dot2_f32_bf16 v88, v198, v27, v88
    v_dot2_f32_bf16 v89, v198, v198, v89
    v_dot2_f32_bf16 v90, v199, v27, v90
    v_dot2_f32_bf16 v91, v199, v199, v91
    v_dot2_f32_bf16 v88, v200, v27, v88
    v_dot2_f32_bf16 v89, v200, v200, v89
    v_dot2_f32_bf16 v90, v201, v27, v90
    v_dot2_f32_bf16 v91, v201, v201, v91
    s_add_u32 m0, m0, 1024
    s_add_u32 s30, s38, 248832
    buffer_load_dwordx4 v11, s[12:15], s30 offen lds
    v_dot2_f32_bf16 v88, v202, v27, v88
    v_dot2_f32_bf16 v89, v202, v202, v89
    v_dot2_f32_bf16 v90, v203, v27, v90
    v_dot2_f32_bf16 v91, v203, v203, v91
    v_dot2_f32_bf16 v88, v204, v27, v88
    v_dot2_f32_bf16 v89, v204, v204, v89
    v_dot2_f32_bf16 v90, v205, v27, v90
    v_dot2_f32_bf16 v91, v205, v205, v91
    v_dot2_f32_bf16 v88, v206, v27, v88
    v_dot2_f32_bf16 v89, v206, v206, v89
    v_dot2_f32_bf16 v90, v207, v27, v90
    v_dot2_f32_bf16 v91, v207, v207, v91
    v_dot2_f32_bf16 v88, v208, v27, v88
    v_dot2_f32_bf16 v89, v208, v208, v89
    v_dot2_f32_bf16 v90, v209, v27, v90
    v_dot2_f32_bf16 v91, v209, v209, v91
    v_dot2_f32_bf16 v88, v210, v27, v88
    v_dot2_f32_bf16 v89, v210, v210, v89
    v_dot2_f32_bf16 v90, v211, v27, v90
    v_dot2_f32_bf16 v91, v211, v211, v91
    s_add_u32 m0, s27, 40960
    s_add_u32 s30, s39, 0
    buffer_load_dwordx4 v11, s[12:15], s30 offen lds
    v_dot2_f32_bf16 v88, v212, v27, v88
    v_dot2_f32_bf16 v89, v212, v212, v89
    v_dot2_f32_bf16 v90, v213, v27, v90
    v_dot2_f32_bf16 v91, v213, v213, v91
    v_dot2_f32_bf16 v88, v214, v27, v88
    v_dot2_f32_bf16 v89, v214, v214, v89
    v_dot2_f32_bf16 v90, v215, v27, v90
    v_dot2_f32_bf16 v91, v215, v215, v91
    v_dot2_f32_bf16 v88, v216, v27, v88
    v_dot2_f32_bf16 v89, v216, v216, v89
    v_dot2_f32_bf16 v90, v217, v27, v90
    v_dot2_f32_bf16 v91, v217, v217, v91
    v_dot2_f32_bf16 v88, v218, v27, v88
    v_dot2_f32_bf16 v89, v218, v218, v89
    v_dot2_f32_bf16 v90, v219, v27, v90
    v_dot2_f32_bf16 v91, v219, v219, v91
    v_dot2_f32_bf16 v88, v220, v27, v88
    v_dot2_f32_bf16 v89, v220, v220, v89
    v_dot2_f32_bf16 v90, v221, v27, v90
    v_dot2_f32_bf16 v91, v221, v221, v91
    s_add_u32 m0, m0, 1024
    s_add_u32 s30, s39, 27648
    buffer_load_dwordx4 v11, s[12:15], s30 offen lds
    v_dot2_f32_bf16 v88, v222, v27, v88
    v_dot2_f32_bf16 v89, v222, v222, v89
    v_dot2_f32_bf16 v90, v223, v27, v90
    v_dot2_f32_bf16 v91, v223, v223, v91
    s_nop 2
    v_add_f32 v88, v88, v90
    v_add_f32 v89, v89, v91
    v_mov_b32 v90, v88
    v_mov_b32 v91, v89
    s_nop 1
    v_permlane32_swap_b32 v88, v90
    v_permlane32_swap_b32 v89, v91
    s_nop 0
    v_add_f32 v88, v88, v90
    v_add_f32 v89, v89, v91
    v_mul_f32 v88, 0x3acccccd, v88
    v_mul_f32 v89, 0x3acccccd, v89
    v_fma_f32 v89, -v88, v88, v89
    v_max_f32 v89, 0, v89
    v_cvt_pk_bf16_f32 v88, v88, v88
    v_lshlrev_b32 v88, 16, v88
    v_cvt_pk_bf16_f32 v89, v89, v89
    v_lshlrev_b32 v89, 16, v89
    v_add_f32 v89, 0x3727c5ac, v89
    v_cvt_pk_bf16_f32 v89, v89, v89
    v_lshlrev_b32 v89, 16, v89
    v_sqrt_f32 v89, v89
    s_nop 0
    v_cvt_pk_bf16_f32 v89, v89, v89
    v_lshlrev_b32 v89, 16, v89
    v_rcp_f32 v13, v89
    v_mov_b32 v12, v89
    v_sub_f32 v64, 0, v88
    v_sub_f32 v65, 0, v88
    v_sub_f32 v66, 0, v88
    v_sub_f32 v67, 0, v88
    v_sub_f32 v68, 0, v88
    v_sub_f32 v69, 0, v88
    v_sub_f32 v70, 0, v88
    v_sub_f32 v71, 0, v88
    v_sub_f32 v72, 0, v88
    v_sub_f32 v73, 0, v88
    v_sub_f32 v74, 0, v88
    v_sub_f32 v75, 0, v88
    v_sub_f32 v76, 0, v88
    v_sub_f32 v77, 0, v88
    v_sub_f32 v78, 0, v88
    v_sub_f32 v79, 0, v88
    v_mul_f32 v14, 0xc0135761, v13
    v_mul_f32 v15, v13, v13
    v_mul_f32 v15, 0x3d372713, v15
    v_mul_f32 v15, v14, v15
    v_mfma_f32_32x32x16_bf16 v[16:31], v[80:83], v[96:99], v[64:79]
    s_add_u32 m0, m0, 1024
    s_add_u32 s30, s39, 55296
    buffer_load_dwordx4 v11, s[12:15], s30 offen lds
    s_nop 3
    v_mfma_f32_32x32x16_bf16 v[16:31], v[84:87], v[100:103], v[16:31]
    s_nop 3
    v_mfma_f32_32x32x16_bf16 v[32:47], v[80:83], v[104:107], v[64:79]
    s_add_u32 m0, m0, 1024
    s_add_u32 s30, s39, 82944
    buffer_load_dwordx4 v11, s[12:15], s30 offen lds
    s_nop 3
    v_mfma_f32_32x32x16_bf16 v[32:47], v[84:87], v[108:111], v[32:47]
    s_nop 3
    v_mfma_f32_32x32x16_bf16 v[48:63], v[80:83], v[112:115], v[64:79]
    v_cvt_pk_bf16_f32 v96, v16, v17
    v_cvt_pk_bf16_f32 v97, v18, v19
    v_cvt_pk_bf16_f32 v98, v20, v21
    v_cvt_pk_bf16_f32 v99, v22, v23
    v_mfma_f32_32x32x16_bf16 v[48:63], v[84:87], v[116:119], v[48:63]
    s_add_u32 m0, m0, 1024
    s_add_u32 s30, s39, 110592
    buffer_load_dwordx4 v11, s[12:15], s30 offen lds
    v_cvt_pk_bf16_f32 v100, v24, v25
    v_cvt_pk_bf16_f32 v101, v26, v27
    v_cvt_pk_bf16_f32 v102, v28, v29
    v_cvt_pk_bf16_f32 v103, v30, v31
    v_mfma_f32_32x32x16_bf16 v[16:31], v[80:83], v[120:123], v[64:79]
    v_cvt_pk_bf16_f32 v104, v32, v33
    v_cvt_pk_bf16_f32 v105, v34, v35
    v_cvt_pk_bf16_f32 v106, v36, v37
    v_cvt_pk_bf16_f32 v107, v38, v39
    v_mfma_f32_32x32x16_bf16 v[16:31], v[84:87], v[124:127], v[16:31]
    s_add_u32 m0, m0, 1024
    s_add_u32 s30, s39, 138240
    buffer_load_dwordx4 v11, s[12:15], s30 offen lds
    v_cvt_pk_bf16_f32 v108, v40, v41
    v_cvt_pk_bf16_f32 v109, v42, v43
    v_cvt_pk_bf16_f32 v110, v44, v45
    v_cvt_pk_bf16_f32 v111, v46, v47
    v_mfma_f32_32x32x16_bf16 v[32:47], v[80:83], v[128:131], v[64:79]
    v_cvt_pk_bf16_f32 v112, v48, v49
    v_cvt_pk_bf16_f32 v113, v50, v51
    v_cvt_pk_bf16_f32 v114, v52, v53
    v_cvt_pk_bf16_f32 v115, v54, v55
    v_mfma_f32_32x32x16_bf16 v[32:47], v[84:87], v[132:135], v[32:47]
    v_cvt_pk_bf16_f32 v116, v56, v57
    v_cvt_pk_bf16_f32 v117, v58, v59
    v_cvt_pk_bf16_f32 v118, v60, v61
    v_cvt_pk_bf16_f32 v119, v62, v63
    v_mfma_f32_32x32x16_bf16 v[48:63], v[80:83], v[136:139], v[64:79]
    s_add_u32 m0, m0, 1024
    s_add_u32 s30, s39, 165888
    buffer_load_dwordx4 v11, s[12:15], s30 offen lds
    v_cvt_pk_bf16_f32 v120, v16, v17
    v_cvt_pk_bf16_f32 v121, v18, v19
    v_cvt_pk_bf16_f32 v122, v20, v21
    v_cvt_pk_bf16_f32 v123, v22, v23
    v_mfma_f32_32x32x16_bf16 v[48:63], v[84:87], v[140:143], v[48:63]
    v_cvt_pk_bf16_f32 v124, v24, v25
    v_cvt_pk_bf16_f32 v125, v26, v27
    v_cvt_pk_bf16_f32 v126, v28, v29
    v_cvt_pk_bf16_f32 v127, v30, v31
    v_mfma_f32_32x32x16_bf16 v[16:31], v[80:83], v[144:147], v[64:79]
    s_add_u32 m0, m0, 1024
    s_add_u32 s30, s39, 193536
    buffer_load_dwordx4 v11, s[12:15], s30 offen lds
    v_cvt_pk_bf16_f32 v128, v32, v33
    v_cvt_pk_bf16_f32 v129, v34, v35
    v_cvt_pk_bf16_f32 v130, v36, v37
    v_cvt_pk_bf16_f32 v131, v38, v39
    v_mfma_f32_32x32x16_bf16 v[16:31], v[84:87], v[148:151], v[16:31]
    v_cvt_pk_bf16_f32 v132, v40, v41
    v_cvt_pk_bf16_f32 v133, v42, v43
    v_cvt_pk_bf16_f32 v134, v44, v45
    v_cvt_pk_bf16_f32 v135, v46, v47
    v_mfma_f32_32x32x16_bf16 v[32:47], v[80:83], v[152:155], v[64:79]
    v_cvt_pk_bf16_f32 v136, v48, v49
    v_cvt_pk_bf16_f32 v137, v50, v51
    v_cvt_pk_bf16_f32 v138, v52, v53
    v_cvt_pk_bf16_f32 v139, v54, v55
    v_mfma_f32_32x32x16_bf16 v[32:47], v[84:87], v[156:159], v[32:47]
    s_add_u32 m0, m0, 1024
    s_add_u32 s30, s39, 221184
    buffer_load_dwordx4 v11, s[12:15], s30 offen lds
    v_cvt_pk_bf16_f32 v140, v56, v57
    v_cvt_pk_bf16_f32 v141, v58, v59
    v_cvt_pk_bf16_f32 v142, v60, v61
    v_cvt_pk_bf16_f32 v143, v62, v63
    v_mfma_f32_32x32x16_bf16 v[48:63], v[80:83], v[160:163], v[64:79]
    v_cvt_pk_bf16_f32 v144, v16, v17
    v_cvt_pk_bf16_f32 v145, v18, v19
    v_cvt_pk_bf16_f32 v146, v20, v21
    v_cvt_pk_bf16_f32 v147, v22, v23
    v_mfma_f32_32x32x16_bf16 v[48:63], v[84:87], v[164:167], v[48:63]
    s_add_u32 m0, m0, 1024
    s_add_u32 s30, s39, 248832
    buffer_load_dwordx4 v11, s[12:15], s30 offen lds
    v_cvt_pk_bf16_f32 v148, v24, v25
    v_cvt_pk_bf16_f32 v149, v26, v27
    v_cvt_pk_bf16_f32 v150, v28, v29
    v_cvt_pk_bf16_f32 v151, v30, v31
    v_mfma_f32_32x32x16_bf16 v[16:31], v[80:83], v[168:171], v[64:79]
    v_cvt_pk_bf16_f32 v152, v32, v33
    v_cvt_pk_bf16_f32 v153, v34, v35
    v_cvt_pk_bf16_f32 v154, v36, v37
    v_cvt_pk_bf16_f32 v155, v38, v39
    v_mfma_f32_32x32x16_bf16 v[16:31], v[84:87], v[172:175], v[16:31]
    v_cvt_pk_bf16_f32 v156, v40, v41
    v_cvt_pk_bf16_f32 v157, v42, v43
    v_cvt_pk_bf16_f32 v158, v44, v45
    v_cvt_pk_bf16_f32 v159, v46, v47
    v_mfma_f32_32x32x16_bf16 v[32:47], v[80:83], v[176:179], v[64:79]
    s_add_u32 m0, s27, 81920
    s_add_u32 s30, s40, 0
    buffer_load_dwordx4 v11, s[12:15], s30 offen lds
    v_cvt_pk_bf16_f32 v160, v48, v49
    v_cvt_pk_bf16_f32 v161, v50, v51
    v_cvt_pk_bf16_f32 v162, v52, v53
    v_cvt_pk_bf16_f32 v163, v54, v55
    v_mfma_f32_32x32x16_bf16 v[32:47], v[84:87], v[180:183], v[32:47]
    v_cvt_pk_bf16_f32 v164, v56, v57
    v_cvt_pk_bf16_f32 v165, v58, v59
    v_cvt_pk_bf16_f32 v166, v60, v61
    v_cvt_pk_bf16_f32 v167, v62, v63
    v_mfma_f32_32x32x16_bf16 v[48:63], v[80:83], v[184:187], v[64:79]
    s_add_u32 m0, m0, 1024
    s_add_u32 s30, s40, 27648
    buffer_load_dwordx4 v11, s[12:15], s30 offen lds
    v_cvt_pk_bf16_f32 v168, v16, v17
    v_cvt_pk_bf16_f32 v169, v18, v19
    v_cvt_pk_bf16_f32 v170, v20, v21
    v_cvt_pk_bf16_f32 v171, v22, v23
    v_mfma_f32_32x32x16_bf16 v[48:63], v[84:87], v[188:191], v[48:63]
    v_cvt_pk_bf16_f32 v172, v24, v25
    v_cvt_pk_bf16_f32 v173, v26, v27
    v_cvt_pk_bf16_f32 v174, v28, v29
    v_cvt_pk_bf16_f32 v175, v30, v31
    v_mfma_f32_32x32x16_bf16 v[16:31], v[80:83], v[192:195], v[64:79]
    v_cvt_pk_bf16_f32 v176, v32, v33
    v_cvt_pk_bf16_f32 v177, v34, v35
    v_cvt_pk_bf16_f32 v178, v36, v37
    v_cvt_pk_bf16_f32 v179, v38, v39
    v_mfma_f32_32x32x16_bf16 v[16:31], v[84:87], v[196:199], v[16:31]
    s_add_u32 m0, m0, 1024
    s_add_u32 s30, s40, 55296
    buffer_load_dwordx4 v11, s[12:15], s30 offen lds
    v_cvt_pk_bf16_f32 v180, v40, v41
    v_cvt_pk_bf16_f32 v181, v42, v43
    v_cvt_pk_bf16_f32 v182, v44, v45
    v_cvt_pk_bf16_f32 v183, v46, v47
    v_mfma_f32_32x32x16_bf16 v[32:47], v[80:83], v[200:203], v[64:79]
    v_cvt_pk_bf16_f32 v184, v48, v49
    v_cvt_pk_bf16_f32 v185, v50, v51
    v_cvt_pk_bf16_f32 v186, v52, v53
    v_cvt_pk_bf16_f32 v187, v54, v55
    v_mfma_f32_32x32x16_bf16 v[32:47], v[84:87], v[204:207], v[32:47]
    s_add_u32 m0, m0, 1024
    s_add_u32 s30, s40, 82944
    buffer_load_dwordx4 v11, s[12:15], s30 offen lds
    v_cvt_pk_bf16_f32 v188, v56, v57
    v_cvt_pk_bf16_f32 v189, v58, v59
    v_cvt_pk_bf16_f32 v190, v60, v61
    v_cvt_pk_bf16_f32 v191, v62, v63
    v_mfma_f32_32x32x16_bf16 v[48:63], v[80:83], v[208:211], v[64:79]
    v_cvt_pk_bf16_f32 v192, v16, v17
    v_cvt_pk_bf16_f32 v193, v18, v19
    v_cvt_pk_bf16_f32 v194, v20, v21
    v_cvt_pk_bf16_f32 v195, v22, v23
    v_mfma_f32_32x32x16_bf16 v[48:63], v[84:87], v[212:215], v[48:63]
    v_cvt_pk_bf16_f32 v196, v24, v25
    v_cvt_pk_bf16_f32 v197, v26, v27
    v_cvt_pk_bf16_f32 v198, v28, v29
    v_cvt_pk_bf16_f32 v199, v30, v31
    v_mfma_f32_32x32x16_bf16 v[16:31], v[80:83], v[216:219], v[64:79]
    s_add_u32 m0, m0, 1024
    s_add_u32 s30, s40, 110592
    buffer_load_dwordx4 v11, s[12:15], s30 offen lds
    v_cvt_pk_bf16_f32 v200, v32, v33
    v_cvt_pk_bf16_f32 v201, v34, v35
    v_cvt_pk_bf16_f32 v202, v36, v37
    v_cvt_pk_bf16_f32 v203, v38, v39
    v_mfma_f32_32x32x16_bf16 v[16:31], v[84:87], v[220:223], v[16:31]
    v_cvt_pk_bf16_f32 v204, v40, v41
    v_cvt_pk_bf16_f32 v205, v42, v43
    v_cvt_pk_bf16_f32 v206, v44, v45
    v_cvt_pk_bf16_f32 v207, v46, v47
    v_mfma_f32_32x32x16_bf16 v[32:47], v[80:83], v[224:227], v[64:79]
    s_add_u32 m0, m0, 1024
    s_add_u32 s30, s40, 138240
    buffer_load_dwordx4 v11, s[12:15], s30 offen lds
    v_cvt_pk_bf16_f32 v208, v48, v49
    v_cvt_pk_bf16_f32 v209, v50, v51
    v_cvt_pk_bf16_f32 v210, v52, v53
    v_cvt_pk_bf16_f32 v211, v54, v55
    v_mfma_f32_32x32x16_bf16 v[32:47], v[84:87], v[228:231], v[32:47]
    v_cvt_pk_bf16_f32 v212, v56, v57
    v_cvt_pk_bf16_f32 v213, v58, v59
    v_cvt_pk_bf16_f32 v214, v60, v61
    v_cvt_pk_bf16_f32 v215, v62, v63
    v_mfma_f32_32x32x16_bf16 v[48:63], v[80:83], v[232:235], v[64:79]
    v_cvt_pk_bf16_f32 v216, v16, v17
    v_cvt_pk_bf16_f32 v217, v18, v19
    v_cvt_pk_bf16_f32 v218, v20, v21
    v_cvt_pk_bf16_f32 v219, v22, v23
    v_mfma_f32_32x32x16_bf16 v[48:63], v[84:87], v[236:239], v[48:63]
    s_add_u32 m0, m0, 1024
    s_add_u32 s30, s40, 165888
    buffer_load_dwordx4 v11, s[12:15], s30 offen lds
    v_cvt_pk_bf16_f32 v220, v24, v25
    v_cvt_pk_bf16_f32 v221, v26, v27
    v_cvt_pk_bf16_f32 v222, v28, v29
    v_cvt_pk_bf16_f32 v223, v30, v31
    v_mfma_f32_32x32x16_bf16 v[16:31], v[80:83], v[240:243], v[64:79]
    v_cvt_pk_bf16_f32 v224, v32, v33
    v_cvt_pk_bf16_f32 v225, v34, v35
    v_cvt_pk_bf16_f32 v226, v36, v37
    v_cvt_pk_bf16_f32 v227, v38, v39
    v_mfma_f32_32x32x16_bf16 v[16:31], v[84:87], v[244:247], v[16:31]
    s_add_u32 m0, m0, 1024
    s_add_u32 s30, s40, 193536
    buffer_load_dwordx4 v11, s[12:15], s30 offen lds
    v_cvt_pk_bf16_f32 v228, v40, v41
    v_cvt_pk_bf16_f32 v229, v42, v43
    v_cvt_pk_bf16_f32 v230, v44, v45
    v_cvt_pk_bf16_f32 v231, v46, v47
    v_mfma_f32_32x32x16_bf16 v[32:47], v[80:83], v[248:251], v[64:79]
    v_cvt_pk_bf16_f32 v232, v48, v49
    v_cvt_pk_bf16_f32 v233, v50, v51
    v_cvt_pk_bf16_f32 v234, v52, v53
    v_cvt_pk_bf16_f32 v235, v54, v55
    v_mfma_f32_32x32x16_bf16 v[32:47], v[84:87], v[252:255], v[32:47]
    s_waitcnt vmcnt(18)
    s_barrier
    ds_read_b64_tr_b16 a[0:1], v2 offset:0
    ds_read_b64_tr_b16 a[2:3], v2 offset:512
    ds_read_b64_tr_b16 a[4:5], v2 offset:2048
    ds_read_b64_tr_b16 a[6:7], v2 offset:2560
    ds_read_b64_tr_b16 a[8:9], v2 offset:4096
    ds_read_b64_tr_b16 a[10:11], v2 offset:4608
    ds_read_b64_tr_b16 a[12:13], v2 offset:6144
    ds_read_b64_tr_b16 a[14:15], v2 offset:6656
    ds_read_b64_tr_b16 a[16:17], v2 offset:8192
    ds_read_b64_tr_b16 a[18:19], v2 offset:8704
    v_cvt_pk_bf16_f32 v236, v56, v57
    v_cvt_pk_bf16_f32 v237, v58, v59
    v_cvt_pk_bf16_f32 v238, v60, v61
    v_cvt_pk_bf16_f32 v239, v62, v63
    v_cvt_pk_bf16_f32 v240, v16, v17
    v_cvt_pk_bf16_f32 v241, v18, v19
    v_cvt_pk_bf16_f32 v242, v20, v21
    v_cvt_pk_bf16_f32 v243, v22, v23
    v_cvt_pk_bf16_f32 v244, v24, v25
    v_cvt_pk_bf16_f32 v245, v26, v27
    v_cvt_pk_bf16_f32 v246, v28, v29
    v_cvt_pk_bf16_f32 v247, v30, v31
    v_cvt_pk_bf16_f32 v248, v32, v33
    v_cvt_pk_bf16_f32 v249, v34, v35
    v_cvt_pk_bf16_f32 v250, v36, v37
    v_cvt_pk_bf16_f32 v251, v38, v39
    v_cvt_pk_bf16_f32 v252, v40, v41
    v_cvt_pk_bf16_f32 v253, v42, v43
    v_cvt_pk_bf16_f32 v254, v44, v45
    v_cvt_pk_bf16_f32 v255, v46, v47
    s_waitcnt lgkmcnt(8)
    v_mfma_f32_32x32x16_bf16 v[16:31], a[0:3], v[96:99], 0
    s_waitcnt lgkmcnt(6)
    ds_read_b64_tr_b16 a[20:21], v2 offset:10240
    ds_read_b64_tr_b16 a[22:23], v2 offset:10752
    v_and_b32 v58, 31, v0
    v_mfma_f32_32x32x16_bf16 v[16:31], a[4:7], v[100:103], v[16:31]
    s_waitcnt lgkmcnt(6)
    s_add_u32 m0, m0, 1024
    s_add_u32 s30, s40, 221184
    ds_read_b64_tr_b16 a[24:25], v2 offset:12288
    ds_read_b64_tr_b16 a[26:27], v2 offset:12800
    buffer_load_dwordx4 v11, s[12:15], s30 offen lds
    v_mfma_f32_32x32x16_bf16 v[16:31], a[8:11], v[104:107], v[16:31]
    s_waitcnt lgkmcnt(6)
    ds_read_b64_tr_b16 a[28:29], v2 offset:14336
    ds_read_b64_tr_b16 a[30:31], v2 offset:14848
    v_mfma_f32_32x32x16_bf16 v[16:31], a[12:15], v[108:111], v[16:31]
    s_waitcnt lgkmcnt(6)
    s_add_u32 m0, m0, 1024
    s_add_u32 s30, s40, 248832
    ds_read_b64_tr_b16 a[0:1], v2 offset:16384
    ds_read_b64_tr_b16 a[2:3], v2 offset:16896
    buffer_load_dwordx4 v11, s[12:15], s30 offen lds
    v_mfma_f32_32x32x16_bf16 v[16:31], a[16:19], v[112:115], v[16:31]
    s_waitcnt lgkmcnt(6)
    ds_read_b64_tr_b16 a[4:5], v2 offset:18432
    ds_read_b64_tr_b16 a[6:7], v2 offset:18944
    v_mfma_f32_32x32x16_bf16 v[16:31], a[20:23], v[116:119], v[16:31]
    s_waitcnt lgkmcnt(6)
    ds_read_b64_tr_b16 a[8:9], v2 offset:20480
    ds_read_b64_tr_b16 a[10:11], v2 offset:20992
    v_mul_u32_u24 v58, 136, v58
    v_mfma_f32_32x32x16_bf16 v[16:31], a[24:27], v[120:123], v[16:31]
    s_waitcnt lgkmcnt(6)
    s_add_u32 m0, s27, 122880
    s_add_u32 s30, s44, 0
    ds_read_b64_tr_b16 a[12:13], v2 offset:22528
    ds_read_b64_tr_b16 a[14:15], v2 offset:23040
    buffer_load_dwordx4 v11, s[12:15], s30 offen lds
    v_mfma_f32_32x32x16_bf16 v[16:31], a[28:31], v[124:127], v[16:31]
    s_waitcnt lgkmcnt(6)
    ds_read_b64_tr_b16 a[16:17], v2 offset:24576
    ds_read_b64_tr_b16 a[18:19], v2 offset:25088
    v_mfma_f32_32x32x16_bf16 v[16:31], a[0:3], v[128:131], v[16:31]
    s_waitcnt lgkmcnt(6)
    s_add_u32 m0, m0, 1024
    s_add_u32 s30, s44, 27648
    ds_read_b64_tr_b16 a[20:21], v2 offset:26624
    ds_read_b64_tr_b16 a[22:23], v2 offset:27136
    buffer_load_dwordx4 v11, s[12:15], s30 offen lds
    v_mfma_f32_32x32x16_bf16 v[16:31], a[4:7], v[132:135], v[16:31]
    s_waitcnt lgkmcnt(6)
    ds_read_b64_tr_b16 a[24:25], v2 offset:28672
    ds_read_b64_tr_b16 a[26:27], v2 offset:29184
    v_mfma_f32_32x32x16_bf16 v[16:31], a[8:11], v[136:139], v[16:31]
    s_waitcnt lgkmcnt(6)
    ds_read_b64_tr_b16 a[28:29], v2 offset:30720
    ds_read_b64_tr_b16 a[30:31], v2 offset:31232
    v_lshrrev_b32 v59, 5, v0
    v_mfma_f32_32x32x16_bf16 v[16:31], a[12:15], v[140:143], v[16:31]
    s_waitcnt lgkmcnt(6)
    s_add_u32 m0, m0, 1024
    s_add_u32 s30, s44, 55296
    ds_read_b64_tr_b16 a[0:1], v2 offset:32768
    ds_read_b64_tr_b16 a[2:3], v2 offset:33280
    buffer_load_dwordx4 v11, s[12:15], s30 offen lds
    v_mfma_f32_32x32x16_bf16 v[16:31], a[16:19], v[144:147], v[16:31]
    s_waitcnt lgkmcnt(6)
    ds_read_b64_tr_b16 a[4:5], v2 offset:34816
    ds_read_b64_tr_b16 a[6:7], v2 offset:35328
    v_mfma_f32_32x32x16_bf16 v[16:31], a[20:23], v[148:151], v[16:31]
    s_waitcnt lgkmcnt(6)
    s_add_u32 m0, m0, 1024
    s_add_u32 s30, s44, 82944
    ds_read_b64_tr_b16 a[8:9], v2 offset:36864
    ds_read_b64_tr_b16 a[10:11], v2 offset:37376
    buffer_load_dwordx4 v11, s[12:15], s30 offen lds
    v_mfma_f32_32x32x16_bf16 v[16:31], a[24:27], v[152:155], v[16:31]
    s_waitcnt lgkmcnt(6)
    ds_read_b64_tr_b16 a[12:13], v2 offset:38912
    ds_read_b64_tr_b16 a[14:15], v2 offset:39424
    v_mfma_f32_32x32x16_bf16 v[16:31], a[28:31], v[156:159], v[16:31]
    s_waitcnt vmcnt(14) lgkmcnt(6)
    s_barrier
    v_add_u32 v2, 40960, v2
    s_lshl_b32 s29, s25, 4
    buffer_load_dword v92, off, s[20:23], s29 sc1
    ds_read_b64_tr_b16 a[16:17], v2 offset:0
    ds_read_b64_tr_b16 a[18:19], v2 offset:512
    v_lshl_add_u32 v58, v59, 3, v58
    v_mfma_f32_32x32x16_bf16 v[16:31], a[0:3], v[160:163], v[16:31]
    s_waitcnt lgkmcnt(6)
    s_add_u32 m0, m0, 1024
    s_add_u32 s30, s44, 110592
    ds_read_b64_tr_b16 a[20:21], v2 offset:2048
    ds_read_b64_tr_b16 a[22:23], v2 offset:2560
    buffer_load_dwordx4 v11, s[12:15], s30 offen lds
    v_mfma_f32_32x32x16_bf16 v[16:31], a[4:7], v[164:167], v[16:31]
    s_waitcnt lgkmcnt(6)
    ds_read_b64_tr_b16 a[24:25], v2 offset:4096
    ds_read_b64_tr_b16 a[26:27], v2 offset:4608
    v_mfma_f32_32x32x16_bf16 v[16:31], a[8:11], v[168:171], v[16:31]
    s_waitcnt lgkmcnt(6)
    s_add_u32 m0, m0, 1024
    s_add_u32 s30, s44, 138240
    ds_read_b64_tr_b16 a[28:29], v2 offset:6144
    ds_read_b64_tr_b16 a[30:31], v2 offset:6656
    buffer_load_dwordx4 v11, s[12:15], s30 offen lds
    v_mfma_f32_32x32x16_bf16 v[16:31], a[12:15], v[172:175], v[16:31]
    s_waitcnt lgkmcnt(6)
    ds_read_b64_tr_b16 a[0:1], v2 offset:8192
    ds_read_b64_tr_b16 a[2:3], v2 offset:8704
    v_mfma_f32_32x32x16_bf16 v[16:31], a[16:19], v[176:179], v[16:31]
    s_waitcnt lgkmcnt(6)
    ds_read_b64_tr_b16 a[4:5], v2 offset:10240
    ds_read_b64_tr_b16 a[6:7], v2 offset:10752
    v_add_u32 v58, s27, v58
    v_mfma_f32_32x32x16_bf16 v[16:31], a[20:23], v[180:183], v[16:31]
    s_waitcnt lgkmcnt(6)
    s_add_u32 m0, m0, 1024
    s_add_u32 s30, s44, 165888
    ds_read_b64_tr_b16 a[8:9], v2 offset:12288
    ds_read_b64_tr_b16 a[10:11], v2 offset:12800
    buffer_load_dwordx4 v11, s[12:15], s30 offen lds
    v_mfma_f32_32x32x16_bf16 v[16:31], a[24:27], v[184:187], v[16:31]
    s_waitcnt lgkmcnt(6)
    ds_read_b64_tr_b16 a[12:13], v2 offset:14336
    ds_read_b64_tr_b16 a[14:15], v2 offset:14848
    v_mfma_f32_32x32x16_bf16 v[16:31], a[28:31], v[188:191], v[16:31]
    s_waitcnt lgkmcnt(6)
    s_add_u32 m0, m0, 1024
    s_add_u32 s30, s44, 193536
    ds_read_b64_tr_b16 a[16:17], v2 offset:16384
    ds_read_b64_tr_b16 a[18:19], v2 offset:16896
    buffer_load_dwordx4 v11, s[12:15], s30 offen lds
    v_mfma_f32_32x32x16_bf16 v[16:31], a[0:3], v[192:195], v[16:31]
    s_waitcnt lgkmcnt(6)
    ds_read_b64_tr_b16 a[20:21], v2 offset:18432
    ds_read_b64_tr_b16 a[22:23], v2 offset:18944
    v_mfma_f32_32x32x16_bf16 v[16:31], a[4:7], v[196:199], v[16:31]
    s_waitcnt lgkmcnt(6)
    ds_read_b64_tr_b16 a[24:25], v2 offset:20480
    ds_read_b64_tr_b16 a[26:27], v2 offset:20992
    v_bfe_u32 v59, v2, 7, 4
    v_mfma_f32_32x32x16_bf16 v[16:31], a[8:11], v[200:203], v[16:31]
    s_waitcnt lgkmcnt(6)
    s_add_u32 m0, m0, 1024
    s_add_u32 s30, s44, 221184
    ds_read_b64_tr_b16 a[28:29], v2 offset:22528
    ds_read_b64_tr_b16 a[30:31], v2 offset:23040
    buffer_load_dwordx4 v11, s[12:15], s30 offen lds
    v_mfma_f32_32x32x16_bf16 v[16:31], a[12:15], v[204:207], v[16:31]
    s_waitcnt lgkmcnt(6)
    ds_read_b64_tr_b16 a[0:1], v2 offset:24576
    ds_read_b64_tr_b16 a[2:3], v2 offset:25088
    v_mfma_f32_32x32x16_bf16 v[16:31], a[16:19], v[208:211], v[16:31]
    s_waitcnt lgkmcnt(6)
    s_add_u32 m0, m0, 1024
    s_add_u32 s30, s44, 248832
    ds_read_b64_tr_b16 a[4:5], v2 offset:26624
    ds_read_b64_tr_b16 a[6:7], v2 offset:27136
    buffer_load_dwordx4 v11, s[12:15], s30 offen lds
    v_mfma_f32_32x32x16_bf16 v[16:31], a[20:23], v[212:215], v[16:31]
    s_waitcnt lgkmcnt(6)
    ds_read_b64_tr_b16 a[8:9], v2 offset:28672
    ds_read_b64_tr_b16 a[10:11], v2 offset:29184
    v_mfma_f32_32x32x16_bf16 v[16:31], a[24:27], v[216:219], v[16:31]
    s_waitcnt lgkmcnt(6)
    ds_read_b64_tr_b16 a[12:13], v2 offset:30720
    ds_read_b64_tr_b16 a[14:15], v2 offset:31232
    v_mul_u32_u24 v59, 136, v59
    v_mfma_f32_32x32x16_bf16 v[16:31], a[28:31], v[220:223], v[16:31]
    s_waitcnt lgkmcnt(6)
    ds_read_b64_tr_b16 a[16:17], v2 offset:32768
    ds_read_b64_tr_b16 a[18:19], v2 offset:33280
    v_and_b32 v60, 63, v2
    v_mfma_f32_32x32x16_bf16 v[16:31], a[0:3], v[224:227], v[16:31]
    s_waitcnt lgkmcnt(6)
    ds_read_b64_tr_b16 a[20:21], v2 offset:34816
    ds_read_b64_tr_b16 a[22:23], v2 offset:35328
    v_add3_u32 v59, s27, v59, v60
    v_mfma_f32_32x32x16_bf16 v[16:31], a[4:7], v[228:231], v[16:31]
    s_waitcnt lgkmcnt(6)
    ds_read_b64_tr_b16 a[24:25], v2 offset:36864
    ds_read_b64_tr_b16 a[26:27], v2 offset:37376
    v_lshrrev_b32 v57, 5, v0
    v_mfma_f32_32x32x16_bf16 v[16:31], a[8:11], v[232:235], v[16:31]
    s_waitcnt lgkmcnt(6)
    ds_read_b64_tr_b16 a[28:29], v2 offset:38912
    ds_read_b64_tr_b16 a[30:31], v2 offset:39424
    v_mul_u32_u24 v57, 13824, v57
    v_mfma_f32_32x32x16_bf16 v[16:31], a[12:15], v[236:239], v[16:31]
    s_waitcnt lgkmcnt(6)
    ds_read_b64_tr_b16 a[0:1], v3 offset:0
    ds_read_b64_tr_b16 a[2:3], v3 offset:512
    v_add_u32 v57, v1, v57
    v_mfma_f32_32x32x16_bf16 v[16:31], a[16:19], v[240:243], v[16:31]
    s_waitcnt lgkmcnt(6)
    ds_read_b64_tr_b16 a[4:5], v3 offset:2048
    ds_read_b64_tr_b16 a[6:7], v3 offset:2560
    v_mfma_f32_32x32x16_bf16 v[16:31], a[20:23], v[244:247], v[16:31]
    s_waitcnt lgkmcnt(6)
    ds_read_b64_tr_b16 a[8:9], v3 offset:4096
    ds_read_b64_tr_b16 a[10:11], v3 offset:4608
    v_mfma_f32_32x32x16_bf16 v[16:31], a[24:27], v[248:251], v[16:31]
    s_waitcnt lgkmcnt(6)
    ds_read_b64_tr_b16 a[12:13], v3 offset:6144
    ds_read_b64_tr_b16 a[14:15], v3 offset:6656
    v_mfma_f32_32x32x16_bf16 v[16:31], a[28:31], v[252:255], v[16:31]
    s_waitcnt lgkmcnt(6)
    ds_read_b64_tr_b16 a[16:17], v3 offset:8192
    ds_read_b64_tr_b16 a[18:19], v3 offset:8704
    s_mov_b32 s32, 0
    s_mov_b32 s31, 40960
    s_mov_b32 s34, 0
    s_branch k1_pb
k1_loop:
    v_mfma_f32_32x32x16_bf16 v[16:31], a[0:3], v[96:99], 0
    s_waitcnt lgkmcnt(6)
    s_add_u32 m0, s27, s44
    s_add_u32 s30, s39, 0
    ds_read_b64_tr_b16 a[20:21], v2 offset:10240
    ds_read_b64_tr_b16 a[22:23], v2 offset:10752
    buffer_load_dwordx4 v11, s[12:15], s30 offen lds
    v_mfma_f32_32x32x16_bf16 v[16:31], a[4:7], v[100:103], v[16:31]
    s_waitcnt lgkmcnt(6)
    v_add_u32 v3, s31, v3
    v_xor_b32 v3, s37, v3
    s_add_u32 m0, m0, 1024
    s_add_u32 s30, s39, 27648
    ds_read_b64_tr_b16 a[24:25], v2 offset:12288
    ds_read_b64_tr_b16 a[26:27], v2 offset:12800
    buffer_load_dwordx4 v11, s[12:15], s30 offen lds
    v_mfma_f32_32x32x16_bf16 v[16:31], a[8:11], v[104:107], v[16:31]
    s_waitcnt lgkmcnt(6)
    s_add_u32 m0, m0, 1024
    s_add_u32 s30, s39, 55296
    ds_read_b64_tr_b16 a[28:29], v2 offset:14336
    ds_read_b64_tr_b16 a[30:31], v2 offset:14848
    buffer_load_dwordx4 v11, s[12:15], s30 offen lds
    v_mfma_f32_32x32x16_bf16 v[16:31], a[12:15], v[108:111], v[16:31]
    s_waitcnt lgkmcnt(6)
    ds_read_b64_tr_b16 a[0:1], v2 offset:16384
    ds_read_b64_tr_b16 a[2:3], v2 offset:16896
    v_mul_f32 v48, v32, v32
    v_mul_f32 v49, v33, v33
    v_fma_f32 v48, v48, v15, v14
    v_fma_f32 v49, v49, v15, v14
    v_mul_f32 v48, v48, v32
    v_mul_f32 v49, v49, v33
    v_mfma_f32_32x32x16_bf16 v[16:31], a[16:19], v[112:115], v[16:31]
    s_waitcnt lgkmcnt(6)
    ds_read_b64_tr_b16 a[4:5], v2 offset:18432
    ds_read_b64_tr_b16 a[6:7], v2 offset:18944
    v_exp_f32 v48, v48
    v_exp_f32 v49, v49
    v_fma_f32 v48, v48, v12, v12
    v_mfma_f32_32x32x16_bf16 v[16:31], a[20:23], v[116:119], v[16:31]
    s_waitcnt lgkmcnt(6)
    s_add_u32 m0, m0, 1024
    s_add_u32 s30, s39, 82944
    ds_read_b64_tr_b16 a[8:9], v2 offset:20480
    ds_read_b64_tr_b16 a[10:11], v2 offset:20992
    buffer_load_dwordx4 v11, s[12:15], s30 offen lds
    v_fma_f32 v49, v49, v12, v12
    v_mfma_f32_32x32x16_bf16 v[16:31], a[24:27], v[120:123], v[16:31]
    s_waitcnt lgkmcnt(6)
    ds_read_b64_tr_b16 a[12:13], v2 offset:22528
    ds_read_b64_tr_b16 a[14:15], v2 offset:23040
    v_rcp_f32 v48, v48
    v_rcp_f32 v49, v49
    v_mul_f32 v32, v32, v48
    v_mul_f32 v33, v33, v49
    v_mfma_f32_32x32x16_bf16 v[16:31], a[28:31], v[124:127], v[16:31]
    s_waitcnt lgkmcnt(6)
    ds_read_b64_tr_b16 a[16:17], v2 offset:24576
    ds_read_b64_tr_b16 a[18:19], v2 offset:25088
    v_cvt_pk_bf16_f32 v72, v32, v33
    v_mul_f32 v48, v34, v34
    v_mul_f32 v49, v35, v35
    v_fma_f32 v48, v48, v15, v14
    v_mfma_f32_32x32x16_bf16 v[16:31], a[0:3], v[128:131], v[16:31]
    s_waitcnt lgkmcnt(6)
    ds_read_b64_tr_b16 a[20:21], v2 offset:26624
    ds_read_b64_tr_b16 a[22:23], v2 offset:27136
    v_fma_f32 v49, v49, v15, v14
    v_mul_f32 v48, v48, v34
    v_mul_f32 v49, v49, v35
    v_exp_f32 v48, v48
    v_mfma_f32_32x32x16_bf16 v[16:31], a[4:7], v[132:135], v[16:31]
    s_waitcnt lgkmcnt(6)
    s_add_u32 m0, m0, 1024
    s_add_u32 s30, s39, 110592
    ds_read_b64_tr_b16 a[24:25], v2 offset:28672
    ds_read_b64_tr_b16 a[26:27], v2 offset:29184
    buffer_load_dwordx4 v11, s[12:15], s30 offen lds
    v_exp_f32 v49, v49
    v_mfma_f32_32x32x16_bf16 v[16:31], a[8:11], v[136:139], v[16:31]
    s_waitcnt lgkmcnt(6)
    ds_read_b64_tr_b16 a[28:29], v2 offset:30720
    ds_read_b64_tr_b16 a[30:31], v2 offset:31232
    v_fma_f32 v48, v48, v12, v12
    v_fma_f32 v49, v49, v12, v12
    v_rcp_f32 v48, v48
    v_mfma_f32_32x32x16_bf16 v[16:31], a[12:15], v[140:143], v[16:31]
    s_waitcnt lgkmcnt(6)
    ds_read_b64_tr_b16 a[0:1], v2 offset:32768
    ds_read_b64_tr_b16 a[2:3], v2 offset:33280
    v_rcp_f32 v49, v49
    v_mul_f32 v34, v34, v48
    v_mul_f32 v35, v35, v49
    v_cvt_pk_bf16_f32 v73, v34, v35
    v_mfma_f32_32x32x16_bf16 v[16:31], a[16:19], v[144:147], v[16:31]
    s_waitcnt lgkmcnt(6)
    ds_read_b64_tr_b16 a[4:5], v2 offset:34816
    ds_read_b64_tr_b16 a[6:7], v2 offset:35328
    v_mul_f32 v48, v36, v36
    v_mul_f32 v49, v37, v37
    v_fma_f32 v48, v48, v15, v14
    v_fma_f32 v49, v49, v15, v14
    v_mul_f32 v48, v48, v36
    v_mfma_f32_32x32x16_bf16 v[16:31], a[20:23], v[148:151], v[16:31]
    s_waitcnt lgkmcnt(6)
    s_add_u32 m0, m0, 1024
    s_add_u32 s30, s39, 138240
    ds_read_b64_tr_b16 a[8:9], v2 offset:36864
    ds_read_b64_tr_b16 a[10:11], v2 offset:37376
    buffer_load_dwordx4 v11, s[12:15], s30 offen lds
    v_mul_f32 v49, v49, v37
    v_mfma_f32_32x32x16_bf16 v[16:31], a[24:27], v[152:155], v[16:31]
    s_waitcnt lgkmcnt(6)
    ds_read_b64_tr_b16 a[12:13], v2 offset:38912
    ds_read_b64_tr_b16 a[14:15], v2 offset:39424
    v_exp_f32 v48, v48
    v_exp_f32 v49, v49
    v_fma_f32 v48, v48, v12, v12
    v_fma_f32 v49, v49, v12, v12
    v_mfma_f32_32x32x16_bf16 v[16:31], a[28:31], v[156:159], v[16:31]
    s_waitcnt lgkmcnt(6)
    v_add_u32 v2, 40960, v2
    ds_read_b64_tr_b16 a[16:17], v2 offset:0
    ds_read_b64_tr_b16 a[18:19], v2 offset:512
    v_rcp_f32 v48, v48
    v_rcp_f32 v49, v49
    v_mfma_f32_32x32x16_bf16 v[16:31], a[0:3], v[160:163], v[16:31]
    s_waitcnt lgkmcnt(6)
    ds_read_b64_tr_b16 a[20:21], v2 offset:2048
    ds_read_b64_tr_b16 a[22:23], v2 offset:2560
    v_mul_f32 v36, v36, v48
    v_mul_f32 v37, v37, v49
    v_cvt_pk_bf16_f32 v74, v36, v37
    v_mul_f32 v48, v38, v38
    v_mul_f32 v49, v39, v39
    v_mfma_f32_32x32x16_bf16 v[16:31], a[4:7], v[164:167], v[16:31]
    s_waitcnt lgkmcnt(6)
    s_add_u32 m0, m0, 1024
    s_add_u32 s30, s39, 165888
    ds_read_b64_tr_b16 a[24:25], v2 offset:4096
    ds_read_b64_tr_b16 a[26:27], v2 offset:4608
    buffer_load_dwordx4 v11, s[12:15], s30 offen lds
    v_fma_f32 v48, v48, v15, v14
    v_fma_f32 v49, v49, v15, v14
    v_mfma_f32_32x32x16_bf16 v[16:31], a[8:11], v[168:171], v[16:31]
    s_waitcnt lgkmcnt(6)
    ds_read_b64_tr_b16 a[28:29], v2 offset:6144
    ds_read_b64_tr_b16 a[30:31], v2 offset:6656
    v_mul_f32 v48, v48, v38
    v_mul_f32 v49, v49, v39
    v_exp_f32 v48, v48
    v_mfma_f32_32x32x16_bf16 v[16:31], a[12:15], v[172:175], v[16:31]
    s_waitcnt lgkmcnt(6)
    ds_read_b64_tr_b16 a[0:1], v2 offset:8192
    ds_read_b64_tr_b16 a[2:3], v2 offset:8704
    v_exp_f32 v49, v49
    v_fma_f32 v48, v48, v12, v12
    v_fma_f32 v49, v49, v12, v12
    v_mfma_f32_32x32x16_bf16 v[16:31], a[16:19], v[176:179], v[16:31]
    s_waitcnt lgkmcnt(6)
    ds_read_b64_tr_b16 a[4:5], v2 offset:10240
    ds_read_b64_tr_b16 a[6:7], v2 offset:10752
    v_rcp_f32 v48, v48
    v_rcp_f32 v49, v49
    v_mul_f32 v38, v38, v48
    v_mul_f32 v39, v39, v49
    v_mfma_f32_32x32x16_bf16 v[16:31], a[20:23], v[180:183], v[16:31]
    s_waitcnt lgkmcnt(6)
    s_add_u32 m0, m0, 1024
    s_add_u32 s30, s39, 193536
    ds_read_b64_tr_b16 a[8:9], v2 offset:12288
    ds_read_b64_tr_b16 a[10:11], v2 offset:12800
    buffer_load_dwordx4 v11, s[12:15], s30 offen lds
    v_cvt_pk_bf16_f32 v75, v38, v39
    v_mfma_f32_32x32x16_bf16 v[16:31], a[24:27], v[184:187], v[16:31]
    s_waitcnt lgkmcnt(6)
    ds_read_b64_tr_b16 a[12:13], v2 offset:14336
    ds_read_b64_tr_b16 a[14:15], v2 offset:14848
    buffer_store_dwordx4 v[72:75], v95, s[16:19], s36 offen offset:0 sc1
    v_mul_f32 v48, v40, v40
    v_mul_f32 v49, v41, v41
    v_fma_f32 v48, v48, v15, v14
    v_fma_f32 v49, v49, v15, v14
    v_mfma_f32_32x32x16_bf16 v[16:31], a[28:31], v[188:191], v[16:31]
    s_waitcnt lgkmcnt(6)
    ds_read_b64_tr_b16 a[16:17], v2 offset:16384
    ds_read_b64_tr_b16 a[18:19], v2 offset:16896
    v_mul_f32 v48, v48, v40
    v_mul_f32 v49, v49, v41
    v_exp_f32 v48, v48
    v_mfma_f32_32x32x16_bf16 v[16:31], a[0:3], v[192:195], v[16:31]
    s_waitcnt lgkmcnt(6)
    ds_read_b64_tr_b16 a[20:21], v2 offset:18432
    ds_read_b64_tr_b16 a[22:23], v2 offset:18944
    v_exp_f32 v49, v49
    v_fma_f32 v48, v48, v12, v12
    v_fma_f32 v49, v49, v12, v12
    v_mfma_f32_32x32x16_bf16 v[16:31], a[4:7], v[196:199], v[16:31]
    s_waitcnt lgkmcnt(6)
    s_add_u32 m0, m0, 1024
    s_add_u32 s30, s39, 221184
    ds_read_b64_tr_b16 a[24:25], v2 offset:20480
    ds_read_b64_tr_b16 a[26:27], v2 offset:20992
    buffer_load_dwordx4 v11, s[12:15], s30 offen lds
    v_rcp_f32 v48, v48
    v_mfma_f32_32x32x16_bf16 v[16:31], a[8:11], v[200:203], v[16:31]
    s_waitcnt lgkmcnt(6)
    ds_read_b64_tr_b16 a[28:29], v2 offset:22528
    ds_read_b64_tr_b16 a[30:31], v2 offset:23040
    v_rcp_f32 v49, v49
    v_mul_f32 v40, v40, v48
    v_mul_f32 v41, v41, v49
    v_cvt_pk_bf16_f32 v76, v40, v41
    v_mul_f32 v48, v42, v42
    v_mfma_f32_32x32x16_bf16 v[16:31], a[12:15], v[204:207], v[16:31]
    s_waitcnt lgkmcnt(6)
    ds_read_b64_tr_b16 a[0:1], v2 offset:24576
    ds_read_b64_tr_b16 a[2:3], v2 offset:25088
    v_mul_f32 v49, v43, v43
    v_fma_f32 v48, v48, v15, v14
    v_fma_f32 v49, v49, v15, v14
    v_mul_f32 v48, v48, v42
    v_mfma_f32_32x32x16_bf16 v[16:31], a[16:19], v[208:211], v[16:31]
    s_waitcnt lgkmcnt(6)
    ds_read_b64_tr_b16 a[4:5], v2 offset:26624
    ds_read_b64_tr_b16 a[6:7], v2 offset:27136
    v_mul_f32 v49, v49, v43
    v_exp_f32 v48, v48
    v_exp_f32 v49, v49
    v_mfma_f32_32x32x16_bf16 v[16:31], a[20:23], v[212:215], v[16:31]
    s_waitcnt lgkmcnt(6)
    s_add_u32 m0, m0, 1024
    s_add_u32 s30, s39, 248832
    ds_read_b64_tr_b16 a[8:9], v2 offset:28672
    ds_read_b64_tr_b16 a[10:11], v2 offset:29184
    buffer_load_dwordx4 v11, s[12:15], s30 offen lds
    v_fma_f32 v48, v48, v12, v12
    v_fma_f32 v49, v49, v12, v12
    v_mfma_f32_32x32x16_bf16 v[16:31], a[24:27], v[216:219], v[16:31]
    s_waitcnt lgkmcnt(6)
    ds_read_b64_tr_b16 a[12:13], v2 offset:30720
    ds_read_b64_tr_b16 a[14:15], v2 offset:31232
    v_rcp_f32 v48, v48
    v_rcp_f32 v49, v49
    v_mul_f32 v42, v42, v48
    v_mfma_f32_32x32x16_bf16 v[16:31], a[28:31], v[220:223], v[16:31]
    s_waitcnt lgkmcnt(6)
    ds_read_b64_tr_b16 a[16:17], v2 offset:32768
    ds_read_b64_tr_b16 a[18:19], v2 offset:33280
    v_mul_f32 v43, v43, v49
    v_cvt_pk_bf16_f32 v77, v42, v43
    v_mul_f32 v48, v44, v44
    v_mul_f32 v49, v45, v45
    v_mfma_f32_32x32x16_bf16 v[16:31], a[0:3], v[224:227], v[16:31]
    s_waitcnt lgkmcnt(6)
    ds_read_b64_tr_b16 a[20:21], v2 offset:34816
    ds_read_b64_tr_b16 a[22:23], v2 offset:35328
    v_fma_f32 v48, v48, v15, v14
    v_fma_f32 v49, v49, v15, v14
    v_mul_f32 v48, v48, v44
    v_mul_f32 v49, v49, v45
    v_mfma_f32_32x32x16_bf16 v[16:31], a[4:7], v[228:231], v[16:31]
    s_waitcnt lgkmcnt(6)
    ds_read_b64_tr_b16 a[24:25], v2 offset:36864
    ds_read_b64_tr_b16 a[26:27], v2 offset:37376
    v_exp_f32 v48, v48
    v_exp_f32 v49, v49
    v_fma_f32 v48, v48, v12, v12
    v_mfma_f32_32x32x16_bf16 v[16:31], a[8:11], v[232:235], v[16:31]
    s_waitcnt lgkmcnt(6)
    ds_read_b64_tr_b16 a[28:29], v2 offset:38912
    ds_read_b64_tr_b16 a[30:31], v2 offset:39424
    v_fma_f32 v49, v49, v12, v12
    v_rcp_f32 v48, v48
    v_rcp_f32 v49, v49
    v_mfma_f32_32x32x16_bf16 v[16:31], a[12:15], v[236:239], v[16:31]
    s_waitcnt lgkmcnt(6)
    ds_read_b64_tr_b16 a[0:1], v3 offset:0
    ds_read_b64_tr_b16 a[2:3], v3 offset:512
    v_mul_f32 v44, v44, v48
    v_mul_f32 v45, v45, v49
    v_cvt_pk_bf16_f32 v78, v44, v45
    v_mul_f32 v48, v46, v46
    v_mfma_f32_32x32x16_bf16 v[16:31], a[16:19], v[240:243], v[16:31]
    s_waitcnt lgkmcnt(6)
    ds_read_b64_tr_b16 a[4:5], v3 offset:2048
    ds_read_b64_tr_b16 a[6:7], v3 offset:2560
    v_mul_f32 v49, v47, v47
    v_fma_f32 v48, v48, v15, v14
    v_fma_f32 v49, v49, v15, v14
    v_mul_f32 v48, v48, v46
    v_mul_f32 v49, v49, v47
    v_mfma_f32_32x32x16_bf16 v[16:31], a[20:23], v[244:247], v[16:31]
    s_waitcnt lgkmcnt(6)
    ds_read_b64_tr_b16 a[8:9], v3 offset:4096
    ds_read_b64_tr_b16 a[10:11], v3 offset:4608
    v_exp_f32 v48, v48
    v_exp_f32 v49, v49
    v_mfma_f32_32x32x16_bf16 v[16:31], a[24:27], v[248:251], v[16:31]
    s_waitcnt lgkmcnt(6)
    ds_read_b64_tr_b16 a[12:13], v3 offset:6144
    ds_read_b64_tr_b16 a[14:15], v3 offset:6656
    v_fma_f32 v48, v48, v12, v12
    v_fma_f32 v49, v49, v12, v12
    v_rcp_f32 v48, v48
    v_mfma_f32_32x32x16_bf16 v[16:31], a[28:31], v[252:255], v[16:31]
    s_waitcnt lgkmcnt(6)
    ds_read_b64_tr_b16 a[16:17], v3 offset:8192
    ds_read_b64_tr_b16 a[18:19], v3 offset:8704
    v_rcp_f32 v49, v49
    v_mul_f32 v46, v46, v48
    v_mul_f32 v47, v47, v49
    v_cvt_pk_bf16_f32 v79, v46, v47
    buffer_store_dwordx4 v[76:79], v95, s[16:19], s36 offen offset:512 sc1
    s_sub_u32 s31, -81920, s31
    s_sub_u32 s34, 81920, s34
    s_lshl_b32 s28, s26, 2
    s_add_u32 s28, s28, s32
    s_cmp_eq_u32 s28, 1
    s_cbranch_scc1 k1_s1
k1_pb:
    s_and_b32 s28, s45, 0xff
    s_lshl_b32 s35, s28, 11
    s_add_u32 s35, s35, s41
    s_add_u32 s36, s35, 1024
    s_cmp_eq_u32 s28, 13
    s_cselect_b32 s36, s35, s36
    s_cmp_eq_u32 s28, 14
    s_cselect_b32 s36, 0xf0000000, s36
    s_cmp_ge_u32 s28, 13
    s_cselect_b32 s35, 0xf0000000, s35
    s_cselect_b32 s37, 64, 0
    v_mfma_f32_32x32x16_bf16 v[32:47], a[0:3], v[96:99], 0
    s_waitcnt lgkmcnt(6)
    s_bfe_u32 s28, s45, 0x80010
    s_lshl_b32 s28, s28, 7
    s_add_u32 s38, s50, s28
    s_add_u32 s39, s38, 1105920
    s_add_u32 s44, s34, 40960
    s_add_u32 s28, s32, 2
    s_cmp_le_u32 s28, s33
    s_cselect_b32 s14, 2211840, 0
    s_lshr_b32 s45, s45, 8
    ds_read_b64_tr_b16 a[20:21], v3 offset:10240
    ds_read_b64_tr_b16 a[22:23], v3 offset:10752
    v_mfma_f32_32x32x16_bf16 v[32:47], a[4:7], v[100:103], v[32:47]
    s_waitcnt lgkmcnt(6)
    v_add_u32 v2, s31, v2
    v_xor_b32 v2, s37, v2
    ds_read_b64_tr_b16 a[24:25], v3 offset:12288
    ds_read_b64_tr_b16 a[26:27], v3 offset:12800
    v_mfma_f32_32x32x16_bf16 v[32:47], a[8:11], v[104:107], v[32:47]
    s_waitcnt lgkmcnt(6)
    ds_read_b64_tr_b16 a[28:29], v3 offset:14336
    ds_read_b64_tr_b16 a[30:31], v3 offset:14848
    v_mfma_f32_32x32x16_bf16 v[32:47], a[12:15], v[108:111], v[32:47]
    s_waitcnt lgkmcnt(6)
    ds_read_b64_tr_b16 a[0:1], v3 offset:16384
    ds_read_b64_tr_b16 a[2:3], v3 offset:16896
    v_mul_f32 v48, v16, v16
    v_mul_f32 v49, v17, v17
    v_fma_f32 v48, v48, v15, v14
    v_fma_f32 v49, v49, v15, v14
    v_mul_f32 v48, v48, v16
    v_mul_f32 v49, v49, v17
    v_mfma_f32_32x32x16_bf16 v[32:47], a[16:19], v[112:115], v[32:47]
    s_waitcnt lgkmcnt(6)
    ds_read_b64_tr_b16 a[4:5], v3 offset:18432
    ds_read_b64_tr_b16 a[6:7], v3 offset:18944
    v_exp_f32 v48, v48
    v_exp_f32 v49, v49
    v_fma_f32 v48, v48, v12, v12
    v_mfma_f32_32x32x16_bf16 v[32:47], a[20:23], v[116:119], v[32:47]
    s_waitcnt lgkmcnt(6)
    ds_read_b64_tr_b16 a[8:9], v3 offset:20480
    ds_read_b64_tr_b16 a[10:11], v3 offset:20992
    v_fma_f32 v49, v49, v12, v12
    v_rcp_f32 v48, v48
    v_mfma_f32_32x32x16_bf16 v[32:47], a[24:27], v[120:123], v[32:47]
    s_waitcnt lgkmcnt(6)
    ds_read_b64_tr_b16 a[12:13], v3 offset:22528
    ds_read_b64_tr_b16 a[14:15], v3 offset:23040
    v_rcp_f32 v49, v49
    v_mul_f32 v16, v16, v48
    v_mul_f32 v17, v17, v49
    v_cvt_pk_bf16_f32 v64, v16, v17
    v_mul_f32 v48, v18, v18
    v_mfma_f32_32x32x16_bf16 v[32:47], a[28:31], v[124:127], v[32:47]
    s_waitcnt lgkmcnt(6)
    ds_read_b64_tr_b16 a[16:17], v3 offset:24576
    ds_read_b64_tr_b16 a[18:19], v3 offset:25088
    v_mul_f32 v49, v19, v19
    v_fma_f32 v48, v48, v15, v14
    v_fma_f32 v49, v49, v15, v14
    v_mul_f32 v48, v48, v18
    v_mfma_f32_32x32x16_bf16 v[32:47], a[0:3], v[128:131], v[32:47]
    s_waitcnt lgkmcnt(6)
    ds_read_b64_tr_b16 a[20:21], v3 offset:26624
    ds_read_b64_tr_b16 a[22:23], v3 offset:27136
    v_mul_f32 v49, v49, v19
    v_exp_f32 v48, v48
    v_exp_f32 v49, v49
    v_mfma_f32_32x32x16_bf16 v[32:47], a[4:7], v[132:135], v[32:47]
    s_waitcnt lgkmcnt(6)
    ds_read_b64_tr_b16 a[24:25], v3 offset:28672
    ds_read_b64_tr_b16 a[26:27], v3 offset:29184
    v_fma_f32 v48, v48, v12, v12
    v_fma_f32 v49, v49, v12, v12
    v_rcp_f32 v48, v48
    v_mfma_f32_32x32x16_bf16 v[32:47], a[8:11], v[136:139], v[32:47]
    s_waitcnt lgkmcnt(6)
    ds_read_b64_tr_b16 a[28:29], v3 offset:30720
    ds_read_b64_tr_b16 a[30:31], v3 offset:31232
    v_rcp_f32 v49, v49
    v_mul_f32 v18, v18, v48
    v_mul_f32 v19, v19, v49
    v_cvt_pk_bf16_f32 v65, v18, v19
    v_mfma_f32_32x32x16_bf16 v[32:47], a[12:15], v[140:143], v[32:47]
    s_waitcnt lgkmcnt(6)
    ds_read_b64_tr_b16 a[0:1], v3 offset:32768
    ds_read_b64_tr_b16 a[2:3], v3 offset:33280
    v_mul_f32 v48, v20, v20
    v_mul_f32 v49, v21, v21
    v_fma_f32 v48, v48, v15, v14
    v_fma_f32 v49, v49, v15, v14
    v_mfma_f32_32x32x16_bf16 v[32:47], a[16:19], v[144:147], v[32:47]
    s_waitcnt lgkmcnt(6)
    ds_read_b64_tr_b16 a[4:5], v3 offset:34816
    ds_read_b64_tr_b16 a[6:7], v3 offset:35328
    v_mul_f32 v48, v48, v20
    v_mul_f32 v49, v49, v21
    v_exp_f32 v48, v48
    v_mfma_f32_32x32x16_bf16 v[32:47], a[20:23], v[148:151], v[32:47]
    s_waitcnt lgkmcnt(6)
    ds_read_b64_tr_b16 a[8:9], v3 offset:36864
    ds_read_b64_tr_b16 a[10:11], v3 offset:37376
    v_exp_f32 v49, v49
    v_fma_f32 v48, v48, v12, v12
    v_fma_f32 v49, v49, v12, v12
    v_mfma_f32_32x32x16_bf16 v[32:47], a[24:27], v[152:155], v[32:47]
    s_waitcnt lgkmcnt(6)
    ds_read_b64_tr_b16 a[12:13], v3 offset:38912
    ds_read_b64_tr_b16 a[14:15], v3 offset:39424
    v_rcp_f32 v48, v48
    v_rcp_f32 v49, v49
    v_mul_f32 v20, v20, v48
    v_mul_f32 v21, v21, v49
    v_mfma_f32_32x32x16_bf16 v[32:47], a[28:31], v[156:159], v[32:47]
    s_waitcnt vmcnt(63) lgkmcnt(6)
    s_barrier
    v_add_u32 v3, 40960, v3
    ds_read_b64_tr_b16 a[16:17], v3 offset:0
    ds_read_b64_tr_b16 a[18:19], v3 offset:512
    v_cvt_pk_bf16_f32 v66, v20, v21
    v_mul_f32 v48, v22, v22
    v_mul_f32 v49, v23, v23
    v_fma_f32 v48, v48, v15, v14
    v_mfma_f32_32x32x16_bf16 v[32:47], a[0:3], v[160:163], v[32:47]
    s_waitcnt lgkmcnt(6)
    s_add_u32 m0, s27, s34
    s_add_u32 s30, s38, 0
    ds_read_b64_tr_b16 a[20:21], v3 offset:2048
    ds_read_b64_tr_b16 a[22:23], v3 offset:2560
    buffer_load_dwordx4 v11, s[12:15], s30 offen lds
    v_fma_f32 v49, v49, v15, v14
    v_mul_f32 v48, v48, v22
    v_mul_f32 v49, v49, v23
    v_mfma_f32_32x32x16_bf16 v[32:47], a[4:7], v[164:167], v[32:47]
    s_waitcnt lgkmcnt(6)
    ds_read_b64_tr_b16 a[24:25], v3 offset:4096
    ds_read_b64_tr_b16 a[26:27], v3 offset:4608
    v_exp_f32 v48, v48
    v_exp_f32 v49, v49
    v_mfma_f32_32x32x16_bf16 v[32:47], a[8:11], v[168:171], v[32:47]
    s_waitcnt lgkmcnt(6)
    s_add_u32 m0, m0, 1024
    s_add_u32 s30, s38, 27648
    ds_read_b64_tr_b16 a[28:29], v3 offset:6144
    ds_read_b64_tr_b16 a[30:31], v3 offset:6656
    buffer_load_dwordx4 v11, s[12:15], s30 offen lds
    v_fma_f32 v48, v48, v12, v12
    v_fma_f32 v49, v49, v12, v12
    v_mfma_f32_32x32x16_bf16 v[32:47], a[12:15], v[172:175], v[32:47]
    s_waitcnt lgkmcnt(6)
    ds_read_b64_tr_b16 a[0:1], v3 offset:8192
    ds_read_b64_tr_b16 a[2:3], v3 offset:8704
    v_rcp_f32 v48, v48
    v_rcp_f32 v49, v49
    v_mul_f32 v22, v22, v48
    v_mfma_f32_32x32x16_bf16 v[32:47], a[16:19], v[176:179], v[32:47]
    s_waitcnt lgkmcnt(6)
    s_add_u32 m0, m0, 1024
    s_add_u32 s30, s38, 55296
    ds_read_b64_tr_b16 a[4:5], v3 offset:10240
    ds_read_b64_tr_b16 a[6:7], v3 offset:10752
    buffer_load_dwordx4 v11, s[12:15], s30 offen lds
    v_mul_f32 v23, v23, v49
    v_cvt_pk_bf16_f32 v67, v22, v23
    v_mfma_f32_32x32x16_bf16 v[32:47], a[20:23], v[180:183], v[32:47]
    s_waitcnt lgkmcnt(6)
    ds_read_b64_tr_b16 a[8:9], v3 offset:12288
    ds_read_b64_tr_b16 a[10:11], v3 offset:12800
    buffer_store_dwordx4 v[64:67], v95, s[16:19], s35 offen offset:0 sc1
    v_mul_f32 v48, v24, v24
    v_mul_f32 v49, v25, v25
    v_fma_f32 v48, v48, v15, v14
    v_mfma_f32_32x32x16_bf16 v[32:47], a[24:27], v[184:187], v[32:47]
    s_waitcnt lgkmcnt(6)
    s_add_u32 m0, m0, 1024
    s_add_u32 s30, s38, 82944
    ds_read_b64_tr_b16 a[12:13], v3 offset:14336
    ds_read_b64_tr_b16 a[14:15], v3 offset:14848
    buffer_load_dwordx4 v11, s[12:15], s30 offen lds
    v_fma_f32 v49, v49, v15, v14
    v_mul_f32 v48, v48, v24
    v_mul_f32 v49, v49, v25
    v_mfma_f32_32x32x16_bf16 v[32:47], a[28:31], v[188:191], v[32:47]
    s_waitcnt lgkmcnt(6)
    ds_read_b64_tr_b16 a[16:17], v3 offset:16384
    ds_read_b64_tr_b16 a[18:19], v3 offset:16896
    v_exp_f32 v48, v48
    v_exp_f32 v49, v49
    v_mfma_f32_32x32x16_bf16 v[32:47], a[0:3], v[192:195], v[32:47]
    s_waitcnt lgkmcnt(6)
    s_add_u32 m0, m0, 1024
    s_add_u32 s30, s38, 110592
    ds_read_b64_tr_b16 a[20:21], v3 offset:18432
    ds_read_b64_tr_b16 a[22:23], v3 offset:18944
    buffer_load_dwordx4 v11, s[12:15], s30 offen lds
    v_fma_f32 v48, v48, v12, v12
    v_fma_f32 v49, v49, v12, v12
    v_mfma_f32_32x32x16_bf16 v[32:47], a[4:7], v[196:199], v[32:47]
    s_waitcnt lgkmcnt(6)
    ds_read_b64_tr_b16 a[24:25], v3 offset:20480
    ds_read_b64_tr_b16 a[26:27], v3 offset:20992
    v_rcp_f32 v48, v48
    v_rcp_f32 v49, v49
    v_mul_f32 v24, v24, v48
    v_mfma_f32_32x32x16_bf16 v[32:47], a[8:11], v[200:203], v[32:47]
    s_waitcnt lgkmcnt(6)
    s_add_u32 m0, m0, 1024
    s_add_u32 s30, s38, 138240
    ds_read_b64_tr_b16 a[28:29], v3 offset:22528
    ds_read_b64_tr_b16 a[30:31], v3 offset:23040
    buffer_load_dwordx4 v11, s[12:15], s30 offen lds
    v_mul_f32 v25, v25, v49
    v_cvt_pk_bf16_f32 v68, v24, v25
    v_mul_f32 v48, v26, v26
    v_mfma_f32_32x32x16_bf16 v[32:47], a[12:15], v[204:207], v[32:47]
    s_waitcnt lgkmcnt(6)
    ds_read_b64_tr_b16 a[0:1], v3 offset:24576
    ds_read_b64_tr_b16 a[2:3], v3 offset:25088
    v_mul_f32 v49, v27, v27
    v_fma_f32 v48, v48, v15, v14
    v_fma_f32 v49, v49, v15, v14
    v_mul_f32 v48, v48, v26
    v_mfma_f32_32x32x16_bf16 v[32:47], a[16:19], v[208:211], v[32:47]
    s_waitcnt lgkmcnt(6)
    s_add_u32 m0, m0, 1024
    s_add_u32 s30, s38, 165888
    ds_read_b64_tr_b16 a[4:5], v3 offset:26624
    ds_read_b64_tr_b16 a[6:7], v3 offset:27136
    buffer_load_dwordx4 v11, s[12:15], s30 offen lds
    v_mul_f32 v49, v49, v27
    v_exp_f32 v48, v48
    v_mfma_f32_32x32x16_bf16 v[32:47], a[20:23], v[212:215], v[32:47]
    s_waitcnt lgkmcnt(6)
    ds_read_b64_tr_b16 a[8:9], v3 offset:28672
    ds_read_b64_tr_b16 a[10:11], v3 offset:29184
    v_exp_f32 v49, v49
    v_fma_f32 v48, v48, v12, v12
    v_fma_f32 v49, v49, v12, v12
    v_mfma_f32_32x32x16_bf16 v[32:47], a[24:27], v[216:219], v[32:47]
    s_waitcnt lgkmcnt(6)
    s_add_u32 m0, m0, 1024
    s_add_u32 s30, s38, 193536
    ds_read_b64_tr_b16 a[12:13], v3 offset:30720
    ds_read_b64_tr_b16 a[14:15], v3 offset:31232
    buffer_load_dwordx4 v11, s[12:15], s30 offen lds
    v_rcp_f32 v48, v48
    v_mfma_f32_32x32x16_bf16 v[32:47], a[28:31], v[220:223], v[32:47]
    s_waitcnt lgkmcnt(6)
    ds_read_b64_tr_b16 a[16:17], v3 offset:32768
    ds_read_b64_tr_b16 a[18:19], v3 offset:33280
    v_rcp_f32 v49, v49
    v_mul_f32 v26, v26, v48
    v_mul_f32 v27, v27, v49
    v_cvt_pk_bf16_f32 v69, v26, v27
    v_mfma_f32_32x32x16_bf16 v[32:47], a[0:3], v[224:227], v[32:47]
    s_waitcnt lgkmcnt(6)
    s_add_u32 m0, m0, 1024
    s_add_u32 s30, s38, 221184
    ds_read_b64_tr_b16 a[20:21], v3 offset:34816
    ds_read_b64_tr_b16 a[22:23], v3 offset:35328
    buffer_load_dwordx4 v11, s[12:15], s30 offen lds
    v_mul_f32 v48, v28, v28
    v_mul_f32 v49, v29, v29
    v_fma_f32 v48, v48, v15, v14
    v_mfma_f32_32x32x16_bf16 v[32:47], a[4:7], v[228:231], v[32:47]
    s_waitcnt lgkmcnt(6)
    ds_read_b64_tr_b16 a[24:25], v3 offset:36864
    ds_read_b64_tr_b16 a[26:27], v3 offset:37376
    v_fma_f32 v49, v49, v15, v14
    v_mul_f32 v48, v48, v28
    v_mul_f32 v49, v49, v29
    v_mfma_f32_32x32x16_bf16 v[32:47], a[8:11], v[232:235], v[32:47]
    s_waitcnt lgkmcnt(6)
    s_add_u32 m0, m0, 1024
    s_add_u32 s30, s38, 248832
    ds_read_b64_tr_b16 a[28:29], v3 offset:38912
    ds_read_b64_tr_b16 a[30:31], v3 offset:39424
    buffer_load_dwordx4 v11, s[12:15], s30 offen lds
    v_exp_f32 v48, v48
    v_exp_f32 v49, v49
    v_mfma_f32_32x32x16_bf16 v[32:47], a[12:15], v[236:239], v[32:47]
    s_waitcnt vmcnt(10) lgkmcnt(6)
    s_barrier
    ds_read_b64_tr_b16 a[0:1], v2 offset:0
    ds_read_b64_tr_b16 a[2:3], v2 offset:512
    v_fma_f32 v48, v48, v12, v12
    v_fma_f32 v49, v49, v12, v12
    v_rcp_f32 v48, v48
    v_mfma_f32_32x32x16_bf16 v[32:47], a[16:19], v[240:243], v[32:47]
    s_waitcnt lgkmcnt(6)
    ds_read_b64_tr_b16 a[4:5], v2 offset:2048
    ds_read_b64_tr_b16 a[6:7], v2 offset:2560
    v_rcp_f32 v49, v49
    v_mul_f32 v28, v28, v48
    v_mul_f32 v29, v29, v49
    v_cvt_pk_bf16_f32 v70, v28, v29
    v_mfma_f32_32x32x16_bf16 v[32:47], a[20:23], v[244:247], v[32:47]
    s_waitcnt lgkmcnt(6)
    ds_read_b64_tr_b16 a[8:9], v2 offset:4096
    ds_read_b64_tr_b16 a[10:11], v2 offset:4608
    v_mul_f32 v48, v30, v30
    v_mul_f32 v49, v31, v31
    v_fma_f32 v48, v48, v15, v14
    v_fma_f32 v49, v49, v15, v14
    v_mfma_f32_32x32x16_bf16 v[32:47], a[24:27], v[248:251], v[32:47]
    s_waitcnt lgkmcnt(6)
    ds_read_b64_tr_b16 a[12:13], v2 offset:6144
    ds_read_b64_tr_b16 a[14:15], v2 offset:6656
    v_mul_f32 v48, v48, v30
    v_mul_f32 v49, v49, v31
    v_exp_f32 v48, v48
    v_mfma_f32_32x32x16_bf16 v[32:47], a[28:31], v[252:255], v[32:47]
    s_waitcnt lgkmcnt(6)
    ds_read_b64_tr_b16 a[16:17], v2 offset:8192
    ds_read_b64_tr_b16 a[18:19], v2 offset:8704
    v_exp_f32 v49, v49
    v_fma_f32 v48, v48, v12, v12
    v_fma_f32 v49, v49, v12, v12
    v_rcp_f32 v48, v48
    v_rcp_f32 v49, v49
    v_mul_f32 v30, v30, v48
    v_mul_f32 v31, v31, v49
    v_cvt_pk_bf16_f32 v71, v30, v31
    buffer_store_dwordx4 v[68:71], v95, s[16:19], s35 offen offset:512 sc1
    s_cmp_lg_u32 s37, 0
    s_cbranch_scc1 k1_s0
k1_next:
    s_add_u32 s32, s32, 1
    s_cmp_le_u32 s32, s33
    s_cbranch_scc1 k1_loop
    s_cmp_lg_u32 s26, 0
    s_cbranch_scc1 k1_nop
    s_add_u32 s29, s47, 0
    buffer_load_dwordx4 v[160:163], v57, s[16:19], s29 offen offset:0 sc1
    buffer_load_dwordx4 v[164:167], v57, s[16:19], s29 offen offset:2048 sc1
    s_add_u32 s29, s47, 4096
    buffer_load_dwordx4 v[168:171], v57, s[16:19], s29 offen offset:0 sc1
    buffer_load_dwordx4 v[172:175], v57, s[16:19], s29 offen offset:2048 sc1
    s_add_u32 s29, s47, 8192
    buffer_load_dwordx4 v[176:179], v57, s[16:19], s29 offen offset:0 sc1
    buffer_load_dwordx4 v[180:183], v57, s[16:19], s29 offen offset:2048 sc1
    s_add_u32 s29, s47, 12288
    buffer_load_dwordx4 v[184:187], v57, s[16:19], s29 offen offset:0 sc1
k1_nop:
    s_nop 7
    v_mul_f32 v48, v32, v32
    v_mul_f32 v49, v33, v33
    v_fma_f32 v48, v48, v15, v14
    v_fma_f32 v49, v49, v15, v14
    v_mul_f32 v48, v48, v32
    v_mul_f32 v49, v49, v33
    v_exp_f32 v48, v48
    v_exp_f32 v49, v49
    v_fma_f32 v48, v48, v12, v12
    v_fma_f32 v49, v49, v12, v12
    v_rcp_f32 v48, v48
    v_rcp_f32 v49, v49
    v_mul_f32 v32, v32, v48
    v_mul_f32 v33, v33, v49
    v_cvt_pk_bf16_f32 v72, v32, v33
    v_mul_f32 v48, v34, v34
    v_mul_f32 v49, v35, v35
    v_fma_f32 v48, v48, v15, v14
    v_fma_f32 v49, v49, v15, v14
    v_mul_f32 v48, v48, v34
    v_mul_f32 v49, v49, v35
    v_exp_f32 v48, v48
    v_exp_f32 v49, v49
    v_fma_f32 v48, v48, v12, v12
    v_fma_f32 v49, v49, v12, v12
    v_rcp_f32 v48, v48
    v_rcp_f32 v49, v49
    v_mul_f32 v34, v34, v48
    v_mul_f32 v35, v35, v49
    v_cvt_pk_bf16_f32 v73, v34, v35
    v_mul_f32 v48, v36, v36
    v_mul_f32 v49, v37, v37
    v_fma_f32 v48, v48, v15, v14
    v_fma_f32 v49, v49, v15, v14
    v_mul_f32 v48, v48, v36
    v_mul_f32 v49, v49, v37
    v_exp_f32 v48, v48
    v_exp_f32 v49, v49
    v_fma_f32 v48, v48, v12, v12
    v_fma_f32 v49, v49, v12, v12
    v_rcp_f32 v48, v48
    v_rcp_f32 v49, v49
    v_mul_f32 v36, v36, v48
    v_mul_f32 v37, v37, v49
    v_cvt_pk_bf16_f32 v74, v36, v37
    v_mul_f32 v48, v38, v38
    v_mul_f32 v49, v39, v39
    v_fma_f32 v48, v48, v15, v14
    v_fma_f32 v49, v49, v15, v14
    v_mul_f32 v48, v48, v38
    v_mul_f32 v49, v49, v39
    v_exp_f32 v48, v48
    v_exp_f32 v49, v49
    v_fma_f32 v48, v48, v12, v12
    v_fma_f32 v49, v49, v12, v12
    v_rcp_f32 v48, v48
    v_rcp_f32 v49, v49
    v_mul_f32 v38, v38, v48
    v_mul_f32 v39, v39, v49
    v_cvt_pk_bf16_f32 v75, v38, v39
    buffer_store_dwordx4 v[72:75], v95, s[16:19], s36 offen offset:0 sc1
    v_mul_f32 v48, v40, v40
    v_mul_f32 v49, v41, v41
    v_fma_f32 v48, v48, v15, v14
    v_fma_f32 v49, v49, v15, v14
    v_mul_f32 v48, v48, v40
    v_mul_f32 v49, v49, v41
    v_exp_f32 v48, v48
    v_exp_f32 v49, v49
    v_fma_f32 v48, v48, v12, v12
    v_fma_f32 v49, v49, v12, v12
    v_rcp_f32 v48, v48
    v_rcp_f32 v49, v49
    v_mul_f32 v40, v40, v48
    v_mul_f32 v41, v41, v49
    v_cvt_pk_bf16_f32 v76, v40, v41
    v_mul_f32 v48, v42, v42
    v_mul_f32 v49, v43, v43
    v_fma_f32 v48, v48, v15, v14
    v_fma_f32 v49, v49, v15, v14
    v_mul_f32 v48, v48, v42
    v_mul_f32 v49, v49, v43
    v_exp_f32 v48, v48
    v_exp_f32 v49, v49
    v_fma_f32 v48, v48, v12, v12
    v_fma_f32 v49, v49, v12, v12
    v_rcp_f32 v48, v48
    v_rcp_f32 v49, v49
    v_mul_f32 v42, v42, v48
    v_mul_f32 v43, v43, v49
    v_cvt_pk_bf16_f32 v77, v42, v43
    v_mul_f32 v48, v44, v44
    v_mul_f32 v49, v45, v45
    v_fma_f32 v48, v48, v15, v14
    v_fma_f32 v49, v49, v15, v14
    v_mul_f32 v48, v48, v44
    v_mul_f32 v49, v49, v45
    v_exp_f32 v48, v48
    v_exp_f32 v49, v49
    v_fma_f32 v48, v48, v12, v12
    v_fma_f32 v49, v49, v12, v12
    v_rcp_f32 v48, v48
    v_rcp_f32 v49, v49
    v_mul_f32 v44, v44, v48
    v_mul_f32 v45, v45, v49
    v_cvt_pk_bf16_f32 v78, v44, v45
    v_mul_f32 v48, v46, v46
    v_mul_f32 v49, v47, v47
    v_fma_f32 v48, v48, v15, v14
    v_fma_f32 v49, v49, v15, v14
    v_mul_f32 v48, v48, v46
    v_mul_f32 v49, v49, v47
    v_exp_f32 v48, v48
    v_exp_f32 v49, v49
    v_fma_f32 v48, v48, v12, v12
    v_fma_f32 v49, v49, v12, v12
    v_rcp_f32 v48, v48
    v_rcp_f32 v49, v49
    v_mul_f32 v46, v46, v48
    v_mul_f32 v47, v47, v49
    v_cvt_pk_bf16_f32 v79, v46, v47
    buffer_store_dwordx4 v[76:79], v95, s[16:19], s36 offen offset:512 sc1
    s_cmp_lg_u32 s26, 0
    s_cbranch_scc1 k1_fin
    s_waitcnt vmcnt(2)
    v_cmp_eq_u64 s[54:55], s[48:49], v[162:163]
    s_and_b64 s[56:57], s[54:55], exec
    v_cmp_eq_u64 s[54:55], s[48:49], v[166:167]
    s_and_b64 s[56:57], s[54:55], s[56:57]
    v_cmp_eq_u64 s[54:55], s[48:49], v[170:171]
    s_and_b64 s[56:57], s[54:55], s[56:57]
    v_cmp_eq_u64 s[54:55], s[48:49], v[174:175]
    s_and_b64 s[56:57], s[54:55], s[56:57]
    v_cmp_eq_u64 s[54:55], s[48:49], v[178:179]
    s_and_b64 s[56:57], s[54:55], s[56:57]
    v_cmp_eq_u64 s[54:55], s[48:49], v[182:183]
    s_and_b64 s[56:57], s[54:55], s[56:57]
    v_cmp_eq_u64 s[54:55], s[48:49], v[186:187]
    s_and_b64 s[56:57], s[54:55], s[56:57]
    s_andn2_b64 s[56:57], exec, s[56:57]
    s_cbranch_scc1 k1_b_re
k1_b_got:
    v_add_f32 v160, v160, v164
    v_add_f32 v161, v161, v165
    v_add_f32 v160, v160, v168
    v_add_f32 v161, v161, v169
    v_add_f32 v160, v160, v172
    v_add_f32 v161, v161, v173
    v_add_f32 v160, v160, v176
    v_add_f32 v161, v161, v177
    v_add_f32 v160, v160, v180
    v_add_f32 v161, v161, v181
    v_add_f32 v160, v160, v184
    v_add_f32 v161, v161, v185
    v_mov_b32 v162, v160
    v_mov_b32 v163, v161
    s_nop 1
    v_permlane32_swap_b32 v160, v162
    v_permlane32_swap_b32 v161, v163
    s_nop 0
    v_add_f32 v160, v160, v162
    v_add_f32 v161, v161, v163
    v_mul_f32 v160, 0x3a97b426, v160
    v_mul_f32 v161, 0x3a97b426, v161
    v_fma_f32 v161, -v160, v160, v161
    v_max_f32 v161, 0, v161
    v_cvt_pk_bf16_f32 v160, v160, v160
    v_lshlrev_b32 v160, 16, v160
    v_cvt_pk_bf16_f32 v161, v161, v161
    v_lshlrev_b32 v161, 16, v161
    v_add_f32 v161, 0x3727c5ac, v161
    v_cvt_pk_bf16_f32 v161, v161, v161
    v_lshlrev_b32 v161, 16, v161
    v_sqrt_f32 v161, v161
    s_nop 0
    v_cvt_pk_bf16_f32 v161, v161, v161
    v_lshlrev_b32 v161, 16, v161
    v_rcp_f32 v161, v161
    s_nop 0
    v_mul_f32 v160, v160, v161
    s_add_u32 s42, s42, 3670016
    s_add_u32 s43, s42, 131072
    v_accvgpr_read_b32 v16, a144
    v_accvgpr_read_b32 v17, a145
    v_accvgpr_read_b32 v18, a146
    v_accvgpr_read_b32 v19, a147
    v_accvgpr_read_b32 v20, a148
    v_accvgpr_read_b32 v21, a149
    v_accvgpr_read_b32 v22, a150
    v_accvgpr_read_b32 v23, a151
    v_accvgpr_read_b32 v24, a152
    v_accvgpr_read_b32 v25, a153
    v_accvgpr_read_b32 v26, a154
    v_accvgpr_read_b32 v27, a155
    v_accvgpr_read_b32 v28, a156
    v_accvgpr_read_b32 v29, a157
    v_accvgpr_read_b32 v30, a158
    v_accvgpr_read_b32 v31, a159
    v_accvgpr_read_b32 v32, a160
    v_accvgpr_read_b32 v33, a161
    v_accvgpr_read_b32 v34, a162
    v_accvgpr_read_b32 v35, a163
    v_accvgpr_read_b32 v36, a164
    v_accvgpr_read_b32 v37, a165
    v_accvgpr_read_b32 v38, a166
    v_accvgpr_read_b32 v39, a167
    v_accvgpr_read_b32 v40, a168
    v_accvgpr_read_b32 v41, a169
    v_accvgpr_read_b32 v42, a170
    v_accvgpr_read_b32 v43, a171
    v_accvgpr_read_b32 v44, a172
    v_accvgpr_read_b32 v45, a173
    v_accvgpr_read_b32 v46, a174
    v_accvgpr_read_b32 v47, a175
    v_fma_f32 v16, v16, v161, -v160
    v_fma_f32 v17, v17, v161, -v160
    v_fma_f32 v18, v18, v161, -v160
    v_fma_f32 v19, v19, v161, -v160
    v_cvt_pk_bf16_f32 v16, v16, v17
    v_cvt_pk_bf16_f32 v17, v18, v19
    ds_write_b64 v58, v[16:17] offset:0
    v_fma_f32 v20, v20, v161, -v160
    v_fma_f32 v21, v21, v161, -v160
    v_fma_f32 v22, v22, v161, -v160
    v_fma_f32 v23, v23, v161, -v160
    v_cvt_pk_bf16_f32 v20, v20, v21
    v_cvt_pk_bf16_f32 v21, v22, v23
    ds_write_b64 v58, v[20:21] offset:16
    v_fma_f32 v24, v24, v161, -v160
    v_fma_f32 v25, v25, v161, -v160
    v_fma_f32 v26, v26, v161, -v160
    v_fma_f32 v27, v27, v161, -v160
    v_cvt_pk_bf16_f32 v24, v24, v25
    v_cvt_pk_bf16_f32 v25, v26, v27
    ds_write_b64 v58, v[24:25] offset:32
    v_fma_f32 v28, v28, v161, -v160
    v_fma_f32 v29, v29, v161, -v160
    v_fma_f32 v30, v30, v161, -v160
    v_fma_f32 v31, v31, v161, -v160
    v_cvt_pk_bf16_f32 v28, v28, v29
    v_cvt_pk_bf16_f32 v29, v30, v31
    ds_write_b64 v58, v[28:29] offset:48
    ds_read_b64_tr_b16 v[168:169], v59 offset:0
    ds_read_b64_tr_b16 v[170:171], v59 offset:544
    ds_read_b64_tr_b16 v[172:173], v59 offset:2176
    ds_read_b64_tr_b16 v[174:175], v59 offset:2720
    v_fma_f32 v32, v32, v161, -v160
    v_fma_f32 v33, v33, v161, -v160
    v_fma_f32 v34, v34, v161, -v160
    v_fma_f32 v35, v35, v161, -v160
    v_cvt_pk_bf16_f32 v32, v32, v33
    v_cvt_pk_bf16_f32 v33, v34, v35
    ds_write_b64 v58, v[32:33] offset:64
    v_fma_f32 v36, v36, v161, -v160
    v_fma_f32 v37, v37, v161, -v160
    v_fma_f32 v38, v38, v161, -v160
    v_fma_f32 v39, v39, v161, -v160
    v_cvt_pk_bf16_f32 v36, v36, v37
    v_cvt_pk_bf16_f32 v37, v38, v39
    ds_write_b64 v58, v[36:37] offset:80
    v_fma_f32 v40, v40, v161, -v160
    v_fma_f32 v41, v41, v161, -v160
    v_fma_f32 v42, v42, v161, -v160
    v_fma_f32 v43, v43, v161, -v160
    v_cvt_pk_bf16_f32 v40, v40, v41
    v_cvt_pk_bf16_f32 v41, v42, v43
    ds_write_b64 v58, v[40:41] offset:96
    v_fma_f32 v44, v44, v161, -v160
    v_fma_f32 v45, v45, v161, -v160
    v_fma_f32 v46, v46, v161, -v160
    v_fma_f32 v47, v47, v161, -v160
    v_cvt_pk_bf16_f32 v44, v44, v45
    v_cvt_pk_bf16_f32 v45, v46, v47
    ds_write_b64 v58, v[44:45] offset:112
    ds_read_b64_tr_b16 v[176:177], v59 offset:64
    ds_read_b64_tr_b16 v[178:179], v59 offset:608
    ds_read_b64_tr_b16 v[180:181], v59 offset:2240
    ds_read_b64_tr_b16 v[182:183], v59 offset:2784
    s_waitcnt lgkmcnt(0)
    buffer_store_dwordx4 v[168:171], v1, s[16:19], s42 offen offset:0 sc1
    buffer_store_dwordx4 v[172:175], v1, s[16:19], s42 offen offset:1024 sc1
    buffer_store_dwordx4 v[176:179], v1, s[16:19], s43 offen offset:0 sc1
    buffer_store_dwordx4 v[180:183], v1, s[16:19], s43 offen offset:1024 sc1
    s_sub_u32 s42, s42, 131072
    v_accvgpr_read_b32 v16, a176
    v_accvgpr_read_b32 v17, a177
    v_accvgpr_read_b32 v18, a178
    v_accvgpr_read_b32 v19, a179
    v_accvgpr_read_b32 v20, a180
    v_accvgpr_read_b32 v21, a181
    v_accvgpr_read_b32 v22, a182
    v_accvgpr_read_b32 v23, a183
    v_accvgpr_read_b32 v24, a184
    v_accvgpr_read_b32 v25, a185
    v_accvgpr_read_b32 v26, a186
    v_accvgpr_read_b32 v27, a187
    v_accvgpr_read_b32 v28, a188
    v_accvgpr_read_b32 v29, a189
    v_accvgpr_read_b32 v30, a190
    v_accvgpr_read_b32 v31, a191
    v_fma_f32 v16, v16, v161, -v160
    v_fma_f32 v17, v17, v161, -v160
    v_fma_f32 v18, v18, v161, -v160
    v_fma_f32 v19, v19, v161, -v160
    v_cvt_pk_bf16_f32 v16, v16, v17
    v_cvt_pk_bf16_f32 v17, v18, v19
    ds_write_b64 v58, v[16:17] offset:0
    v_fma_f32 v20, v20, v161, -v160
    v_fma_f32 v21, v21, v161, -v160
    v_fma_f32 v22, v22, v161, -v160
    v_fma_f32 v23, v23, v161, -v160
    v_cvt_pk_bf16_f32 v20, v20, v21
    v_cvt_pk_bf16_f32 v21, v22, v23
    ds_write_b64 v58, v[20:21] offset:16
    v_fma_f32 v24, v24, v161, -v160
    v_fma_f32 v25, v25, v161, -v160
    v_fma_f32 v26, v26, v161, -v160
    v_fma_f32 v27, v27, v161, -v160
    v_cvt_pk_bf16_f32 v24, v24, v25
    v_cvt_pk_bf16_f32 v25, v26, v27
    ds_write_b64 v58, v[24:25] offset:32
    v_fma_f32 v28, v28, v161, -v160
    v_fma_f32 v29, v29, v161, -v160
    v_fma_f32 v30, v30, v161, -v160
    v_fma_f32 v31, v31, v161, -v160
    v_cvt_pk_bf16_f32 v28, v28, v29
    v_cvt_pk_bf16_f32 v29, v30, v31
    ds_write_b64 v58, v[28:29] offset:48
    ds_read_b64_tr_b16 v[168:169], v59 offset:0
    ds_read_b64_tr_b16 v[170:171], v59 offset:544
    ds_read_b64_tr_b16 v[172:173], v59 offset:2176
    ds_read_b64_tr_b16 v[174:175], v59 offset:2720
    s_waitcnt lgkmcnt(0)
    buffer_store_dwordx4 v[168:171], v1, s[16:19], s42 offen offset:0 sc1
    buffer_store_dwordx4 v[172:175], v1, s[16:19], s42 offen offset:1024 sc1
    s_branch k1_fin
k1_s1:
    v_add_f32 v50, v50, v32
    v_fma_f32 v51, v32, v32, v51
    v_add_f32 v50, v50, v33
    v_fma_f32 v51, v33, v33, v51
    v_add_f32 v50, v50, v34
    v_fma_f32 v51, v34, v34, v51
    v_add_f32 v50, v50, v35
    v_fma_f32 v51, v35, v35, v51
    v_add_f32 v50, v50, v36
    v_fma_f32 v51, v36, v36, v51
    v_add_f32 v50, v50, v37
    v_fma_f32 v51, v37, v37, v51
    v_add_f32 v50, v50, v38
    v_fma_f32 v51, v38, v38, v51
    v_add_f32 v50, v50, v39
    v_fma_f32 v51, v39, v39, v51
    v_add_f32 v50, v50, v40
    v_fma_f32 v51, v40, v40, v51
    v_add_f32 v50, v50, v41
    v_fma_f32 v51, v41, v41, v51
    v_add_f32 v50, v50, v42
    v_fma_f32 v51, v42, v42, v51
    v_add_f32 v50, v50, v43
    v_fma_f32 v51, v43, v43, v51
    v_add_f32 v50, v50, v44
    v_fma_f32 v51, v44, v44, v51
    v_add_f32 v50, v50, v45
    v_fma_f32 v51, v45, v45, v51
    v_add_f32 v50, v50, v46
    v_fma_f32 v51, v46, v46, v51
    v_add_f32 v50, v50, v47
    v_fma_f32 v51, v47, v47, v51
    s_mov_b32 s37, 12
    v_mov_b32 v52, v50
    v_mov_b32 v53, v51
    v_and_b32 v54, 0x1ff, v1
    v_readfirstlane_b32 s48, v92
    s_cmp_lg_u32 s48, 0
    s_cbranch_scc0 k1_nb_sp
k1_nb_bk:
    v_permlane32_swap_b32 v50, v52
    v_permlane32_swap_b32 v51, v53
    s_lshl_b32 s28, s37, 11
    s_add_u32 s28, s28, s47
    s_not_b32 s49, s48
    v_add_f32 v50, v50, v52
    v_add_f32 v51, v51, v53
    v_mov_b32 v52, s48
    v_mov_b32 v53, s49
    buffer_store_dwordx4 v[50:53], v54, s[16:19], s28 offen sc1
    v_accvgpr_write_b32 a160, v32
    v_accvgpr_write_b32 a161, v33
    v_accvgpr_write_b32 a162, v34
    v_accvgpr_write_b32 a163, v35
    v_accvgpr_write_b32 a164, v36
    v_accvgpr_write_b32 a165, v37
    v_accvgpr_write_b32 a166, v38
    v_accvgpr_write_b32 a167, v39
    v_accvgpr_write_b32 a168, v40
    v_accvgpr_write_b32 a169, v41
    v_accvgpr_write_b32 a170, v42
    v_accvgpr_write_b32 a171, v43
    v_accvgpr_write_b32 a172, v44
    v_accvgpr_write_b32 a173, v45
    v_accvgpr_write_b32 a174, v46
    v_accvgpr_write_b32 a175, v47
    s_branch k1_pb
k1_s0:
    v_mov_b32 v50, v16
    v_mul_f32 v51, v16, v16
    v_add_f32 v50, v50, v17
    v_fma_f32 v51, v17, v17, v51
    v_add_f32 v50, v50, v18
    v_fma_f32 v51, v18, v18, v51
    v_add_f32 v50, v50, v19
    v_fma_f32 v51, v19, v19, v51
    v_add_f32 v50, v50, v20
    v_fma_f32 v51, v20, v20, v51
    v_add_f32 v50, v50, v21
    v_fma_f32 v51, v21, v21, v51
    v_add_f32 v50, v50, v22
    v_fma_f32 v51, v22, v22, v51
    v_add_f32 v50, v50, v23
    v_fma_f32 v51, v23, v23, v51
    v_add_f32 v50, v50, v24
    v_fma_f32 v51, v24, v24, v51
    v_add_f32 v50, v50, v25
    v_fma_f32 v51, v25, v25, v51
    v_add_f32 v50, v50, v26
    v_fma_f32 v51, v26, v26, v51
    v_add_f32 v50, v50, v27
    v_fma_f32 v51, v27, v27, v51
    v_add_f32 v50, v50, v28
    v_fma_f32 v51, v28, v28, v51
    v_add_f32 v50, v50, v29
    v_fma_f32 v51, v29, v29, v51
    v_add_f32 v50, v50, v30
    v_fma_f32 v51, v30, v30, v51
    v_add_f32 v50, v50, v31
    v_fma_f32 v51, v31, v31, v51
    s_cmp_eq_u32 s32, 0
    s_cbranch_scc0 k1_s2
    v_accvgpr_write_b32 a144, v16
    v_accvgpr_write_b32 a145, v17
    v_accvgpr_write_b32 a146, v18
    v_accvgpr_write_b32 a147, v19
    v_accvgpr_write_b32 a148, v20
    v_accvgpr_write_b32 a149, v21
    v_accvgpr_write_b32 a150, v22
    v_accvgpr_write_b32 a151, v23
    v_accvgpr_write_b32 a152, v24
    v_accvgpr_write_b32 a153, v25
    v_accvgpr_write_b32 a154, v26
    v_accvgpr_write_b32 a155, v27
    v_accvgpr_write_b32 a156, v28
    v_accvgpr_write_b32 a157, v29
    v_accvgpr_write_b32 a158, v30
    v_accvgpr_write_b32 a159, v31
    s_branch k1_next
k1_s2:
    s_mov_b32 s37, 13
    v_mov_b32 v52, v50
    v_mov_b32 v53, v51
    v_and_b32 v54, 0x1ff, v1
    v_readfirstlane_b32 s48, v92
    s_cmp_lg_u32 s48, 0
    s_cbranch_scc0 k1_nc_sp
k1_nc_bk:
    v_permlane32_swap_b32 v50, v52
    v_permlane32_swap_b32 v51, v53
    s_lshl_b32 s28, s37, 11
    s_add_u32 s28, s28, s47
    s_not_b32 s49, s48
    v_add_f32 v50, v50, v52
    v_add_f32 v51, v51, v53
    v_mov_b32 v52, s48
    v_mov_b32 v53, s49
    buffer_store_dwordx4 v[50:53], v54, s[16:19], s28 offen sc1
    v_accvgpr_write_b32 a176, v16
    v_accvgpr_write_b32 a177, v17
    v_accvgpr_write_b32 a178, v18
    v_accvgpr_write_b32 a179, v19
    v_accvgpr_write_b32 a180, v20
    v_accvgpr_write_b32 a181, v21
    v_accvgpr_write_b32 a182, v22
    v_accvgpr_write_b32 a183, v23
    v_accvgpr_write_b32 a184, v24
    v_accvgpr_write_b32 a185, v25
    v_accvgpr_write_b32 a186, v26
    v_accvgpr_write_b32 a187, v27
    v_accvgpr_write_b32 a188, v28
    v_accvgpr_write_b32 a189, v29
    v_accvgpr_write_b32 a190, v30
    v_accvgpr_write_b32 a191, v31
    s_mov_b32 s37, 64
    s_branch k1_next
.globl recurrent_scan__softmax_full_mha__mixer_gmlp__prompt_kernel
.p2align 8
.type recurrent_scan__softmax_full_mha__mixer_gmlp__prompt_kernel,@function
recurrent_scan__softmax_full_mha__mixer_gmlp__prompt_kernel:
k2_top:
    s_cmp_ge_u32 s2, 256
    s_cbranch_scc1 k2_end
    s_load_dwordx2 s[4:5], s[0:1], 80
    s_load_dwordx2 s[8:9], s[0:1], 80
    s_load_dwordx2 s[12:13], s[0:1], 40
    s_load_dwordx2 s[20:21], s[0:1], 48
    s_load_dwordx2 s[16:17], s[0:1], 0
    s_load_dwordx2 s[60:61], s[0:1], 64
    s_getpc_b64 s[64:65]
    s_lshr_b32 s3, s2, 3
    v_lshrrev_b32 v2, 5, v0
    v_lshl_add_u32 v2, s3, 4, v2
    v_min_u32 v2, (code_end-k2_top)/128-1, v2
    v_lshlrev_b32 v2, 7, v2
    v_mov_b32 v3, s65
    v_add_co_u32 v2, vcc, s64, v2
    s_nop 1
    v_addc_co_u32 v3, vcc, 0, v3, vcc
    global_load_dword v15, v[2:3], off
    v_lshrrev_b32 v1, 6, v0
    v_and_b32 v0, 63, v0
    v_readfirstlane_b32 s24, v1
    s_mov_b32 s6, 33554432
    s_mov_b32 s7, 0x00020000
    s_mov_b32 s10, 33554432
    s_mov_b32 s11, 0x00020000
    s_mov_b32 s14, 8388608
    s_mov_b32 s15, 0x00020000
    s_mov_b32 s22, 4096
    s_mov_b32 s23, 0x00020000
    s_mov_b32 s18, 2621440
    s_mov_b32 s19, 0x00020000
    s_mov_b32 s62, 2621440
    s_mov_b32 s63, 0x00020000
    s_and_b32 s42, s24, 3
    s_lshr_b32 s43, s24, 2
    s_and_b32 s25, s2, 7
    s_lshl_b32 s25, s25, 2
    s_lshr_b32 s29, s2, 6
    s_add_u32 s25, s25, s29
    s_bfe_u32 s26, s2, 0x30003
    s_lshl_b32 s26, s26, 2
    s_add_u32 s26, s26, s42
    s_bfe_u32 s27, s2, 0x20001
    s_lshl_b32 s27, s27, 2
    s_bfe_u32 s29, s2, 0x20003
    s_add_u32 s27, s27, s29
    s_lshr_b32 s44, s2, 5
    s_min_u32 s28, s44, 6
    s_and_b32 s29, s2, 1
    s_mul_i32 s29, s29, 7
    s_add_u32 s28, s28, s29
    s_mul_i32 s31, s25, 212992
    s_min_u32 s35, s24, 6
    s_lshl_b32 s35, s35, 10
    s_add_u32 s32, s31, s35
    s_lshl_b32 s33, s28, 1
    s_add_u32 s33, s33, s43
    s_min_u32 s33, s33, 26
    s_lshl_b32 s33, s33, 7
    s_add_u32 s33, s33, s42
    s_lshl_b32 s33, s33, 10
    s_add_u32 s33, s33, 18874368
    s_lshl_b32 s36, s24, 10
    s_lshl_b32 s37, s36, 1
    s_add_u32 s36, s36, 7168
    s_add_u32 s37, s37, 15360
    s_lshl_b32 s34, s27, 3
    s_add_u32 s34, s34, s24
    s_lshl_b32 s34, s34, 16
    s_mul_i32 s29, s26, 196608
    s_add_u32 s29, s29, 23068672
    s_lshl_b32 s39, s25, 9
    s_add_u32 s39, s39, s29
    s_lshr_b32 s30, s25, 1
    s_lshl_b32 s30, s30, 8
    s_add_u32 s29, s29, s30
    s_and_b32 s30, s25, 1
    s_lshl_b32 s30, s30, 3
    s_add_u32 s29, s29, s30
    s_add_u32 s40, s29, 16384
    s_add_u32 s29, s39, 98304
    s_add_u32 s30, s40, 98304
    v_lshlrev_b32 v1, 4, v0
    v_lshrrev_b32 v12, 3, v0
    v_lshrrev_b32 v13, 4, v0
    v_and_b32 v14, 7, v0
    v_xor_b32 v13, v13, v14
    v_lshlrev_b32 v13, 4, v13
    v_lshl_add_u32 v7, v12, 12, v13
    v_xor_b32 v8, 0x8040, v7
    s_mov_b32 s45, 128
    s_mov_b32 s41, 33
    s_mov_b32 s46, 14
    s_cmp_lt_u32 s2, 224
    s_cbranch_scc1 k2_np
    s_sub_u32 s34, s2, 224
    s_lshl_b32 s34, s34, 3
    s_add_u32 s34, s34, s24
    s_lshl_b32 s34, s34, 15
    s_add_u32 s34, s34, 512
    s_mov_b32 s14, 0
    s_mov_b32 s45, 256
    s_mov_b32 s41, 6
    s_mov_b32 s46, 5
    s_mov_b32 s33, 0xf0000000
    v_add_u32 v8, 128, v7
k2_np:
    v_and_b32 v12, 31, v0
    v_lshrrev_b32 v13, 5, v0
    v_lshlrev_b32 v4, 3, v12
    v_bfe_u32 v14, v0, 4, 1
    v_mul_u32_u24 v14, 48896, v14
    v_lshl_add_u32 v14, v12, 4, v14
    v_lshl_add_u32 v173, v13, 8, v14
    v_lshl_add_u32 v11, v13, 30, v14
    s_waitcnt lgkmcnt(0)
    s_add_u32 m0, s37, 0
    s_nop 0
    buffer_load_dwordx4 v7, s[12:15], s34 offen lds
    s_add_u32 m0, s37, 1024
    s_nop 0
    buffer_load_dwordx4 v8, s[12:15], s34 offen lds
    s_add_u32 m0, s36, 0
    s_add_u32 s34, s34, s45
    buffer_load_dwordx4 v1, s[8:11], s33 offen lds
    s_add_u32 m0, s35, 0
    s_add_u32 s33, s33, 4096
    buffer_load_dwordx4 v1, s[8:11], s32 offen lds
    buffer_load_dwordx4 v[112:115], v173, s[4:7], s39 offen
    buffer_load_dwordx2 v[120:121], v11, s[4:7], s40 offen
    buffer_load_dwordx4 v[116:119], v173, s[4:7], s29 offen
    buffer_load_dwordx2 v[122:123], v11, s[4:7], s30 offen
    s_add_u32 m0, s37, 32768
    s_nop 0
    buffer_load_dwordx4 v7, s[12:15], s34 offen lds
    s_add_u32 m0, s37, 33792
    s_add_u32 s32, s32, 6656
    buffer_load_dwordx4 v8, s[12:15], s34 offen lds
    s_add_u32 m0, s36, 32768
    s_add_u32 s34, s34, s45
    buffer_load_dwordx4 v1, s[8:11], s33 offen lds
    s_add_u32 m0, s35, 32768
    s_add_u32 s33, s33, 4096
    buffer_load_dwordx4 v1, s[8:11], s32 offen lds
    s_lshl_b32 s29, s43, 10
    v_add_u32 v3, s29, v1
    v_add_u32 v2, s29, v3
    s_lshl_b32 s29, s43, 8
    s_add_u32 s29, s29, 6144
    v_add_u32 v4, s29, v4
    s_lshl_b32 s29, s43, 2
    v_add_u32 v13, s29, v13
    v_bfe_u32 v14, v0, 1, 3
    v_xor_b32 v13, v13, v14
    v_lshlrev_b32 v13, 4, v13
    v_lshl_add_u32 v13, v12, 7, v13
    s_lshl_b32 s29, s42, 12
    s_add_u32 s29, s29, 15360
    v_add_u32 v5, s29, v13
    v_xor_b32 v6, 32, v5
    v_mov_b32 v9, 0xdddddddd
    s_lshl_b32 s29, s24, 3
    s_mov_b32 s54, 0x140e0700
    s_mov_b32 s55, 0x29231e19
    s_lshr_b64 s[54:55], s[54:55], s29
    s_and_b32 s49, s54, 0xff
    s_mul_i32 s47, s49, 40960
    s_mul_i32 s29, s44, 5120
    s_add_u32 s47, s47, s29
    s_add_u32 s47, s47, 29319168
    s_bfe_u32 s29, s2, 0x20003
    s_mul_i32 s29, s29, 1280
    s_add_u32 s65, s47, s29
    s_sub_u32 s65, s65, 204800
    v_add_u32 v14, 54, v0
    v_lshrrev_b32 v14, 6, v14
    v_lshlrev_b32 v14, 30, v14
    v_lshl_add_u32 v14, v0, 7, v14
    s_mov_b32 s38, 0
    s_mov_b32 s14, 8388608
    s_lshl_b32 s29, s2, 3
    s_add_u32 s29, s29, s24
    s_lshl_b32 s29, s29, 12
    v_lshlrev_b32 v13, 3, v1
    s_bfm_b64 exec, 4, 0
    buffer_load_dword v15, v13, s[12:15], s29 offen offset:512
    s_mov_b64 exec, -1
    v_mov_b32 v48, 0
    v_mov_b32 v49, 0
    v_mov_b32 v50, 0
    v_mov_b32 v51, 0
    v_mov_b32 v52, 0
    v_mov_b32 v53, 0
    v_mov_b32 v54, 0
    v_mov_b32 v55, 0
    v_mov_b32 v56, 0
    v_mov_b32 v57, 0
    v_mov_b32 v58, 0
    v_mov_b32 v59, 0
    v_mov_b32 v60, 0
    v_mov_b32 v61, 0
    v_mov_b32 v62, 0
    v_mov_b32 v63, 0
    v_mov_b32 v64, 0
    v_mov_b32 v65, 0
    v_mov_b32 v66, 0
    v_mov_b32 v67, 0
    v_mov_b32 v68, 0
    v_mov_b32 v69, 0
    v_mov_b32 v70, 0
    v_mov_b32 v71, 0
    v_mov_b32 v72, 0
    v_mov_b32 v73, 0
    v_mov_b32 v74, 0
    v_mov_b32 v75, 0
    v_mov_b32 v76, 0
    v_mov_b32 v77, 0
    v_mov_b32 v78, 0
    v_mov_b32 v79, 0
    v_mov_b32 v80, 0
    v_mov_b32 v81, 0
    v_mov_b32 v82, 0
    v_mov_b32 v83, 0
    v_mov_b32 v84, 0
    v_mov_b32 v85, 0
    v_mov_b32 v86, 0
    v_mov_b32 v87, 0
    v_mov_b32 v88, 0
    v_mov_b32 v89, 0
    v_mov_b32 v90, 0
    v_mov_b32 v91, 0
    v_mov_b32 v92, 0
    v_mov_b32 v93, 0
    v_mov_b32 v94, 0
    v_mov_b32 v95, 0
    v_mov_b32 v96, 0
    v_mov_b32 v97, 0
    v_mov_b32 v98, 0
    v_mov_b32 v99, 0
    v_mov_b32 v100, 0
    v_mov_b32 v101, 0
    v_mov_b32 v102, 0
    v_mov_b32 v103, 0
    v_mov_b32 v104, 0
    v_mov_b32 v105, 0
    v_mov_b32 v106, 0
    v_mov_b32 v107, 0
    v_mov_b32 v108, 0
    v_mov_b32 v109, 0
    v_mov_b32 v110, 0
    v_mov_b32 v111, 0
    s_waitcnt vmcnt(5)
    s_barrier
    ds_read_b128 v[124:127], v3 offset:0
    ds_read_b64 v[128:129], v4
    ds_read_b128 v[148:151], v5 offset:0
    ds_read_b128 v[144:147], v2 offset:11264
    ds_read_b128 v[140:143], v2 offset:7168
    ds_read_b128 v[132:135], v2 offset:2048
    ds_read_b128 v[136:139], v2 offset:3072
    s_waitcnt lgkmcnt(2)
    v_mfma_f32_32x32x16_bf16 v[16:31], v[124:127], v[112:115], 0
    v_mfma_f32_32x32x8_bf16 v[16:31], v[128:129], v[120:121], v[16:31]
    s_add_u32 m0, s37, 65536
    s_nop 0
    buffer_load_dwordx4 v7, s[12:15], s34 offen lds
    s_add_u32 m0, s37, 66560
    s_add_u32 s32, s32, 6656
    buffer_load_dwordx4 v8, s[12:15], s34 offen lds
    s_add_u32 m0, s36, 65536
    s_add_u32 s34, s34, s45
    buffer_load_dwordx4 v1, s[8:11], s33 offen lds
    s_add_u32 m0, s35, 65536
    s_add_u32 s33, s33, 4096
    buffer_load_dwordx4 v1, s[8:11], s32 offen lds
    s_xor_b32 s35, s35, 0x10000
    s_xor_b32 s36, s36, 0x10000
    s_xor_b32 s37, s37, 0x10000
    s_cmp_eq_u32 s43, 0
    s_cbranch_scc0 k2b_loop
.p2align 6
k2a_loop:
    v_exp_f32 v16, v16
    v_exp_f32 v17, v17
    v_exp_f32 v18, v18
    v_exp_f32 v19, v19
    v_exp_f32 v20, v20
    v_exp_f32 v21, v21
    v_exp_f32 v22, v22
    v_exp_f32 v23, v23
    v_exp_f32 v24, v24
    v_exp_f32 v25, v25
    v_exp_f32 v26, v26
    v_exp_f32 v27, v27
    v_exp_f32 v28, v28
    v_exp_f32 v29, v29
    v_exp_f32 v30, v30
    v_exp_f32 v31, v31
    s_waitcnt vmcnt(5)
    s_barrier
    s_setprio 1
    s_waitcnt lgkmcnt(2)
    v_mfma_f32_32x32x16_bf16 v[32:47], v[124:127], v[116:119], 0
    s_setprio 2
    v_mfma_f32_32x32x8_bf16 v[32:47], v[128:129], v[122:123], v[32:47]
    ds_read_b128 v[124:127], v3 offset:32768
    ds_read_b64 v[128:129], v4 offset:32768
    v_mfma_f32_32x32x16_bf16 v[80:95], v[140:143], v[148:151], v[80:95]
    ds_read_b128 v[140:143], v2 offset:8192
    s_add_u32 m0, s37, 32768
    s_nop 0
    buffer_load_dwordx4 v7, s[12:15], s34 offen lds
    v_mfma_f32_32x32x16_bf16 v[96:111], v[144:147], v[148:151], v[96:111]
    s_waitcnt lgkmcnt(3)
    ds_read_b128 v[144:147], v2 offset:12288
    ds_read_b128 v[148:151], v6 offset:0
    v_smfmac_f32_32x32x32_bf16 v[48:63], v[132:135], v[16:23], v9
    s_add_u32 m0, s37, 33792
    s_add_u32 s32, s32, 6656
    buffer_load_dwordx4 v8, s[12:15], s34 offen lds
    v_smfmac_f32_32x32x32_bf16 v[48:63], v[136:139], v[24:31], v9
    s_setprio 0
    v_exp_f32 v32, v32
    v_exp_f32 v33, v33
    v_exp_f32 v34, v34
    v_exp_f32 v35, v35
    v_exp_f32 v36, v36
    v_exp_f32 v37, v37
    v_exp_f32 v38, v38
    v_exp_f32 v39, v39
    v_exp_f32 v40, v40
    v_exp_f32 v41, v41
    v_exp_f32 v42, v42
    v_exp_f32 v43, v43
    v_exp_f32 v44, v44
    v_exp_f32 v45, v45
    v_exp_f32 v46, v46
    v_exp_f32 v47, v47
    s_setprio 1
    s_waitcnt lgkmcnt(0)
    v_mfma_f32_32x32x16_bf16 v[16:31], v[124:127], v[112:115], 0
    s_setprio 2
    s_add_u32 m0, s36, 32768
    s_add_u32 s34, s34, s45
    buffer_load_dwordx4 v1, s[8:11], s33 offen lds
    v_mfma_f32_32x32x8_bf16 v[16:31], v[128:129], v[120:121], v[16:31]
    s_add_u32 m0, s35, 32768
    s_add_u32 s33, s33, 4096
    buffer_load_dwordx4 v1, s[8:11], s32 offen lds
    v_mfma_f32_32x32x16_bf16 v[80:95], v[140:143], v[148:151], v[80:95]
    ds_read_b128 v[140:143], v2 offset:39936
    s_xor_b32 s35, s35, 0x10000
    s_xor_b32 s36, s36, 0x10000
    s_xor_b32 s37, s37, 0x10000
    v_mfma_f32_32x32x16_bf16 v[96:111], v[144:147], v[148:151], v[96:111]
    ds_read_b128 v[144:147], v2 offset:44032
    ds_read_b128 v[148:151], v5 offset:32768
    s_cmp_lt_u32 s38, s46
    s_cselect_b32 s14, s14, 0
    v_smfmac_f32_32x32x32_bf16 v[64:79], v[132:135], v[32:39], v9
    ds_read_b128 v[132:135], v2 offset:34816
    v_smfmac_f32_32x32x32_bf16 v[64:79], v[136:139], v[40:47], v9
    ds_read_b128 v[136:139], v2 offset:35840
    s_setprio 0
    v_exp_f32 v16, v16
    v_exp_f32 v17, v17
    v_exp_f32 v18, v18
    v_exp_f32 v19, v19
    v_exp_f32 v20, v20
    v_exp_f32 v21, v21
    v_exp_f32 v22, v22
    v_exp_f32 v23, v23
    v_exp_f32 v24, v24
    v_exp_f32 v25, v25
    v_exp_f32 v26, v26
    v_exp_f32 v27, v27
    v_exp_f32 v28, v28
    v_exp_f32 v29, v29
    v_exp_f32 v30, v30
    v_exp_f32 v31, v31
    v_xor_b32 v3, 0x10000, v3
    v_xor_b32 v4, 0x10000, v4
    v_xor_b32 v5, 0x10000, v5
    s_waitcnt vmcnt(4)
    s_barrier
    s_setprio 1
    s_waitcnt lgkmcnt(2)
    v_mfma_f32_32x32x16_bf16 v[32:47], v[124:127], v[116:119], 0
    s_setprio 2
    v_mfma_f32_32x32x8_bf16 v[32:47], v[128:129], v[122:123], v[32:47]
    ds_read_b128 v[124:127], v3 offset:0
    ds_read_b64 v[128:129], v4 offset:0
    s_cmp_ge_u32 s38, 6
    s_cselect_b32 s29, s65, 0xf0000000
    s_add_u32 s65, s65, 40960
    buffer_load_dword v15, v14, s[4:7], s29 offen
    v_mfma_f32_32x32x16_bf16 v[80:95], v[140:143], v[148:151], v[80:95]
    ds_read_b128 v[140:143], v2 offset:40960
    s_add_u32 m0, s37, 0
    s_nop 0
    buffer_load_dwordx4 v7, s[12:15], s34 offen lds
    v_mfma_f32_32x32x16_bf16 v[96:111], v[144:147], v[148:151], v[96:111]
    s_waitcnt lgkmcnt(3)
    ds_read_b128 v[144:147], v2 offset:45056
    ds_read_b128 v[148:151], v6 offset:32768
    v_smfmac_f32_32x32x32_bf16 v[48:63], v[132:135], v[16:23], v9
    s_add_u32 m0, s37, 1024
    s_add_u32 s32, s32, 6656
    buffer_load_dwordx4 v8, s[12:15], s34 offen lds
    v_smfmac_f32_32x32x32_bf16 v[48:63], v[136:139], v[24:31], v9
    s_setprio 0
    v_exp_f32 v32, v32
    v_exp_f32 v33, v33
    v_exp_f32 v34, v34
    v_exp_f32 v35, v35
    v_exp_f32 v36, v36
    v_exp_f32 v37, v37
    v_exp_f32 v38, v38
    v_exp_f32 v39, v39
    v_exp_f32 v40, v40
    v_exp_f32 v41, v41
    v_exp_f32 v42, v42
    v_exp_f32 v43, v43
    v_exp_f32 v44, v44
    v_exp_f32 v45, v45
    v_exp_f32 v46, v46
    v_exp_f32 v47, v47
    v_xor_b32 v2, 0x10000, v2
    v_xor_b32 v6, 0x10000, v6
    s_setprio 1
    s_waitcnt lgkmcnt(0)
    v_mfma_f32_32x32x16_bf16 v[16:31], v[124:127], v[112:115], 0
    s_setprio 2
    s_add_u32 m0, s36, 0
    s_add_u32 s34, s34, s45
    buffer_load_dwordx4 v1, s[8:11], s33 offen lds
    v_mfma_f32_32x32x8_bf16 v[16:31], v[128:129], v[120:121], v[16:31]
    s_add_u32 m0, s35, 0
    s_add_u32 s33, s33, 4096
    buffer_load_dwordx4 v1, s[8:11], s32 offen lds
    v_mfma_f32_32x32x16_bf16 v[80:95], v[140:143], v[148:151], v[80:95]
    ds_read_b128 v[140:143], v2 offset:7168
    v_mfma_f32_32x32x16_bf16 v[96:111], v[144:147], v[148:151], v[96:111]
    ds_read_b128 v[144:147], v2 offset:11264
    ds_read_b128 v[148:151], v5 offset:0
    v_smfmac_f32_32x32x32_bf16 v[64:79], v[132:135], v[32:39], v9
    ds_read_b128 v[132:135], v2 offset:2048
    s_add_u32 s38, s38, 1
    s_cmp_eq_u32 s38, 33
    s_cbranch_scc1 k2_end
    s_cmp_lt_u32 s38, 13
    v_smfmac_f32_32x32x32_bf16 v[64:79], v[136:139], v[40:47], v9
    ds_read_b128 v[136:139], v2 offset:3072
    s_setprio 0
    s_cbranch_scc1 k2a_loop
    s_branch k2a_peel
.p2align 6
k2b_loop:
    s_waitcnt vmcnt(5)
    s_barrier
    v_exp_f32 v16, v16
    v_exp_f32 v17, v17
    v_exp_f32 v18, v18
    v_exp_f32 v19, v19
    v_exp_f32 v20, v20
    v_exp_f32 v21, v21
    v_exp_f32 v22, v22
    v_exp_f32 v23, v23
    v_exp_f32 v24, v24
    v_exp_f32 v25, v25
    v_exp_f32 v26, v26
    v_exp_f32 v27, v27
    v_exp_f32 v28, v28
    v_exp_f32 v29, v29
    v_exp_f32 v30, v30
    v_exp_f32 v31, v31
    s_setprio 1
    s_waitcnt lgkmcnt(2)
    v_mfma_f32_32x32x16_bf16 v[32:47], v[124:127], v[116:119], 0
    s_setprio 2
    v_mfma_f32_32x32x8_bf16 v[32:47], v[128:129], v[122:123], v[32:47]
    ds_read_b128 v[124:127], v3 offset:32768
    ds_read_b64 v[128:129], v4 offset:32768
    v_mfma_f32_32x32x16_bf16 v[80:95], v[140:143], v[148:151], v[80:95]
    ds_read_b128 v[140:143], v2 offset:8192
    s_add_u32 m0, s37, 32768
    s_nop 0
    buffer_load_dwordx4 v7, s[12:15], s34 offen lds
    v_mfma_f32_32x32x16_bf16 v[96:111], v[144:147], v[148:151], v[96:111]
    s_waitcnt lgkmcnt(3)
    ds_read_b128 v[144:147], v2 offset:12288
    ds_read_b128 v[148:151], v6 offset:0
    v_smfmac_f32_32x32x32_bf16 v[48:63], v[132:135], v[16:23], v9
    s_add_u32 m0, s37, 33792
    s_add_u32 s32, s32, 6656
    buffer_load_dwordx4 v8, s[12:15], s34 offen lds
    v_smfmac_f32_32x32x32_bf16 v[48:63], v[136:139], v[24:31], v9
    s_setprio 0
    v_exp_f32 v32, v32
    v_exp_f32 v33, v33
    v_exp_f32 v34, v34
    v_exp_f32 v35, v35
    v_exp_f32 v36, v36
    v_exp_f32 v37, v37
    v_exp_f32 v38, v38
    v_exp_f32 v39, v39
    v_exp_f32 v40, v40
    v_exp_f32 v41, v41
    v_exp_f32 v42, v42
    v_exp_f32 v43, v43
    v_exp_f32 v44, v44
    v_exp_f32 v45, v45
    v_exp_f32 v46, v46
    v_exp_f32 v47, v47
    s_setprio 1
    s_waitcnt lgkmcnt(0)
    v_mfma_f32_32x32x16_bf16 v[16:31], v[124:127], v[112:115], 0
    s_setprio 2
    s_add_u32 m0, s36, 32768
    s_add_u32 s34, s34, s45
    buffer_load_dwordx4 v1, s[8:11], s33 offen lds
    v_mfma_f32_32x32x8_bf16 v[16:31], v[128:129], v[120:121], v[16:31]
    s_add_u32 m0, s35, 32768
    s_add_u32 s33, s33, 4096
    buffer_load_dwordx4 v1, s[8:11], s32 offen lds
    v_mfma_f32_32x32x16_bf16 v[80:95], v[140:143], v[148:151], v[80:95]
    ds_read_b128 v[140:143], v2 offset:39936
    s_xor_b32 s35, s35, 0x10000
    s_xor_b32 s36, s36, 0x10000
    s_xor_b32 s37, s37, 0x10000
    v_mfma_f32_32x32x16_bf16 v[96:111], v[144:147], v[148:151], v[96:111]
    ds_read_b128 v[144:147], v2 offset:44032
    ds_read_b128 v[148:151], v5 offset:32768
    s_cmp_lt_u32 s38, s46
    s_cselect_b32 s14, s14, 0
    v_smfmac_f32_32x32x32_bf16 v[64:79], v[132:135], v[32:39], v9
    ds_read_b128 v[132:135], v2 offset:34816
    v_smfmac_f32_32x32x32_bf16 v[64:79], v[136:139], v[40:47], v9
    ds_read_b128 v[136:139], v2 offset:35840
    s_setprio 0
    s_waitcnt vmcnt(4)
    s_barrier
    v_exp_f32 v16, v16
    v_exp_f32 v17, v17
    v_exp_f32 v18, v18
    v_exp_f32 v19, v19
    v_exp_f32 v20, v20
    v_exp_f32 v21, v21
    v_exp_f32 v22, v22
    v_exp_f32 v23, v23
    v_exp_f32 v24, v24
    v_exp_f32 v25, v25
    v_exp_f32 v26, v26
    v_exp_f32 v27, v27
    v_exp_f32 v28, v28
    v_exp_f32 v29, v29
    v_exp_f32 v30, v30
    v_exp_f32 v31, v31
    v_xor_b32 v3, 0x10000, v3
    v_xor_b32 v4, 0x10000, v4
    v_xor_b32 v5, 0x10000, v5
    s_setprio 1
    s_waitcnt lgkmcnt(2)
    v_mfma_f32_32x32x16_bf16 v[32:47], v[124:127], v[116:119], 0
    s_setprio 2
    v_mfma_f32_32x32x8_bf16 v[32:47], v[128:129], v[122:123], v[32:47]
    ds_read_b128 v[124:127], v3 offset:0
    ds_read_b64 v[128:129], v4 offset:0
    s_cmp_ge_u32 s38, 6
    s_cselect_b32 s29, s65, 0xf0000000
    s_add_u32 s65, s65, 40960
    buffer_load_dword v15, v14, s[4:7], s29 offen
    v_mfma_f32_32x32x16_bf16 v[80:95], v[140:143], v[148:151], v[80:95]
    ds_read_b128 v[140:143], v2 offset:40960
    s_add_u32 m0, s37, 0
    s_nop 0
    buffer_load_dwordx4 v7, s[12:15], s34 offen lds
    v_mfma_f32_32x32x16_bf16 v[96:111], v[144:147], v[148:151], v[96:111]
    s_waitcnt lgkmcnt(3)
    ds_read_b128 v[144:147], v2 offset:45056
    ds_read_b128 v[148:151], v6 offset:32768
    v_smfmac_f32_32x32x32_bf16 v[48:63], v[132:135], v[16:23], v9
    s_add_u32 m0, s37, 1024
    s_add_u32 s32, s32, 6656
    buffer_load_dwordx4 v8, s[12:15], s34 offen lds
    v_smfmac_f32_32x32x32_bf16 v[48:63], v[136:139], v[24:31], v9
    s_setprio 0
    v_exp_f32 v32, v32
    v_exp_f32 v33, v33
    v_exp_f32 v34, v34
    v_exp_f32 v35, v35
    v_exp_f32 v36, v36
    v_exp_f32 v37, v37
    v_exp_f32 v38, v38
    v_exp_f32 v39, v39
    v_exp_f32 v40, v40
    v_exp_f32 v41, v41
    v_exp_f32 v42, v42
    v_exp_f32 v43, v43
    v_exp_f32 v44, v44
    v_exp_f32 v45, v45
    v_exp_f32 v46, v46
    v_exp_f32 v47, v47
    v_xor_b32 v2, 0x10000, v2
    v_xor_b32 v6, 0x10000, v6
    s_setprio 1
    s_waitcnt lgkmcnt(0)
    v_mfma_f32_32x32x16_bf16 v[16:31], v[124:127], v[112:115], 0
    s_setprio 2
    s_add_u32 m0, s36, 0
    s_add_u32 s34, s34, s45
    buffer_load_dwordx4 v1, s[8:11], s33 offen lds
    v_mfma_f32_32x32x8_bf16 v[16:31], v[128:129], v[120:121], v[16:31]
    s_add_u32 m0, s35, 0
    s_add_u32 s33, s33, 4096
    buffer_load_dwordx4 v1, s[8:11], s32 offen lds
    v_mfma_f32_32x32x16_bf16 v[80:95], v[140:143], v[148:151], v[80:95]
    ds_read_b128 v[140:143], v2 offset:7168
    v_mfma_f32_32x32x16_bf16 v[96:111], v[144:147], v[148:151], v[96:111]
    ds_read_b128 v[144:147], v2 offset:11264
    ds_read_b128 v[148:151], v5 offset:0
    v_smfmac_f32_32x32x32_bf16 v[64:79], v[132:135], v[32:39], v9
    ds_read_b128 v[132:135], v2 offset:2048
    s_add_u32 s38, s38, 1
    s_cmp_lt_u32 s38, 13
    v_smfmac_f32_32x32x32_bf16 v[64:79], v[136:139], v[40:47], v9
    ds_read_b128 v[136:139], v2 offset:3072
    s_setprio 0
    s_cbranch_scc1 k2b_loop
    s_branch k2b_peel
.p2align 6
k2a_peel:
    v_exp_f32 v16, v16
    v_exp_f32 v17, v17
    v_exp_f32 v18, v18
    v_exp_f32 v19, v19
    v_exp_f32 v20, v20
    v_exp_f32 v21, v21
    v_exp_f32 v22, v22
    v_exp_f32 v23, v23
    v_exp_f32 v24, v24
    v_exp_f32 v25, v25
    v_exp_f32 v26, v26
    v_exp_f32 v27, v27
    v_exp_f32 v28, v28
    v_exp_f32 v29, v29
    v_exp_f32 v30, v30
    v_exp_f32 v31, v31
    s_waitcnt vmcnt(5)
    s_barrier
    s_setprio 1
    s_waitcnt lgkmcnt(2)
    v_mfma_f32_32x32x16_bf16 v[32:47], v[124:127], v[116:119], 0
    s_setprio 2
    s_lshl_b32 s29, s24, 13
    v_add_u32 v12, s29, v1
    v_xor_b32 v13, 0x8000, v12
    v_add_u32 v172, 4096, v1
    v_mfma_f32_32x32x8_bf16 v[32:47], v[128:129], v[122:123], v[32:47]
    ds_read_b128 v[124:127], v3 offset:32768
    ds_read_b64 v[128:129], v4 offset:32768
    v_mfma_f32_32x32x16_bf16 v[80:95], v[140:143], v[148:151], v[80:95]
    ds_read_b128 v[140:143], v2 offset:8192
    s_add_u32 m0, s37, 32768
    s_nop 0
    buffer_load_dwordx4 v7, s[12:15], s34 offen lds
    v_mfma_f32_32x32x16_bf16 v[96:111], v[144:147], v[148:151], v[96:111]
    s_waitcnt lgkmcnt(3)
    ds_read_b128 v[144:147], v2 offset:12288
    ds_read_b128 v[148:151], v6 offset:0
    v_smfmac_f32_32x32x32_bf16 v[48:63], v[132:135], v[16:23], v9
    s_add_u32 m0, s37, 33792
    s_add_u32 s32, s32, 6656
    buffer_load_dwordx4 v8, s[12:15], s34 offen lds
    v_smfmac_f32_32x32x32_bf16 v[48:63], v[136:139], v[24:31], v9
    s_add_u32 s47, s47, 40960
    buffer_load_dwordx4 v[176:179], v1, s[4:7], s47 offen offset:0
    s_setprio 0
    v_exp_f32 v32, v32
    v_exp_f32 v33, v33
    v_exp_f32 v34, v34
    v_exp_f32 v35, v35
    v_exp_f32 v36, v36
    v_exp_f32 v37, v37
    v_exp_f32 v38, v38
    v_exp_f32 v39, v39
    v_exp_f32 v40, v40
    v_exp_f32 v41, v41
    v_exp_f32 v42, v42
    v_exp_f32 v43, v43
    v_exp_f32 v44, v44
    v_exp_f32 v45, v45
    v_exp_f32 v46, v46
    v_exp_f32 v47, v47
    s_setprio 1
    s_waitcnt lgkmcnt(0)
    v_mfma_f32_32x32x16_bf16 v[16:31], v[124:127], v[112:115], 0
    s_setprio 2
    s_add_u32 m0, s36, 32768
    s_add_u32 s34, s34, s45
    buffer_load_dwordx4 v1, s[8:11], s33 offen lds
    v_mfma_f32_32x32x8_bf16 v[16:31], v[128:129], v[120:121], v[16:31]
    s_add_u32 m0, s35, 32768
    s_add_u32 s33, s33, 4096
    buffer_load_dwordx4 v1, s[8:11], s32 offen lds
    v_mfma_f32_32x32x16_bf16 v[80:95], v[140:143], v[148:151], v[80:95]
    ds_read_b128 v[140:143], v2 offset:39936
    s_xor_b32 s35, s35, 0x10000
    s_xor_b32 s36, s36, 0x10000
    s_xor_b32 s37, s37, 0x10000
    buffer_load_dwordx4 v[180:183], v1, s[4:7], s47 offen offset:1024
    v_mfma_f32_32x32x16_bf16 v[96:111], v[144:147], v[148:151], v[96:111]
    ds_read_b128 v[144:147], v2 offset:44032
    ds_read_b128 v[148:151], v5 offset:32768
    v_smfmac_f32_32x32x32_bf16 v[64:79], v[132:135], v[32:39], v9
    ds_read_b128 v[132:135], v2 offset:34816
    buffer_load_dwordx4 v[184:187], v1, s[4:7], s47 offen offset:2048
    v_smfmac_f32_32x32x32_bf16 v[64:79], v[136:139], v[40:47], v9
    ds_read_b128 v[136:139], v2 offset:35840
    s_setprio 0
    v_exp_f32 v16, v16
    v_exp_f32 v17, v17
    v_exp_f32 v18, v18
    v_exp_f32 v19, v19
    v_exp_f32 v20, v20
    v_exp_f32 v21, v21
    v_exp_f32 v22, v22
    v_exp_f32 v23, v23
    v_exp_f32 v24, v24
    v_exp_f32 v25, v25
    v_exp_f32 v26, v26
    v_exp_f32 v27, v27
    v_exp_f32 v28, v28
    v_exp_f32 v29, v29
    v_exp_f32 v30, v30
    v_exp_f32 v31, v31
    v_xor_b32 v3, 0x10000, v3
    v_xor_b32 v4, 0x10000, v4
    v_xor_b32 v5, 0x10000, v5
    s_waitcnt vmcnt(7)
    s_barrier
    s_setprio 1
    s_waitcnt lgkmcnt(2)
    v_mfma_f32_32x32x16_bf16 v[32:47], v[124:127], v[116:119], 0
    s_setprio 2
    buffer_load_dwordx4 v[188:191], v1, s[4:7], s47 offen offset:3072
    v_mfma_f32_32x32x8_bf16 v[32:47], v[128:129], v[122:123], v[32:47]
    ds_read_b128 v[124:127], v3 offset:0
    ds_read_b64 v[128:129], v4 offset:0
    v_mfma_f32_32x32x16_bf16 v[80:95], v[140:143], v[148:151], v[80:95]
    ds_read_b128 v[140:143], v2 offset:40960
    s_add_u32 m0, s37, 0
    s_nop 0
    buffer_load_dwordx4 v7, s[12:15], s34 offen lds
    v_mfma_f32_32x32x16_bf16 v[96:111], v[144:147], v[148:151], v[96:111]
    s_waitcnt lgkmcnt(3)
    ds_read_b128 v[144:147], v2 offset:45056
    ds_read_b128 v[148:151], v6 offset:32768
    v_smfmac_f32_32x32x32_bf16 v[48:63], v[132:135], v[16:23], v9
    s_add_u32 m0, s37, 1024
    s_add_u32 s32, s32, 6656
    buffer_load_dwordx4 v8, s[12:15], s34 offen lds
    v_smfmac_f32_32x32x32_bf16 v[48:63], v[136:139], v[24:31], v9
    buffer_load_dwordx4 v[192:195], v172, s[4:7], s47 offen offset:0
    s_setprio 0
    v_exp_f32 v32, v32
    v_exp_f32 v33, v33
    v_exp_f32 v34, v34
    v_exp_f32 v35, v35
    v_exp_f32 v36, v36
    v_exp_f32 v37, v37
    v_exp_f32 v38, v38
    v_exp_f32 v39, v39
    v_exp_f32 v40, v40
    v_exp_f32 v41, v41
    v_exp_f32 v42, v42
    v_exp_f32 v43, v43
    v_exp_f32 v44, v44
    v_exp_f32 v45, v45
    v_exp_f32 v46, v46
    v_exp_f32 v47, v47
    v_xor_b32 v2, 0x10000, v2
    v_xor_b32 v6, 0x10000, v6
    s_setprio 1
    s_waitcnt lgkmcnt(0)
    v_mfma_f32_32x32x16_bf16 v[16:31], v[124:127], v[112:115], 0
    s_setprio 2
    s_add_u32 m0, s36, 0
    s_add_u32 s34, s34, s45
    buffer_load_dwordx4 v1, s[8:11], s33 offen lds
    v_mfma_f32_32x32x8_bf16 v[16:31], v[128:129], v[120:121], v[16:31]
    s_add_u32 m0, s35, 0
    s_add_u32 s33, s33, 4096
    buffer_load_dwordx4 v1, s[8:11], s32 offen lds
    v_mfma_f32_32x32x16_bf16 v[80:95], v[140:143], v[148:151], v[80:95]
    ds_read_b128 v[140:143], v2 offset:7168
    s_add_u32 s47, s47, 40960
    buffer_load_dwordx4 v[196:199], v1, s[4:7], s47 offen offset:0
    v_mfma_f32_32x32x16_bf16 v[96:111], v[144:147], v[148:151], v[96:111]
    ds_read_b128 v[144:147], v2 offset:11264
    ds_read_b128 v[148:151], v5 offset:0
    v_smfmac_f32_32x32x32_bf16 v[64:79], v[132:135], v[32:39], v9
    ds_read_b128 v[132:135], v2 offset:2048
    buffer_load_dwordx4 v[200:203], v1, s[4:7], s47 offen offset:1024
    v_smfmac_f32_32x32x32_bf16 v[64:79], v[136:139], v[40:47], v9
    ds_read_b128 v[136:139], v2 offset:3072
    s_setprio 0
    v_exp_f32 v16, v16
    v_exp_f32 v17, v17
    v_exp_f32 v18, v18
    v_exp_f32 v19, v19
    v_exp_f32 v20, v20
    v_exp_f32 v21, v21
    v_exp_f32 v22, v22
    v_exp_f32 v23, v23
    v_exp_f32 v24, v24
    v_exp_f32 v25, v25
    v_exp_f32 v26, v26
    v_exp_f32 v27, v27
    v_exp_f32 v28, v28
    v_exp_f32 v29, v29
    v_exp_f32 v30, v30
    v_exp_f32 v31, v31
    s_waitcnt vmcnt(10)
    s_barrier
    s_setprio 1
    s_waitcnt lgkmcnt(2)
    v_mfma_f32_32x32x16_bf16 v[32:47], v[124:127], v[116:119], 0
    s_setprio 2
    buffer_load_dwordx4 v[204:207], v1, s[4:7], s47 offen offset:2048
    v_mfma_f32_32x32x8_bf16 v[32:47], v[128:129], v[122:123], v[32:47]
    ds_read_b128 v[124:127], v3 offset:32768
    ds_read_b64 v[128:129], v4 offset:32768
    v_mfma_f32_32x32x16_bf16 v[80:95], v[140:143], v[148:151], v[80:95]
    ds_read_b128 v[140:143], v2 offset:8192
    s_add_u32 m0, s37, 32768
    s_nop 0
    buffer_load_dwordx4 v7, s[12:15], s34 offen lds
    v_mfma_f32_32x32x16_bf16 v[96:111], v[144:147], v[148:151], v[96:111]
    s_waitcnt lgkmcnt(3)
    ds_read_b128 v[144:147], v2 offset:12288
    ds_read_b128 v[148:151], v6 offset:0
    v_smfmac_f32_32x32x32_bf16 v[48:63], v[132:135], v[16:23], v9
    s_add_u32 m0, s37, 33792
    s_add_u32 s32, s32, 6656
    buffer_load_dwordx4 v8, s[12:15], s34 offen lds
    v_smfmac_f32_32x32x32_bf16 v[48:63], v[136:139], v[24:31], v9
    buffer_load_dwordx4 v[208:211], v1, s[4:7], s47 offen offset:3072
    s_setprio 0
    v_exp_f32 v32, v32
    v_exp_f32 v33, v33
    v_exp_f32 v34, v34
    v_exp_f32 v35, v35
    v_exp_f32 v36, v36
    v_exp_f32 v37, v37
    v_exp_f32 v38, v38
    v_exp_f32 v39, v39
    v_exp_f32 v40, v40
    v_exp_f32 v41, v41
    v_exp_f32 v42, v42
    v_exp_f32 v43, v43
    v_exp_f32 v44, v44
    v_exp_f32 v45, v45
    v_exp_f32 v46, v46
    v_exp_f32 v47, v47
    s_setprio 1
    s_waitcnt lgkmcnt(0)
    v_mfma_f32_32x32x16_bf16 v[16:31], v[124:127], v[112:115], 0
    s_setprio 2
    s_add_u32 m0, s36, 32768
    s_add_u32 s34, s34, s45
    buffer_load_dwordx4 v1, s[8:11], s33 offen lds
    v_mfma_f32_32x32x8_bf16 v[16:31], v[128:129], v[120:121], v[16:31]
    s_add_u32 m0, s35, 32768
    s_add_u32 s33, s33, 4096
    buffer_load_dwordx4 v1, s[8:11], s32 offen lds
    v_mfma_f32_32x32x16_bf16 v[80:95], v[140:143], v[148:151], v[80:95]
    ds_read_b128 v[140:143], v2 offset:39936
    buffer_load_dwordx4 v[212:215], v172, s[4:7], s47 offen offset:0
    v_mfma_f32_32x32x16_bf16 v[96:111], v[144:147], v[148:151], v[96:111]
    ds_read_b128 v[144:147], v2 offset:44032
    ds_read_b128 v[148:151], v5 offset:32768
    v_smfmac_f32_32x32x32_bf16 v[64:79], v[132:135], v[32:39], v9
    ds_read_b128 v[132:135], v2 offset:34816
    s_add_u32 s47, s47, 40960
    buffer_load_dwordx4 v[216:219], v1, s[4:7], s47 offen offset:0
    v_smfmac_f32_32x32x32_bf16 v[64:79], v[136:139], v[40:47], v9
    ds_read_b128 v[136:139], v2 offset:35840
    s_setprio 0
    v_exp_f32 v16, v16
    v_exp_f32 v17, v17
    v_exp_f32 v18, v18
    v_exp_f32 v19, v19
    v_exp_f32 v20, v20
    v_exp_f32 v21, v21
    v_exp_f32 v22, v22
    v_exp_f32 v23, v23
    v_exp_f32 v24, v24
    v_exp_f32 v25, v25
    v_exp_f32 v26, v26
    v_exp_f32 v27, v27
    v_exp_f32 v28, v28
    v_exp_f32 v29, v29
    v_exp_f32 v30, v30
    v_exp_f32 v31, v31
    v_xor_b32 v3, 0x10000, v3
    v_xor_b32 v4, 0x10000, v4
    v_xor_b32 v5, 0x10000, v5
    s_waitcnt vmcnt(10)
    s_barrier
    s_setprio 1
    s_waitcnt lgkmcnt(2)
    v_mfma_f32_32x32x16_bf16 v[32:47], v[124:127], v[116:119], 0
    s_setprio 2
    v_mfma_f32_32x32x8_bf16 v[32:47], v[128:129], v[122:123], v[32:47]
    ds_read_b128 v[124:127], v3 offset:0
    ds_read_b64 v[128:129], v4 offset:0
    v_mfma_f32_32x32x16_bf16 v[80:95], v[140:143], v[148:151], v[80:95]
    ds_read_b128 v[140:143], v2 offset:40960
    buffer_load_dwordx4 v[220:223], v1, s[4:7], s47 offen offset:1024
    v_mfma_f32_32x32x16_bf16 v[96:111], v[144:147], v[148:151], v[96:111]
    s_waitcnt lgkmcnt(3)
    ds_read_b128 v[144:147], v2 offset:45056
    ds_read_b128 v[148:151], v6 offset:32768
    v_smfmac_f32_32x32x32_bf16 v[48:63], v[132:135], v[16:23], v9
    buffer_load_dwordx4 v[224:227], v1, s[4:7], s47 offen offset:2048
    v_smfmac_f32_32x32x32_bf16 v[48:63], v[136:139], v[24:31], v9
    buffer_load_dwordx4 v[228:231], v1, s[4:7], s47 offen offset:3072
    s_setprio 0
    v_exp_f32 v32, v32
    v_exp_f32 v33, v33
    v_exp_f32 v34, v34
    v_exp_f32 v35, v35
    v_exp_f32 v36, v36
    v_exp_f32 v37, v37
    v_exp_f32 v38, v38
    v_exp_f32 v39, v39
    v_exp_f32 v40, v40
    v_exp_f32 v41, v41
    v_exp_f32 v42, v42
    v_exp_f32 v43, v43
    v_exp_f32 v44, v44
    v_exp_f32 v45, v45
    v_exp_f32 v46, v46
    v_exp_f32 v47, v47
    v_xor_b32 v2, 0x10000, v2
    v_xor_b32 v6, 0x10000, v6
    s_setprio 1
    s_waitcnt lgkmcnt(0)
    v_mfma_f32_32x32x16_bf16 v[16:31], v[124:127], v[112:115], 0
    s_setprio 2
    buffer_load_dwordx4 v[232:235], v172, s[4:7], s47 offen offset:0
    v_mfma_f32_32x32x8_bf16 v[16:31], v[128:129], v[120:121], v[16:31]
    s_add_u32 s47, s47, 40960
    buffer_load_dwordx4 v[236:239], v1, s[4:7], s47 offen offset:0
    v_mfma_f32_32x32x16_bf16 v[80:95], v[140:143], v[148:151], v[80:95]
    ds_read_b128 v[140:143], v2 offset:7168
    buffer_load_dwordx4 v[240:243], v1, s[4:7], s47 offen offset:1024
    v_mfma_f32_32x32x16_bf16 v[96:111], v[144:147], v[148:151], v[96:111]
    ds_read_b128 v[144:147], v2 offset:11264
    ds_read_b128 v[148:151], v5 offset:0
    v_smfmac_f32_32x32x32_bf16 v[64:79], v[132:135], v[32:39], v9
    ds_read_b128 v[132:135], v2 offset:2048
    buffer_load_dwordx4 v[244:247], v1, s[4:7], s47 offen offset:2048
    v_smfmac_f32_32x32x32_bf16 v[64:79], v[136:139], v[40:47], v9
    ds_read_b128 v[136:139], v2 offset:3072
    s_setprio 0
    v_exp_f32 v16, v16
    v_exp_f32 v17, v17
    v_exp_f32 v18, v18
    v_exp_f32 v19, v19
    v_exp_f32 v20, v20
    v_exp_f32 v21, v21
    v_exp_f32 v22, v22
    v_exp_f32 v23, v23
    v_exp_f32 v24, v24
    v_exp_f32 v25, v25
    v_exp_f32 v26, v26
    v_exp_f32 v27, v27
    v_exp_f32 v28, v28
    v_exp_f32 v29, v29
    v_exp_f32 v30, v30
    v_exp_f32 v31, v31
    s_waitcnt vmcnt(9)
    s_barrier
    s_setprio 1
    s_waitcnt lgkmcnt(2)
    v_mfma_f32_32x32x16_bf16 v[32:47], v[124:127], v[116:119], 0
    s_setprio 2
    v_mfma_f32_32x32x8_bf16 v[32:47], v[128:129], v[122:123], v[32:47]
    ds_read_b128 v[124:127], v3 offset:32768
    ds_read_b64 v[128:129], v4 offset:32768
    v_mfma_f32_32x32x16_bf16 v[80:95], v[140:143], v[148:151], v[80:95]
    ds_read_b128 v[140:143], v2 offset:8192
    buffer_load_dwordx4 v[248:251], v1, s[4:7], s47 offen offset:3072
    v_mfma_f32_32x32x16_bf16 v[96:111], v[144:147], v[148:151], v[96:111]
    s_waitcnt lgkmcnt(3)
    ds_read_b128 v[144:147], v2 offset:12288
    ds_read_b128 v[148:151], v6 offset:0
    v_smfmac_f32_32x32x32_bf16 v[48:63], v[132:135], v[16:23], v9
    buffer_load_dwordx4 v[252:255], v172, s[4:7], s47 offen offset:0
    v_smfmac_f32_32x32x32_bf16 v[48:63], v[136:139], v[24:31], v9
    s_add_u32 s47, s47, 40960
    buffer_load_dwordx4 v[152:155], v1, s[4:7], s47 offen offset:0
    s_setprio 0
    v_exp_f32 v32, v32
    v_exp_f32 v33, v33
    v_exp_f32 v34, v34
    v_exp_f32 v35, v35
    v_exp_f32 v36, v36
    v_exp_f32 v37, v37
    v_exp_f32 v38, v38
    v_exp_f32 v39, v39
    v_exp_f32 v40, v40
    v_exp_f32 v41, v41
    v_exp_f32 v42, v42
    v_exp_f32 v43, v43
    v_exp_f32 v44, v44
    v_exp_f32 v45, v45
    v_exp_f32 v46, v46
    v_exp_f32 v47, v47
    s_setprio 1
    s_waitcnt lgkmcnt(0)
    v_mfma_f32_32x32x16_bf16 v[16:31], v[124:127], v[112:115], 0
    s_setprio 2
    buffer_load_dwordx4 v[156:159], v1, s[4:7], s47 offen offset:1024
    v_mfma_f32_32x32x8_bf16 v[16:31], v[128:129], v[120:121], v[16:31]
    buffer_load_dwordx4 v[160:163], v1, s[4:7], s47 offen offset:2048
    v_mfma_f32_32x32x16_bf16 v[80:95], v[140:143], v[148:151], v[80:95]
    ds_read_b128 v[140:143], v2 offset:39936
    buffer_load_dwordx4 v[164:167], v1, s[4:7], s47 offen offset:3072
    v_mfma_f32_32x32x16_bf16 v[96:111], v[144:147], v[148:151], v[96:111]
    ds_read_b128 v[144:147], v2 offset:44032
    ds_read_b128 v[148:151], v5 offset:32768
    v_smfmac_f32_32x32x32_bf16 v[64:79], v[132:135], v[32:39], v9
    ds_read_b128 v[132:135], v2 offset:34816
    buffer_load_dwordx4 v[168:171], v172, s[4:7], s47 offen offset:0
    v_smfmac_f32_32x32x32_bf16 v[64:79], v[136:139], v[40:47], v9
    ds_read_b128 v[136:139], v2 offset:35840
    s_setprio 0
    v_exp_f32 v16, v16
    v_exp_f32 v17, v17
    v_exp_f32 v18, v18
    v_exp_f32 v19, v19
    v_exp_f32 v20, v20
    v_exp_f32 v21, v21
    v_exp_f32 v22, v22
    v_exp_f32 v23, v23
    v_exp_f32 v24, v24
    v_exp_f32 v25, v25
    v_exp_f32 v26, v26
    v_exp_f32 v27, v27
    v_exp_f32 v28, v28
    v_exp_f32 v29, v29
    v_exp_f32 v30, v30
    v_exp_f32 v31, v31
    s_setprio 1
    s_waitcnt lgkmcnt(2)
    v_mfma_f32_32x32x16_bf16 v[32:47], v[124:127], v[116:119], 0
    s_setprio 2
    v_mfma_f32_32x32x8_bf16 v[32:47], v[128:129], v[122:123], v[32:47]
    v_mfma_f32_32x32x16_bf16 v[80:95], v[140:143], v[148:151], v[80:95]
    ds_read_b128 v[140:143], v2 offset:40960
    s_mov_b32 s50, 0x1f800000
    s_mov_b32 s51, 0x5f800000
    s_lshl_b32 s48, s26, 6
    s_add_u32 s48, s48, s25
    s_lshl_b32 s48, s48, 6
    s_add_u32 s48, s48, 31981568
    v_mfma_f32_32x32x16_bf16 v[96:111], v[144:147], v[148:151], v[96:111]
    s_waitcnt lgkmcnt(1)
    ds_read_b128 v[144:147], v2 offset:45056
    ds_read_b128 v[148:151], v6 offset:32768
    v_smfmac_f32_32x32x32_bf16 v[48:63], v[132:135], v[16:23], v9
    v_smfmac_f32_32x32x32_bf16 v[48:63], v[136:139], v[24:31], v9
    s_waitcnt lgkmcnt(0)
    v_mfma_f32_32x32x16_bf16 v[80:95], v[140:143], v[148:151], v[80:95]
    v_mfma_f32_32x32x16_bf16 v[96:111], v[144:147], v[148:151], v[96:111]
    s_setprio 0
    v_exp_f32 v32, v32
    v_exp_f32 v33, v33
    v_exp_f32 v34, v34
    v_exp_f32 v35, v35
    v_exp_f32 v36, v36
    v_exp_f32 v37, v37
    v_exp_f32 v38, v38
    v_exp_f32 v39, v39
    v_exp_f32 v40, v40
    v_exp_f32 v41, v41
    v_exp_f32 v42, v42
    ds_write_b128 v12, v[80:83] offset:0
    ds_write_b128 v12, v[84:87] offset:1024
    v_exp_f32 v43, v43
    ds_write_b128 v12, v[88:91] offset:2048
    ds_write_b128 v12, v[92:95] offset:3072
    v_exp_f32 v44, v44
    ds_write_b128 v12, v[96:99] offset:4096
    v_exp_f32 v45, v45
    ds_write_b128 v12, v[100:103] offset:5120
    v_exp_f32 v46, v46
    ds_write_b128 v12, v[104:107] offset:6144
    v_exp_f32 v47, v47
    ds_write_b128 v12, v[108:111] offset:7168
    s_setprio 1
    v_smfmac_f32_32x32x32_bf16 v[64:79], v[132:135], v[32:39], v9
    s_setprio 2
    v_smfmac_f32_32x32x32_bf16 v[64:79], v[136:139], v[40:47], v9
    s_setprio 0
    s_waitcnt lgkmcnt(0)
    s_barrier
    ds_read_b128 v[80:83], v13 offset:0
    ds_read_b128 v[84:87], v13 offset:1024
    ds_read_b128 v[88:91], v13 offset:2048
    ds_read_b128 v[92:95], v13 offset:3072
    ds_read_b128 v[96:99], v13 offset:4096
    ds_read_b128 v[100:103], v13 offset:5120
    ds_read_b128 v[104:107], v13 offset:6144
    ds_read_b128 v[108:111], v13 offset:7168
    s_waitcnt lgkmcnt(4)
    v_pk_add_f32 v[48:49], v[48:49], v[80:81]
    v_pk_add_f32 v[50:51], v[50:51], v[82:83]
    v_pk_add_f32 v[52:53], v[52:53], v[84:85]
    v_pk_add_f32 v[54:55], v[54:55], v[86:87]
    v_pk_add_f32 v[56:57], v[56:57], v[88:89]
    v_pk_add_f32 v[58:59], v[58:59], v[90:91]
    v_pk_add_f32 v[60:61], v[60:61], v[92:93]
    s_waitcnt lgkmcnt(0)
    v_pk_add_f32 v[64:65], v[64:65], v[96:97]
    v_pk_add_f32 v[66:67], v[66:67], v[98:99]
    v_pk_add_f32 v[68:69], v[68:69], v[100:101]
    v_pk_add_f32 v[70:71], v[70:71], v[102:103]
    v_pk_add_f32 v[72:73], v[72:73], v[104:105]
    v_pk_add_f32 v[74:75], v[74:75], v[106:107]
    v_pk_add_f32 v[76:77], v[76:77], v[108:109]
    v_cmp_le_f32 s[52:53], s50, v60
    v_cmp_ge_f32 s[54:55], s51, v60
    v_cmp_le_f32 s[56:57], s50, v76
    v_cmp_ge_f32 s[58:59], s51, v76
    s_and_b64 s[52:53], s[52:53], s[54:55]
    s_and_b64 s[56:57], s[56:57], s[58:59]
    s_and_b64 s[52:53], s[52:53], s[56:57]
    s_andn2_b64 s[52:53], exec, s[52:53]
    s_cbranch_scc1 k2_slow
k2_ofin:
    v_rcp_f32 v14, v60
    v_rcp_f32 v15, v76
    s_add_u32 s29, s39, 98304
    s_add_u32 s30, s40, 98304
    v_mul_f32 v48, v48, v14
    v_mul_f32 v49, v49, v14
    v_mul_f32 v50, v50, v14
    v_mul_f32 v51, v51, v14
    v_mul_f32 v52, v52, v14
    v_mul_f32 v53, v53, v14
    v_mul_f32 v54, v54, v14
    v_mul_f32 v55, v55, v14
    v_mul_f32 v56, v56, v14
    v_mul_f32 v57, v57, v14
    v_mul_f32 v58, v58, v14
    v_mul_f32 v59, v59, v14
    v_cvt_pk_bf16_f32 v48, v48, v49
    v_cvt_pk_bf16_f32 v49, v50, v51
    v_cvt_pk_bf16_f32 v50, v52, v53
    v_cvt_pk_bf16_f32 v51, v54, v55
    v_cvt_pk_bf16_f32 v52, v56, v57
    v_cvt_pk_bf16_f32 v53, v58, v59
    buffer_store_dwordx4 v[48:51], v173, s[4:7], s39 offen sc1
    buffer_store_dwordx2 v[52:53], v11, s[4:7], s40 offen sc1
    v_mul_f32 v64, v64, v15
    v_mul_f32 v65, v65, v15
    v_mul_f32 v66, v66, v15
    v_mul_f32 v67, v67, v15
    v_mul_f32 v68, v68, v15
    v_mul_f32 v69, v69, v15
    v_mul_f32 v70, v70, v15
    v_mul_f32 v71, v71, v15
    v_mul_f32 v72, v72, v15
    v_mul_f32 v73, v73, v15
    v_mul_f32 v74, v74, v15
    v_mul_f32 v75, v75, v15
    v_cvt_pk_bf16_f32 v64, v64, v65
    v_cvt_pk_bf16_f32 v65, v66, v67
    v_cvt_pk_bf16_f32 v66, v68, v69
    v_cvt_pk_bf16_f32 v67, v70, v71
    v_cvt_pk_bf16_f32 v68, v72, v73
    v_cvt_pk_bf16_f32 v69, v74, v75
    buffer_store_dwordx4 v[64:67], v173, s[4:7], s29 offen sc1
    buffer_store_dwordx2 v[68:69], v11, s[4:7], s30 offen sc1
    s_branch k2_p3
.p2align 6
k2b_peel:
    s_waitcnt vmcnt(5)
    s_barrier
    v_exp_f32 v16, v16
    v_exp_f32 v17, v17
    v_exp_f32 v18, v18
    v_exp_f32 v19, v19
    v_exp_f32 v20, v20
    v_exp_f32 v21, v21
    v_exp_f32 v22, v22
    v_exp_f32 v23, v23
    v_exp_f32 v24, v24
    v_exp_f32 v25, v25
    v_exp_f32 v26, v26
    v_exp_f32 v27, v27
    v_exp_f32 v28, v28
    v_exp_f32 v29, v29
    v_exp_f32 v30, v30
    v_exp_f32 v31, v31
    s_setprio 1
    s_waitcnt lgkmcnt(2)
    v_mfma_f32_32x32x16_bf16 v[32:47], v[124:127], v[116:119], 0
    s_setprio 2
    s_lshl_b32 s29, s24, 13
    v_add_u32 v12, s29, v1
    v_xor_b32 v13, 0x8000, v12
    v_add_u32 v172, 4096, v1
    v_mfma_f32_32x32x8_bf16 v[32:47], v[128:129], v[122:123], v[32:47]
    ds_read_b128 v[124:127], v3 offset:32768
    ds_read_b64 v[128:129], v4 offset:32768
    v_mfma_f32_32x32x16_bf16 v[80:95], v[140:143], v[148:151], v[80:95]
    ds_read_b128 v[140:143], v2 offset:8192
    s_add_u32 m0, s37, 32768
    s_nop 0
    buffer_load_dwordx4 v7, s[12:15], s34 offen lds
    v_mfma_f32_32x32x16_bf16 v[96:111], v[144:147], v[148:151], v[96:111]
    s_waitcnt lgkmcnt(3)
    ds_read_b128 v[144:147], v2 offset:12288
    ds_read_b128 v[148:151], v6 offset:0
    v_smfmac_f32_32x32x32_bf16 v[48:63], v[132:135], v[16:23], v9
    s_add_u32 m0, s37, 33792
    s_add_u32 s32, s32, 6656
    buffer_load_dwordx4 v8, s[12:15], s34 offen lds
    v_smfmac_f32_32x32x32_bf16 v[48:63], v[136:139], v[24:31], v9
    s_add_u32 s47, s47, 40960
    buffer_load_dwordx4 v[176:179], v1, s[4:7], s47 offen offset:0
    s_setprio 0
    v_exp_f32 v32, v32
    v_exp_f32 v33, v33
    v_exp_f32 v34, v34
    v_exp_f32 v35, v35
    v_exp_f32 v36, v36
    v_exp_f32 v37, v37
    v_exp_f32 v38, v38
    v_exp_f32 v39, v39
    v_exp_f32 v40, v40
    v_exp_f32 v41, v41
    v_exp_f32 v42, v42
    v_exp_f32 v43, v43
    v_exp_f32 v44, v44
    v_exp_f32 v45, v45
    v_exp_f32 v46, v46
    v_exp_f32 v47, v47
    s_setprio 1
    s_waitcnt lgkmcnt(0)
    v_mfma_f32_32x32x16_bf16 v[16:31], v[124:127], v[112:115], 0
    s_setprio 2
    s_add_u32 m0, s36, 32768
    s_add_u32 s34, s34, s45
    buffer_load_dwordx4 v1, s[8:11], s33 offen lds
    v_mfma_f32_32x32x8_bf16 v[16:31], v[128:129], v[120:121], v[16:31]
    s_add_u32 m0, s35, 32768
    s_add_u32 s33, s33, 4096
    buffer_load_dwordx4 v1, s[8:11], s32 offen lds
    v_mfma_f32_32x32x16_bf16 v[80:95], v[140:143], v[148:151], v[80:95]
    ds_read_b128 v[140:143], v2 offset:39936
    s_xor_b32 s35, s35, 0x10000
    s_xor_b32 s36, s36, 0x10000
    s_xor_b32 s37, s37, 0x10000
    buffer_load_dwordx4 v[180:183], v1, s[4:7], s47 offen offset:1024
    v_mfma_f32_32x32x16_bf16 v[96:111], v[144:147], v[148:151], v[96:111]
    ds_read_b128 v[144:147], v2 offset:44032
    ds_read_b128 v[148:151], v5 offset:32768
    v_smfmac_f32_32x32x32_bf16 v[64:79], v[132:135], v[32:39], v9
    ds_read_b128 v[132:135], v2 offset:34816
    buffer_load_dwordx4 v[184:187], v1, s[4:7], s47 offen offset:2048
    v_smfmac_f32_32x32x32_bf16 v[64:79], v[136:139], v[40:47], v9
    ds_read_b128 v[136:139], v2 offset:35840
    s_setprio 0
    s_waitcnt vmcnt(7)
    s_barrier
    v_exp_f32 v16, v16
    v_exp_f32 v17, v17
    v_exp_f32 v18, v18
    v_exp_f32 v19, v19
    v_exp_f32 v20, v20
    v_exp_f32 v21, v21
    v_exp_f32 v22, v22
    v_exp_f32 v23, v23
    v_exp_f32 v24, v24
    v_exp_f32 v25, v25
    v_exp_f32 v26, v26
    v_exp_f32 v27, v27
    v_exp_f32 v28, v28
    v_exp_f32 v29, v29
    v_exp_f32 v30, v30
    v_exp_f32 v31, v31
    v_xor_b32 v3, 0x10000, v3
    v_xor_b32 v4, 0x10000, v4
    v_xor_b32 v5, 0x10000, v5
    s_setprio 1
    s_waitcnt lgkmcnt(2)
    v_mfma_f32_32x32x16_bf16 v[32:47], v[124:127], v[116:119], 0
    s_setprio 2
    buffer_load_dwordx4 v[188:191], v1, s[4:7], s47 offen offset:3072
    v_mfma_f32_32x32x8_bf16 v[32:47], v[128:129], v[122:123], v[32:47]
    ds_read_b128 v[124:127], v3 offset:0
    ds_read_b64 v[128:129], v4 offset:0
    v_mfma_f32_32x32x16_bf16 v[80:95], v[140:143], v[148:151], v[80:95]
    ds_read_b128 v[140:143], v2 offset:40960
    s_add_u32 m0, s37, 0
    s_nop 0
    buffer_load_dwordx4 v7, s[12:15], s34 offen lds
    v_mfma_f32_32x32x16_bf16 v[96:111], v[144:147], v[148:151], v[96:111]
    s_waitcnt lgkmcnt(3)
    ds_read_b128 v[144:147], v2 offset:45056
    ds_read_b128 v[148:151], v6 offset:32768
    v_smfmac_f32_32x32x32_bf16 v[48:63], v[132:135], v[16:23], v9
    s_add_u32 m0, s37, 1024
    s_add_u32 s32, s32, 6656
    buffer_load_dwordx4 v8, s[12:15], s34 offen lds
    v_smfmac_f32_32x32x32_bf16 v[48:63], v[136:139], v[24:31], v9
    buffer_load_dwordx4 v[192:195], v172, s[4:7], s47 offen offset:0
    s_setprio 0
    v_exp_f32 v32, v32
    v_exp_f32 v33, v33
    v_exp_f32 v34, v34
    v_exp_f32 v35, v35
    v_exp_f32 v36, v36
    v_exp_f32 v37, v37
    v_exp_f32 v38, v38
    v_exp_f32 v39, v39
    v_exp_f32 v40, v40
    v_exp_f32 v41, v41
    v_exp_f32 v42, v42
    v_exp_f32 v43, v43
    v_exp_f32 v44, v44
    v_exp_f32 v45, v45
    v_exp_f32 v46, v46
    v_exp_f32 v47, v47
    v_xor_b32 v2, 0x10000, v2
    v_xor_b32 v6, 0x10000, v6
    s_setprio 1
    s_waitcnt lgkmcnt(0)
    v_mfma_f32_32x32x16_bf16 v[16:31], v[124:127], v[112:115], 0
    s_setprio 2
    s_add_u32 m0, s36, 0
    s_add_u32 s34, s34, s45
    buffer_load_dwordx4 v1, s[8:11], s33 offen lds
    v_mfma_f32_32x32x8_bf16 v[16:31], v[128:129], v[120:121], v[16:31]
    s_add_u32 m0, s35, 0
    s_add_u32 s33, s33, 4096
    buffer_load_dwordx4 v1, s[8:11], s32 offen lds
    v_mfma_f32_32x32x16_bf16 v[80:95], v[140:143], v[148:151], v[80:95]
    ds_read_b128 v[140:143], v2 offset:7168
    s_add_u32 s47, s47, 40960
    buffer_load_dwordx4 v[196:199], v1, s[4:7], s47 offen offset:0
    v_mfma_f32_32x32x16_bf16 v[96:111], v[144:147], v[148:151], v[96:111]
    ds_read_b128 v[144:147], v2 offset:11264
    ds_read_b128 v[148:151], v5 offset:0
    v_smfmac_f32_32x32x32_bf16 v[64:79], v[132:135], v[32:39], v9
    ds_read_b128 v[132:135], v2 offset:2048
    buffer_load_dwordx4 v[200:203], v1, s[4:7], s47 offen offset:1024
    v_smfmac_f32_32x32x32_bf16 v[64:79], v[136:139], v[40:47], v9
    ds_read_b128 v[136:139], v2 offset:3072
    s_setprio 0
    s_waitcnt vmcnt(10)
    s_barrier
    v_exp_f32 v16, v16
    v_exp_f32 v17, v17
    v_exp_f32 v18, v18
    v_exp_f32 v19, v19
    v_exp_f32 v20, v20
    v_exp_f32 v21, v21
    v_exp_f32 v22, v22
    v_exp_f32 v23, v23
    v_exp_f32 v24, v24
    v_exp_f32 v25, v25
    v_exp_f32 v26, v26
    v_exp_f32 v27, v27
    v_exp_f32 v28, v28
    v_exp_f32 v29, v29
    v_exp_f32 v30, v30
    v_exp_f32 v31, v31
    s_setprio 1
    s_waitcnt lgkmcnt(2)
    v_mfma_f32_32x32x16_bf16 v[32:47], v[124:127], v[116:119], 0
    s_setprio 2
    buffer_load_dwordx4 v[204:207], v1, s[4:7], s47 offen offset:2048
    v_mfma_f32_32x32x8_bf16 v[32:47], v[128:129], v[122:123], v[32:47]
    ds_read_b128 v[124:127], v3 offset:32768
    ds_read_b64 v[128:129], v4 offset:32768
    v_mfma_f32_32x32x16_bf16 v[80:95], v[140:143], v[148:151], v[80:95]
    ds_read_b128 v[140:143], v2 offset:8192
    s_add_u32 m0, s37, 32768
    s_nop 0
    buffer_load_dwordx4 v7, s[12:15], s34 offen lds
    v_mfma_f32_32x32x16_bf16 v[96:111], v[144:147], v[148:151], v[96:111]
    s_waitcnt lgkmcnt(3)
    ds_read_b128 v[144:147], v2 offset:12288
    ds_read_b128 v[148:151], v6 offset:0
    v_smfmac_f32_32x32x32_bf16 v[48:63], v[132:135], v[16:23], v9
    s_add_u32 m0, s37, 33792
    s_add_u32 s32, s32, 6656
    buffer_load_dwordx4 v8, s[12:15], s34 offen lds
    v_smfmac_f32_32x32x32_bf16 v[48:63], v[136:139], v[24:31], v9
    s_lshl_b32 s27, s27, 2
    s_add_u32 s27, s27, s42
    s_lshr_b32 s48, s27, 1
    s_lshl_b32 s48, s48, 5
    s_add_u32 s48, s48, s28
    s_lshl_b32 s48, s48, 1
    s_and_b32 s29, s27, 1
    s_add_u32 s48, s48, s29
    s_lshl_b32 s48, s48, 6
    s_add_u32 s48, s48, 31983616
    s_setprio 0
    v_exp_f32 v32, v32
    v_exp_f32 v33, v33
    v_exp_f32 v34, v34
    v_exp_f32 v35, v35
    v_exp_f32 v36, v36
    v_exp_f32 v37, v37
    v_exp_f32 v38, v38
    v_exp_f32 v39, v39
    v_exp_f32 v40, v40
    v_exp_f32 v41, v41
    v_exp_f32 v42, v42
    v_exp_f32 v43, v43
    v_exp_f32 v44, v44
    v_exp_f32 v45, v45
    v_exp_f32 v46, v46
    v_exp_f32 v47, v47
    s_setprio 1
    s_waitcnt lgkmcnt(0)
    v_mfma_f32_32x32x16_bf16 v[16:31], v[124:127], v[112:115], 0
    s_setprio 2
    s_add_u32 m0, s36, 32768
    s_add_u32 s34, s34, s45
    buffer_load_dwordx4 v1, s[8:11], s33 offen lds
    v_mfma_f32_32x32x8_bf16 v[16:31], v[128:129], v[120:121], v[16:31]
    s_add_u32 m0, s35, 32768
    s_add_u32 s33, s33, 4096
    buffer_load_dwordx4 v1, s[8:11], s32 offen lds
    v_mfma_f32_32x32x16_bf16 v[80:95], v[140:143], v[148:151], v[80:95]
    ds_read_b128 v[140:143], v2 offset:39936
    s_mul_i32 s39, s27, 98304
    s_lshl_b32 s29, s28, 11
    s_add_u32 s39, s39, s29
    s_add_u32 s39, s39, 23089152
    s_cmp_eq_u32 s44, 7
    s_cselect_b32 s39, 0xf0000000, s39
    s_cselect_b32 s48, 0xf0000000, s48
    s_cmp_eq_u32 s28, 13
    s_cselect_b32 s40, 0xf0000000, s39
    s_lshl_b32 s30, s27, 6
    v_and_b32 v14, 31, v0
    v_lshlrev_b32 v14, 1, v14
    buffer_load_ushort v10, v14, s[20:23], s30 offen
    v_mfma_f32_32x32x16_bf16 v[96:111], v[144:147], v[148:151], v[96:111]
    ds_read_b128 v[144:147], v2 offset:44032
    ds_read_b128 v[148:151], v5 offset:32768
    v_smfmac_f32_32x32x32_bf16 v[64:79], v[132:135], v[32:39], v9
    ds_read_b128 v[132:135], v2 offset:34816
    buffer_load_dwordx4 v[152:155], v173, s[4:7], s39 offen offset:0
    v_smfmac_f32_32x32x32_bf16 v[64:79], v[136:139], v[40:47], v9
    ds_read_b128 v[136:139], v2 offset:35840
    s_setprio 0
    s_waitcnt vmcnt(9)
    s_barrier
    v_exp_f32 v16, v16
    v_exp_f32 v17, v17
    v_exp_f32 v18, v18
    v_exp_f32 v19, v19
    v_exp_f32 v20, v20
    v_exp_f32 v21, v21
    v_exp_f32 v22, v22
    v_exp_f32 v23, v23
    v_exp_f32 v24, v24
    v_exp_f32 v25, v25
    v_exp_f32 v26, v26
    v_exp_f32 v27, v27
    v_exp_f32 v28, v28
    v_exp_f32 v29, v29
    v_exp_f32 v30, v30
    v_exp_f32 v31, v31
    v_xor_b32 v3, 0x10000, v3
    v_xor_b32 v4, 0x10000, v4
    v_xor_b32 v5, 0x10000, v5
    s_setprio 1
    s_waitcnt lgkmcnt(2)
    v_mfma_f32_32x32x16_bf16 v[32:47], v[124:127], v[116:119], 0
    s_setprio 2
    v_mfma_f32_32x32x8_bf16 v[32:47], v[128:129], v[122:123], v[32:47]
    ds_read_b128 v[124:127], v3 offset:0
    ds_read_b64 v[128:129], v4 offset:0
    v_mfma_f32_32x32x16_bf16 v[80:95], v[140:143], v[148:151], v[80:95]
    ds_read_b128 v[140:143], v2 offset:40960
    buffer_load_dwordx4 v[156:159], v173, s[4:7], s39 offen offset:512
    v_mfma_f32_32x32x16_bf16 v[96:111], v[144:147], v[148:151], v[96:111]
    s_waitcnt lgkmcnt(3)
    ds_read_b128 v[144:147], v2 offset:45056
    ds_read_b128 v[148:151], v6 offset:32768
    v_smfmac_f32_32x32x32_bf16 v[48:63], v[132:135], v[16:23], v9
    buffer_load_dwordx4 v[160:163], v173, s[4:7], s40 offen offset:1024
    v_smfmac_f32_32x32x32_bf16 v[48:63], v[136:139], v[24:31], v9
    buffer_load_dwordx4 v[164:167], v173, s[4:7], s40 offen offset:1536
    s_setprio 0
    v_exp_f32 v32, v32
    v_exp_f32 v33, v33
    v_exp_f32 v34, v34
    v_exp_f32 v35, v35
    v_exp_f32 v36, v36
    v_exp_f32 v37, v37
    v_exp_f32 v38, v38
    v_exp_f32 v39, v39
    v_exp_f32 v40, v40
    v_exp_f32 v41, v41
    v_exp_f32 v42, v42
    v_exp_f32 v43, v43
    v_exp_f32 v44, v44
    v_exp_f32 v45, v45
    v_exp_f32 v46, v46
    v_exp_f32 v47, v47
    v_xor_b32 v2, 0x10000, v2
    v_xor_b32 v6, 0x10000, v6
    s_setprio 1
    s_waitcnt lgkmcnt(0)
    v_mfma_f32_32x32x16_bf16 v[16:31], v[124:127], v[112:115], 0
    s_setprio 2
    buffer_load_dwordx4 v[208:211], v1, s[4:7], s47 offen offset:3072
    v_mfma_f32_32x32x8_bf16 v[16:31], v[128:129], v[120:121], v[16:31]
    buffer_load_dwordx4 v[212:215], v172, s[4:7], s47 offen offset:0
    v_mfma_f32_32x32x16_bf16 v[80:95], v[140:143], v[148:151], v[80:95]
    ds_read_b128 v[140:143], v2 offset:7168
    s_add_u32 s47, s47, 40960
    buffer_load_dwordx4 v[216:219], v1, s[4:7], s47 offen offset:0
    v_mfma_f32_32x32x16_bf16 v[96:111], v[144:147], v[148:151], v[96:111]
    ds_read_b128 v[144:147], v2 offset:11264
    ds_read_b128 v[148:151], v5 offset:0
    v_smfmac_f32_32x32x32_bf16 v[64:79], v[132:135], v[32:39], v9
    ds_read_b128 v[132:135], v2 offset:2048
    buffer_load_dwordx4 v[220:223], v1, s[4:7], s47 offen offset:1024
    v_smfmac_f32_32x32x32_bf16 v[64:79], v[136:139], v[40:47], v9
    ds_read_b128 v[136:139], v2 offset:3072
    s_setprio 0
    s_waitcnt vmcnt(9)
    s_barrier
    v_exp_f32 v16, v16
    v_exp_f32 v17, v17
    v_exp_f32 v18, v18
    v_exp_f32 v19, v19
    v_exp_f32 v20, v20
    v_exp_f32 v21, v21
    v_exp_f32 v22, v22
    v_exp_f32 v23, v23
    v_exp_f32 v24, v24
    v_exp_f32 v25, v25
    v_exp_f32 v26, v26
    v_exp_f32 v27, v27
    v_exp_f32 v28, v28
    v_exp_f32 v29, v29
    v_exp_f32 v30, v30
    v_exp_f32 v31, v31
    s_setprio 1
    s_waitcnt lgkmcnt(2)
    v_mfma_f32_32x32x16_bf16 v[32:47], v[124:127], v[116:119], 0
    s_setprio 2
    v_mfma_f32_32x32x8_bf16 v[32:47], v[128:129], v[122:123], v[32:47]
    ds_read_b128 v[124:127], v3 offset:32768
    ds_read_b64 v[128:129], v4 offset:32768
    v_mfma_f32_32x32x16_bf16 v[80:95], v[140:143], v[148:151], v[80:95]
    ds_read_b128 v[140:143], v2 offset:8192
    buffer_load_dwordx4 v[224:227], v1, s[4:7], s47 offen offset:2048
    v_mfma_f32_32x32x16_bf16 v[96:111], v[144:147], v[148:151], v[96:111]
    s_waitcnt lgkmcnt(3)
    ds_read_b128 v[144:147], v2 offset:12288
    ds_read_b128 v[148:151], v6 offset:0
    v_smfmac_f32_32x32x32_bf16 v[48:63], v[132:135], v[16:23], v9
    buffer_load_dwordx4 v[228:231], v1, s[4:7], s47 offen offset:3072
    v_smfmac_f32_32x32x32_bf16 v[48:63], v[136:139], v[24:31], v9
    buffer_load_dwordx4 v[232:235], v172, s[4:7], s47 offen offset:0
    s_setprio 0
    v_exp_f32 v32, v32
    v_exp_f32 v33, v33
    v_exp_f32 v34, v34
    v_exp_f32 v35, v35
    v_exp_f32 v36, v36
    v_exp_f32 v37, v37
    v_exp_f32 v38, v38
    v_exp_f32 v39, v39
    v_exp_f32 v40, v40
    v_exp_f32 v41, v41
    v_exp_f32 v42, v42
    v_exp_f32 v43, v43
    v_exp_f32 v44, v44
    v_exp_f32 v45, v45
    v_exp_f32 v46, v46
    v_exp_f32 v47, v47
    s_setprio 1
    s_waitcnt lgkmcnt(0)
    v_mfma_f32_32x32x16_bf16 v[16:31], v[124:127], v[112:115], 0
    s_setprio 2
    s_add_u32 s47, s47, 40960
    buffer_load_dwordx4 v[236:239], v1, s[4:7], s47 offen offset:0
    v_mfma_f32_32x32x8_bf16 v[16:31], v[128:129], v[120:121], v[16:31]
    buffer_load_dwordx4 v[240:243], v1, s[4:7], s47 offen offset:1024
    v_mfma_f32_32x32x16_bf16 v[80:95], v[140:143], v[148:151], v[80:95]
    ds_read_b128 v[140:143], v2 offset:39936
    buffer_load_dwordx4 v[244:247], v1, s[4:7], s47 offen offset:2048
    v_mfma_f32_32x32x16_bf16 v[96:111], v[144:147], v[148:151], v[96:111]
    ds_read_b128 v[144:147], v2 offset:44032
    ds_read_b128 v[148:151], v5 offset:32768
    v_smfmac_f32_32x32x32_bf16 v[64:79], v[132:135], v[32:39], v9
    ds_read_b128 v[132:135], v2 offset:34816
    buffer_load_dwordx4 v[248:251], v1, s[4:7], s47 offen offset:3072
    v_smfmac_f32_32x32x32_bf16 v[64:79], v[136:139], v[40:47], v9
    ds_read_b128 v[136:139], v2 offset:35840
    s_setprio 0
    v_exp_f32 v16, v16
    v_exp_f32 v17, v17
    v_exp_f32 v18, v18
    v_exp_f32 v19, v19
    v_exp_f32 v20, v20
    v_exp_f32 v21, v21
    v_exp_f32 v22, v22
    v_exp_f32 v23, v23
    v_exp_f32 v24, v24
    v_exp_f32 v25, v25
    v_exp_f32 v26, v26
    v_exp_f32 v27, v27
    v_exp_f32 v28, v28
    v_exp_f32 v29, v29
    v_exp_f32 v30, v30
    v_exp_f32 v31, v31
    s_setprio 1
    s_waitcnt lgkmcnt(2)
    v_mfma_f32_32x32x16_bf16 v[32:47], v[124:127], v[116:119], 0
    s_setprio 2
    v_mfma_f32_32x32x8_bf16 v[32:47], v[128:129], v[122:123], v[32:47]
    v_mfma_f32_32x32x16_bf16 v[80:95], v[140:143], v[148:151], v[80:95]
    ds_read_b128 v[140:143], v2 offset:40960
    buffer_load_dwordx4 v[252:255], v172, s[4:7], s47 offen offset:0
    v_mfma_f32_32x32x16_bf16 v[96:111], v[144:147], v[148:151], v[96:111]
    s_waitcnt lgkmcnt(1)
    ds_read_b128 v[144:147], v2 offset:45056
    ds_read_b128 v[148:151], v6 offset:32768
    v_smfmac_f32_32x32x32_bf16 v[48:63], v[132:135], v[16:23], v9
    v_smfmac_f32_32x32x32_bf16 v[48:63], v[136:139], v[24:31], v9
    s_waitcnt lgkmcnt(0)
    v_mfma_f32_32x32x16_bf16 v[80:95], v[140:143], v[148:151], v[80:95]
    v_mfma_f32_32x32x16_bf16 v[96:111], v[144:147], v[148:151], v[96:111]
    s_setprio 0
    v_exp_f32 v32, v32
    v_exp_f32 v33, v33
    v_exp_f32 v34, v34
    v_exp_f32 v35, v35
    v_exp_f32 v36, v36
    v_exp_f32 v37, v37
    v_exp_f32 v38, v38
    v_exp_f32 v39, v39
    v_exp_f32 v40, v40
    ds_write_b128 v12, v[48:51] offset:0
    v_exp_f32 v41, v41
    v_exp_f32 v42, v42
    ds_write_b128 v12, v[52:55] offset:1024
    v_exp_f32 v43, v43
    v_exp_f32 v44, v44
    ds_write_b128 v12, v[56:59] offset:2048
    v_exp_f32 v45, v45
    v_exp_f32 v46, v46
    ds_write_b128 v12, v[60:63] offset:3072
    v_exp_f32 v47, v47
    s_setprio 1
    s_nop 0
    v_smfmac_f32_32x32x32_bf16 v[64:79], v[132:135], v[32:39], v9
    s_setprio 2
    v_smfmac_f32_32x32x32_bf16 v[64:79], v[136:139], v[40:47], v9
    s_waitcnt vmcnt(12)
    v_lshlrev_b32 v14, 16, v10
    v_lshlrev_b32 v15, 16, v10
    v_lshlrev_b32 v16, 16, v152
    v_and_b32 v17, 0xffff0000, v152
    v_lshlrev_b32 v18, 16, v153
    v_and_b32 v19, 0xffff0000, v153
    v_lshlrev_b32 v20, 16, v154
    v_and_b32 v21, 0xffff0000, v154
    v_lshlrev_b32 v22, 16, v155
    v_and_b32 v23, 0xffff0000, v155
    v_lshlrev_b32 v24, 16, v156
    v_and_b32 v25, 0xffff0000, v156
    ds_write_b128 v12, v[64:67] offset:4096
    ds_write_b128 v12, v[68:71] offset:5120
    ds_write_b128 v12, v[72:75] offset:6144
    ds_write_b128 v12, v[76:79] offset:7168
    s_setprio 0
    v_lshlrev_b32 v26, 16, v157
    v_and_b32 v27, 0xffff0000, v157
    v_lshlrev_b32 v28, 16, v158
    v_and_b32 v29, 0xffff0000, v158
    v_lshlrev_b32 v30, 16, v159
    v_and_b32 v31, 0xffff0000, v159
    v_lshlrev_b32 v32, 16, v160
    v_and_b32 v33, 0xffff0000, v160
    v_lshlrev_b32 v34, 16, v161
    v_and_b32 v35, 0xffff0000, v161
    v_lshlrev_b32 v36, 16, v162
    v_and_b32 v37, 0xffff0000, v162
    v_lshlrev_b32 v38, 16, v163
    v_and_b32 v39, 0xffff0000, v163
    v_lshlrev_b32 v40, 16, v164
    v_and_b32 v41, 0xffff0000, v164
    v_lshlrev_b32 v42, 16, v165
    v_and_b32 v43, 0xffff0000, v165
    v_lshlrev_b32 v44, 16, v166
    v_and_b32 v45, 0xffff0000, v166
    v_lshlrev_b32 v46, 16, v167
    v_and_b32 v47, 0xffff0000, v167
    v_pk_add_f32 v[80:81], v[80:81], v[14:15]
    v_pk_add_f32 v[82:83], v[82:83], v[14:15]
    v_pk_add_f32 v[84:85], v[84:85], v[14:15]
    v_pk_add_f32 v[86:87], v[86:87], v[14:15]
    v_pk_add_f32 v[88:89], v[88:89], v[14:15]
    v_pk_add_f32 v[90:91], v[90:91], v[14:15]
    v_pk_add_f32 v[92:93], v[92:93], v[14:15]
    v_pk_add_f32 v[94:95], v[94:95], v[14:15]
    v_pk_add_f32 v[96:97], v[96:97], v[14:15]
    v_pk_add_f32 v[98:99], v[98:99], v[14:15]
    v_pk_add_f32 v[100:101], v[100:101], v[14:15]
    v_pk_add_f32 v[102:103], v[102:103], v[14:15]
    v_pk_add_f32 v[104:105], v[104:105], v[14:15]
    v_pk_add_f32 v[106:107], v[106:107], v[14:15]
    v_pk_add_f32 v[108:109], v[108:109], v[14:15]
    v_pk_add_f32 v[110:111], v[110:111], v[14:15]
    s_waitcnt vmcnt(12) lgkmcnt(0)
    s_barrier
    ds_read_b128 v[48:51], v13 offset:0
    ds_read_b128 v[52:55], v13 offset:1024
    ds_read_b128 v[56:59], v13 offset:2048
    ds_read_b128 v[60:63], v13 offset:3072
    ds_read_b128 v[64:67], v13 offset:4096
    ds_read_b128 v[68:71], v13 offset:5120
    ds_read_b128 v[72:75], v13 offset:6144
    ds_read_b128 v[76:79], v13 offset:7168
    s_waitcnt lgkmcnt(6)
    v_pk_add_f32 v[80:81], v[80:81], v[48:49]
    v_pk_add_f32 v[82:83], v[82:83], v[50:51]
    v_pk_add_f32 v[84:85], v[84:85], v[52:53]
    v_pk_add_f32 v[86:87], v[86:87], v[54:55]
    v_pk_mul_f32 v[80:81], v[80:81], v[16:17]
    v_pk_mul_f32 v[82:83], v[82:83], v[18:19]
    v_pk_mul_f32 v[84:85], v[84:85], v[20:21]
    v_pk_mul_f32 v[86:87], v[86:87], v[22:23]
    v_cvt_pk_bf16_f32 v80, v80, v81
    v_cvt_pk_bf16_f32 v81, v82, v83
    v_cvt_pk_bf16_f32 v82, v84, v85
    v_cvt_pk_bf16_f32 v83, v86, v87
    buffer_store_dwordx4 v[80:83], v173, s[4:7], s39 offen offset:0 sc1
    s_waitcnt lgkmcnt(4)
    v_pk_add_f32 v[88:89], v[88:89], v[56:57]
    v_pk_add_f32 v[90:91], v[90:91], v[58:59]
    v_pk_add_f32 v[92:93], v[92:93], v[60:61]
    v_pk_add_f32 v[94:95], v[94:95], v[62:63]
    v_pk_mul_f32 v[88:89], v[88:89], v[24:25]
    v_pk_mul_f32 v[90:91], v[90:91], v[26:27]
    v_pk_mul_f32 v[92:93], v[92:93], v[28:29]
    v_pk_mul_f32 v[94:95], v[94:95], v[30:31]
    v_cvt_pk_bf16_f32 v88, v88, v89
    v_cvt_pk_bf16_f32 v89, v90, v91
    v_cvt_pk_bf16_f32 v90, v92, v93
    v_cvt_pk_bf16_f32 v91, v94, v95
    buffer_store_dwordx4 v[88:91], v173, s[4:7], s39 offen offset:512 sc1
    s_waitcnt lgkmcnt(2)
    v_pk_add_f32 v[96:97], v[96:97], v[64:65]
    v_pk_add_f32 v[98:99], v[98:99], v[66:67]
    v_pk_add_f32 v[100:101], v[100:101], v[68:69]
    v_pk_add_f32 v[102:103], v[102:103], v[70:71]
    v_pk_mul_f32 v[96:97], v[96:97], v[32:33]
    v_pk_mul_f32 v[98:99], v[98:99], v[34:35]
    v_pk_mul_f32 v[100:101], v[100:101], v[36:37]
    v_pk_mul_f32 v[102:103], v[102:103], v[38:39]
    v_cvt_pk_bf16_f32 v96, v96, v97
    v_cvt_pk_bf16_f32 v97, v98, v99
    v_cvt_pk_bf16_f32 v98, v100, v101
    v_cvt_pk_bf16_f32 v99, v102, v103
    buffer_store_dwordx4 v[96:99], v173, s[4:7], s40 offen offset:1024 sc1
    s_waitcnt lgkmcnt(0)
    v_pk_add_f32 v[104:105], v[104:105], v[72:73]
    v_pk_add_f32 v[106:107], v[106:107], v[74:75]
    v_pk_add_f32 v[108:109], v[108:109], v[76:77]
    v_pk_add_f32 v[110:111], v[110:111], v[78:79]
    v_pk_mul_f32 v[104:105], v[104:105], v[40:41]
    v_pk_mul_f32 v[106:107], v[106:107], v[42:43]
    v_pk_mul_f32 v[108:109], v[108:109], v[44:45]
    v_pk_mul_f32 v[110:111], v[110:111], v[46:47]
    v_cvt_pk_bf16_f32 v104, v104, v105
    v_cvt_pk_bf16_f32 v105, v106, v107
    v_cvt_pk_bf16_f32 v106, v108, v109
    v_cvt_pk_bf16_f32 v107, v110, v111
    buffer_store_dwordx4 v[104:107], v173, s[4:7], s40 offen offset:1536 sc1
k2_p3:
    s_and_b32 s30, s2, 7
    s_lshl_b32 s30, s30, 2
    s_bfe_u32 s29, s2, 0x20003
    s_add_u32 s30, s30, s29
    s_mul_i32 s54, s30, 192
    s_add_u32 s54, s54, s49
    s_lshl_b32 s54, s54, 10
    s_add_u32 s54, s54, 23068672
    s_mul_i32 s55, s30, 81920
    s_mul_i32 s29, s44, 160
    s_add_u32 s55, s55, s29
    s_lshl_b32 s29, s24, 6
    s_sub_u32 s29, s29, 192
    v_add_u32 v9, s29, v0
    v_mul_u32_u24 v8, 3277, v9
    v_lshrrev_b32 v8, 16, v8
    v_mul_u32_u24 v3, 1120, v8
    v_lshl_add_u32 v3, v9, 3, v3
    v_add_u32 v8, v8, v9
    v_lshlrev_b32 v8, 4, v8
    v_add_u32 v2, 65536, v8
    v_lshlrev_b32 v13, 6, v0
    v_mov_b32 v15, 1
    s_mul_i32 s64, s24, 5120
    s_lshl_b32 s29, s24, 12
    s_sub_u32 s29, s29, 1024
    s_cmp_lt_u32 s24, 4
    s_cselect_b32 s64, s64, s29
    s_add_u32 s64, s64, 131072
    v_add_u32 v12, s64, v1
    s_mul_i32 s29, s24, 5376
    s_add_u32 s29, s29, 65536
    v_and_b32 v4, 15, v0
    v_mul_u32_u24 v4, 336, v4
    v_and_b32 v0, 0x30, v0
    v_add3_u32 v0, s29, v4, v0
    s_add_u32 s29, s44, 0
    s_and_b32 s29, s29, 3
    s_mul_i32 s36, s29, 20480
    s_add_u32 s36, s36, s55
    s_mul_i32 s29, s29, 49152
    s_add_u32 s32, s29, s54
    s_add_u32 s29, s44, 1
    s_and_b32 s29, s29, 3
    s_mul_i32 s37, s29, 20480
    s_add_u32 s37, s37, s55
    s_mul_i32 s29, s29, 49152
    s_add_u32 s33, s29, s54
    s_add_u32 s29, s44, 2
    s_and_b32 s29, s29, 3
    s_mul_i32 s38, s29, 20480
    s_add_u32 s38, s38, s55
    s_mul_i32 s29, s29, 49152
    s_add_u32 s34, s29, s54
    s_add_u32 s29, s44, 3
    s_and_b32 s29, s29, 3
    s_mul_i32 s39, s29, 20480
    s_add_u32 s39, s39, s55
    s_mul_i32 s29, s29, 49152
    s_add_u32 s35, s29, s54
    s_lshl_b32 s30, s30, 12
    s_add_u32 s30, s30, 31981568
    s_lshl_b32 s29, s24, 3
    s_mov_b32 s54, 0x20000e00
    s_mov_b32 s55, 0x342e2a24
    s_mov_b32 s56, 0x06200e0e
    s_mov_b32 s57, 0x08080606
    s_lshr_b64 s[54:55], s[54:55], s29
    s_lshr_b64 s[56:57], s[56:57], s29
    s_bfm_b64 s[52:53], s56, s54
    s_mov_b32 s45, 0x100000
    s_mov_b32 s54, 0xbfb8aa3b
    s_mov_b32 s55, s54
    s_mov_b32 s56, 1.0
    s_mov_b32 s57, 1.0
    s_mov_b64 exec, 1
    s_waitcnt vmcnt(0)
    buffer_store_dword v15, off, s[4:7], s48 sc1
    s_mov_b64 exec, -1
    s_cmp_lt_u32 s24, 2
    s_cbranch_scc1 k2_t70
    s_cmp_lt_u32 s24, 3
    s_cbranch_scc1 k2_t60
    s_cmp_lt_u32 s24, 4
    s_cbranch_scc1 k2_t51
    s_add_u32 s47, s47, 40960
    buffer_load_dwordx4 v[152:155], v1, s[4:7], s47 offen offset:0
    buffer_load_dwordx4 v[156:159], v1, s[4:7], s47 offen offset:1024
    buffer_load_dwordx4 v[160:163], v1, s[4:7], s47 offen offset:2048
    buffer_load_dwordx4 v[164:167], v1, s[4:7], s47 offen offset:3072
    buffer_load_dwordx4 v[168:171], v172, s[4:7], s47 offen offset:0
    s_cmp_lt_u32 s24, 6
    s_cbranch_scc1 k2_t51
k2_t61:
    s_add_u32 s47, s47, 40960
    buffer_load_dwordx4 v[112:115], v1, s[4:7], s47 offen offset:0
    buffer_load_dwordx4 v[116:119], v1, s[4:7], s47 offen offset:1024
    buffer_load_dwordx4 v[120:123], v1, s[4:7], s47 offen offset:2048
    buffer_load_dwordx4 v[124:127], v1, s[4:7], s47 offen offset:3072
    buffer_load_dwordx4 v[128:131], v172, s[4:7], s47 offen offset:0
    buffer_load_dwordx2 v[4:5], v3, s[16:19], s36 offen
    buffer_load_dwordx2 v[6:7], v3, s[16:19], s37 offen
    buffer_load_dwordx2 v[8:9], v3, s[16:19], s38 offen
    buffer_load_dwordx2 v[10:11], v3, s[16:19], s39 offen
    s_mov_b64 exec, s[52:53]
k2_p61:
    buffer_load_dword v14, v13, s[4:7], s30 offen sc1
    s_sub_u32 s45, s45, 1
    s_cbranch_scc1 k2_p61x
    s_waitcnt vmcnt(0)
    v_cmp_eq_u32 vcc, 0, v14
    s_and_b64 exec, exec, vcc
    s_cbranch_vccnz k2_p61
k2_p61x:
    s_mov_b64 exec, -1
    s_waitcnt lgkmcnt(0)
    buffer_load_dwordx4 v[16:19], v1, s[4:7], s32 offen offset:0 sc1
    buffer_load_dwordx4 v[20:23], v1, s[4:7], s32 offen offset:1024 sc1
    buffer_load_dwordx4 v[24:27], v1, s[4:7], s32 offen offset:2048 sc1
    buffer_load_dwordx4 v[28:31], v1, s[4:7], s32 offen offset:3072 sc1
    buffer_load_dwordx4 v[32:35], v172, s[4:7], s32 offen offset:0 sc1
    buffer_load_dwordx4 v[36:39], v172, s[4:7], s32 offen offset:1024 sc1
    buffer_load_dwordx4 v[44:47], v1, s[4:7], s33 offen offset:0 sc1
    buffer_load_dwordx4 v[48:51], v1, s[4:7], s33 offen offset:1024 sc1
    buffer_load_dwordx4 v[52:55], v1, s[4:7], s33 offen offset:2048 sc1
    buffer_load_dwordx4 v[56:59], v1, s[4:7], s33 offen offset:3072 sc1
    buffer_load_dwordx4 v[60:63], v172, s[4:7], s33 offen offset:0 sc1
    buffer_load_dwordx4 v[64:67], v172, s[4:7], s33 offen offset:1024 sc1
    s_waitcnt vmcnt(11)
    v_mfma_f32_16x16x32_bf16 v[72:75], v[176:179], v[16:19], 0
    v_mfma_f32_16x16x32_bf16 v[76:79], v[180:183], v[16:19], 0
    v_mfma_f32_16x16x32_bf16 v[80:83], v[184:187], v[16:19], 0
    v_mfma_f32_16x16x32_bf16 v[84:87], v[188:191], v[16:19], 0
    v_mfma_f32_16x16x32_bf16 v[88:91], v[192:195], v[16:19], 0
    buffer_load_dwordx4 v[16:19], v1, s[4:7], s34 offen offset:0 sc1
    s_waitcnt vmcnt(11)
    v_mfma_f32_16x16x32_bf16 v[72:75], v[196:199], v[20:23], v[72:75]
    v_mfma_f32_16x16x32_bf16 v[76:79], v[200:203], v[20:23], v[76:79]
    v_mfma_f32_16x16x32_bf16 v[80:83], v[204:207], v[20:23], v[80:83]
    v_mfma_f32_16x16x32_bf16 v[84:87], v[208:211], v[20:23], v[84:87]
    v_mfma_f32_16x16x32_bf16 v[88:91], v[212:215], v[20:23], v[88:91]
    buffer_load_dwordx4 v[20:23], v1, s[4:7], s34 offen offset:1024 sc1
    s_waitcnt vmcnt(11)
    v_mfma_f32_16x16x32_bf16 v[72:75], v[216:219], v[24:27], v[72:75]
    v_mfma_f32_16x16x32_bf16 v[76:79], v[220:223], v[24:27], v[76:79]
    v_mfma_f32_16x16x32_bf16 v[80:83], v[224:227], v[24:27], v[80:83]
    v_mfma_f32_16x16x32_bf16 v[84:87], v[228:231], v[24:27], v[84:87]
    v_mfma_f32_16x16x32_bf16 v[88:91], v[232:235], v[24:27], v[88:91]
    buffer_load_dwordx4 v[24:27], v1, s[4:7], s34 offen offset:2048 sc1
    s_waitcnt vmcnt(11)
    v_mfma_f32_16x16x32_bf16 v[72:75], v[236:239], v[28:31], v[72:75]
    v_mfma_f32_16x16x32_bf16 v[76:79], v[240:243], v[28:31], v[76:79]
    v_mfma_f32_16x16x32_bf16 v[80:83], v[244:247], v[28:31], v[80:83]
    v_mfma_f32_16x16x32_bf16 v[84:87], v[248:251], v[28:31], v[84:87]
    v_mfma_f32_16x16x32_bf16 v[88:91], v[252:255], v[28:31], v[88:91]
    buffer_load_dwordx4 v[28:31], v1, s[4:7], s34 offen offset:3072 sc1
    s_waitcnt vmcnt(11)
    v_mfma_f32_16x16x32_bf16 v[72:75], v[152:155], v[32:35], v[72:75]
    v_mfma_f32_16x16x32_bf16 v[76:79], v[156:159], v[32:35], v[76:79]
    v_mfma_f32_16x16x32_bf16 v[80:83], v[160:163], v[32:35], v[80:83]
    v_mfma_f32_16x16x32_bf16 v[84:87], v[164:167], v[32:35], v[84:87]
    v_mfma_f32_16x16x32_bf16 v[88:91], v[168:171], v[32:35], v[88:91]
    buffer_load_dwordx4 v[32:35], v172, s[4:7], s34 offen offset:0 sc1
    s_waitcnt vmcnt(11)
    v_mfma_f32_16x16x32_bf16 v[72:75], v[112:115], v[36:39], v[72:75]
    v_mfma_f32_16x16x32_bf16 v[76:79], v[116:119], v[36:39], v[76:79]
    v_mfma_f32_16x16x32_bf16 v[80:83], v[120:123], v[36:39], v[80:83]
    v_mfma_f32_16x16x32_bf16 v[84:87], v[124:127], v[36:39], v[84:87]
    v_mfma_f32_16x16x32_bf16 v[88:91], v[128:131], v[36:39], v[88:91]
    buffer_load_dwordx4 v[36:39], v172, s[4:7], s34 offen offset:1024 sc1
    s_nop 3
    ds_write_b128 v0, v[72:75] offset:0
    ds_write_b128 v0, v[76:79] offset:64
    ds_write_b128 v0, v[80:83] offset:128
    ds_write_b128 v0, v[84:87] offset:192
    ds_write_b128 v0, v[88:91] offset:256
    v_xor_b32 v0, 0x10000, v0
    s_waitcnt vmcnt(11)
    v_mfma_f32_16x16x32_bf16 v[92:95], v[176:179], v[44:47], 0
    v_mfma_f32_16x16x32_bf16 v[96:99], v[180:183], v[44:47], 0
    v_mfma_f32_16x16x32_bf16 v[100:103], v[184:187], v[44:47], 0
    v_mfma_f32_16x16x32_bf16 v[104:107], v[188:191], v[44:47], 0
    v_mfma_f32_16x16x32_bf16 v[108:111], v[192:195], v[44:47], 0
    buffer_load_dwordx4 v[44:47], v1, s[4:7], s35 offen offset:0 sc1
    s_waitcnt vmcnt(11)
    v_mfma_f32_16x16x32_bf16 v[92:95], v[196:199], v[48:51], v[92:95]
    v_mfma_f32_16x16x32_bf16 v[96:99], v[200:203], v[48:51], v[96:99]
    v_mfma_f32_16x16x32_bf16 v[100:103], v[204:207], v[48:51], v[100:103]
    v_mfma_f32_16x16x32_bf16 v[104:107], v[208:211], v[48:51], v[104:107]
    v_mfma_f32_16x16x32_bf16 v[108:111], v[212:215], v[48:51], v[108:111]
    buffer_load_dwordx4 v[48:51], v1, s[4:7], s35 offen offset:1024 sc1
    s_waitcnt lgkmcnt(0)
    s_barrier
    ds_read_b128 v[132:135], v2 offset:16128
    ds_read_b128 v[136:139], v2 offset:21504
    ds_read_b128 v[140:143], v2 offset:26880
    ds_read_b128 v[144:147], v2 offset:32256
    ds_read_b128 v[148:151], v2 offset:37632
    ds_read_b128 v[40:43], v2 offset:0
    ds_read_b128 v[68:71], v2 offset:5376
    ds_read_b128 v[12:15], v2 offset:10752
    v_xor_b32 v2, 0x10000, v2
    s_waitcnt vmcnt(11)
    v_mfma_f32_16x16x32_bf16 v[92:95], v[216:219], v[52:55], v[92:95]
    v_mfma_f32_16x16x32_bf16 v[96:99], v[220:223], v[52:55], v[96:99]
    v_mfma_f32_16x16x32_bf16 v[100:103], v[224:227], v[52:55], v[100:103]
    v_mfma_f32_16x16x32_bf16 v[104:107], v[228:231], v[52:55], v[104:107]
    v_mfma_f32_16x16x32_bf16 v[108:111], v[232:235], v[52:55], v[108:111]
    buffer_load_dwordx4 v[52:55], v1, s[4:7], s35 offen offset:2048 sc1
    s_waitcnt vmcnt(11)
    v_mfma_f32_16x16x32_bf16 v[92:95], v[236:239], v[56:59], v[92:95]
    v_mfma_f32_16x16x32_bf16 v[96:99], v[240:243], v[56:59], v[96:99]
    v_mfma_f32_16x16x32_bf16 v[100:103], v[244:247], v[56:59], v[100:103]
    v_mfma_f32_16x16x32_bf16 v[104:107], v[248:251], v[56:59], v[104:107]
    v_mfma_f32_16x16x32_bf16 v[108:111], v[252:255], v[56:59], v[108:111]
    buffer_load_dwordx4 v[56:59], v1, s[4:7], s35 offen offset:3072 sc1
    s_waitcnt vmcnt(11)
    v_mfma_f32_16x16x32_bf16 v[92:95], v[152:155], v[60:63], v[92:95]
    s_waitcnt lgkmcnt(0)
    v_add_f32 v132, v136, v132
    v_add_f32 v133, v137, v133
    v_mfma_f32_16x16x32_bf16 v[96:99], v[156:159], v[60:63], v[96:99]
    v_add_f32 v134, v138, v134
    v_add_f32 v135, v139, v135
    v_add_f32 v140, v144, v140
    v_mfma_f32_16x16x32_bf16 v[100:103], v[160:163], v[60:63], v[100:103]
    v_add_f32 v141, v145, v141
    v_add_f32 v142, v146, v142
    v_add_f32 v143, v147, v143
    v_mfma_f32_16x16x32_bf16 v[104:107], v[164:167], v[60:63], v[104:107]
    v_add_f32 v132, v148, v132
    v_add_f32 v133, v149, v133
    v_add_f32 v134, v150, v134
    v_mfma_f32_16x16x32_bf16 v[108:111], v[168:171], v[60:63], v[108:111]
    v_add_f32 v135, v151, v135
    v_add_f32 v132, v140, v132
    v_add_f32 v133, v141, v133
    buffer_load_dwordx4 v[60:63], v172, s[4:7], s35 offen offset:0 sc1
    s_waitcnt vmcnt(11)
    v_mfma_f32_16x16x32_bf16 v[92:95], v[112:115], v[64:67], v[92:95]
    v_add_f32 v134, v142, v134
    v_add_f32 v135, v143, v135
    v_mul_f32 v136, s54, v132
    v_mfma_f32_16x16x32_bf16 v[96:99], v[116:119], v[64:67], v[96:99]
    v_mul_f32 v137, s54, v133
    v_mul_f32 v138, s54, v134
    v_mul_f32 v139, s54, v135
    v_mfma_f32_16x16x32_bf16 v[100:103], v[120:123], v[64:67], v[100:103]
    v_exp_f32 v136, v136
    v_exp_f32 v137, v137
    v_exp_f32 v138, v138
    v_mfma_f32_16x16x32_bf16 v[104:107], v[124:127], v[64:67], v[104:107]
    v_exp_f32 v139, v139
    v_lshlrev_b32 v148, 16, v4
    v_lshlrev_b32 v150, 16, v5
    v_mfma_f32_16x16x32_bf16 v[108:111], v[128:131], v[64:67], v[108:111]
    v_add_f32 v136, s56, v136
    v_add_f32 v137, s56, v137
    v_add_f32 v138, s56, v138
    buffer_load_dwordx4 v[64:67], v172, s[4:7], s35 offen offset:1024 sc1
    v_add_f32 v139, s56, v139
    v_rcp_f32 v136, v136
    v_rcp_f32 v137, v137
    v_rcp_f32 v138, v138
    ds_write_b128 v0, v[92:95] offset:0
    ds_write_b128 v0, v[96:99] offset:64
    ds_write_b128 v0, v[100:103] offset:128
    ds_write_b128 v0, v[104:107] offset:192
    ds_write_b128 v0, v[108:111] offset:256
    v_xor_b32 v0, 0x10000, v0
    s_waitcnt vmcnt(11)
    v_mfma_f32_16x16x32_bf16 v[72:75], v[176:179], v[16:19], 0
    v_rcp_f32 v139, v139
    v_and_b32 v149, 0xffff0000, v4
    v_and_b32 v151, 0xffff0000, v5
    v_mfma_f32_16x16x32_bf16 v[76:79], v[180:183], v[16:19], 0
    v_add_f32 v40, v68, v40
    v_add_f32 v41, v69, v41
    v_add_f32 v42, v70, v42
    v_mfma_f32_16x16x32_bf16 v[80:83], v[184:187], v[16:19], 0
    v_add_f32 v43, v71, v43
    v_mul_f32 v132, v136, v132
    v_mul_f32 v133, v137, v133
    v_mfma_f32_16x16x32_bf16 v[84:87], v[188:191], v[16:19], 0
    v_mul_f32 v134, v138, v134
    v_mul_f32 v135, v139, v135
    v_add_f32 v40, v12, v40
    v_mfma_f32_16x16x32_bf16 v[88:91], v[192:195], v[16:19], 0
    v_add_f32 v41, v13, v41
    v_add_f32 v42, v14, v42
    v_add_f32 v43, v15, v43
    s_waitcnt vmcnt(10)
    v_mfma_f32_16x16x32_bf16 v[72:75], v[196:199], v[20:23], v[72:75]
    v_fma_f32 v132, v40, v132, v148
    v_fma_f32 v133, v41, v133, v149
    v_fma_f32 v134, v42, v134, v150
    v_mfma_f32_16x16x32_bf16 v[76:79], v[200:203], v[20:23], v[76:79]
    v_fma_f32 v135, v43, v135, v151
    v_cvt_pk_bf16_f32 v132, v132, v133
    v_cvt_pk_bf16_f32 v133, v134, v135
    v_mfma_f32_16x16x32_bf16 v[80:83], v[204:207], v[20:23], v[80:83]
    buffer_store_dwordx2 v[132:133], v3, s[60:63], s36 offen
    v_mfma_f32_16x16x32_bf16 v[84:87], v[208:211], v[20:23], v[84:87]
    v_mfma_f32_16x16x32_bf16 v[88:91], v[212:215], v[20:23], v[88:91]
    s_waitcnt lgkmcnt(0)
    s_barrier
    ds_read_b128 v[132:135], v2 offset:16128
    ds_read_b128 v[136:139], v2 offset:21504
    ds_read_b128 v[140:143], v2 offset:26880
    ds_read_b128 v[144:147], v2 offset:32256
    ds_read_b128 v[148:151], v2 offset:37632
    ds_read_b128 v[40:43], v2 offset:0
    ds_read_b128 v[68:71], v2 offset:5376
    ds_read_b128 v[12:15], v2 offset:10752
    v_xor_b32 v2, 0x10000, v2
    s_waitcnt vmcnt(10)
    v_mfma_f32_16x16x32_bf16 v[72:75], v[216:219], v[24:27], v[72:75]
    v_mfma_f32_16x16x32_bf16 v[76:79], v[220:223], v[24:27], v[76:79]
    v_mfma_f32_16x16x32_bf16 v[80:83], v[224:227], v[24:27], v[80:83]
    v_mfma_f32_16x16x32_bf16 v[84:87], v[228:231], v[24:27], v[84:87]
    v_mfma_f32_16x16x32_bf16 v[88:91], v[232:235], v[24:27], v[88:91]
    s_waitcnt vmcnt(9)
    v_mfma_f32_16x16x32_bf16 v[72:75], v[236:239], v[28:31], v[72:75]
    v_mfma_f32_16x16x32_bf16 v[76:79], v[240:243], v[28:31], v[76:79]
    v_mfma_f32_16x16x32_bf16 v[80:83], v[244:247], v[28:31], v[80:83]
    v_mfma_f32_16x16x32_bf16 v[84:87], v[248:251], v[28:31], v[84:87]
    v_mfma_f32_16x16x32_bf16 v[88:91], v[252:255], v[28:31], v[88:91]
    s_waitcnt vmcnt(8)
    v_mfma_f32_16x16x32_bf16 v[72:75], v[152:155], v[32:35], v[72:75]
    s_waitcnt lgkmcnt(0)
    v_add_f32 v132, v136, v132
    v_add_f32 v133, v137, v133
    v_mfma_f32_16x16x32_bf16 v[76:79], v[156:159], v[32:35], v[76:79]
    v_add_f32 v134, v138, v134
    v_add_f32 v135, v139, v135
    v_add_f32 v140, v144, v140
    v_mfma_f32_16x16x32_bf16 v[80:83], v[160:163], v[32:35], v[80:83]
    v_add_f32 v141, v145, v141
    v_add_f32 v142, v146, v142
    v_add_f32 v143, v147, v143
    v_mfma_f32_16x16x32_bf16 v[84:87], v[164:167], v[32:35], v[84:87]
    v_add_f32 v132, v148, v132
    v_add_f32 v133, v149, v133
    v_add_f32 v134, v150, v134
    v_mfma_f32_16x16x32_bf16 v[88:91], v[168:171], v[32:35], v[88:91]
    v_add_f32 v135, v151, v135
    v_add_f32 v132, v140, v132
    v_add_f32 v133, v141, v133
    s_waitcnt vmcnt(7)
    v_mfma_f32_16x16x32_bf16 v[72:75], v[112:115], v[36:39], v[72:75]
    v_add_f32 v134, v142, v134
    v_add_f32 v135, v143, v135
    v_mul_f32 v136, s54, v132
    v_mfma_f32_16x16x32_bf16 v[76:79], v[116:119], v[36:39], v[76:79]
    v_mul_f32 v137, s54, v133
    v_mul_f32 v138, s54, v134
    v_mul_f32 v139, s54, v135
    v_mfma_f32_16x16x32_bf16 v[80:83], v[120:123], v[36:39], v[80:83]
    v_exp_f32 v136, v136
    v_exp_f32 v137, v137
    v_exp_f32 v138, v138
    v_mfma_f32_16x16x32_bf16 v[84:87], v[124:127], v[36:39], v[84:87]
    v_exp_f32 v139, v139
    v_lshlrev_b32 v148, 16, v6
    v_lshlrev_b32 v150, 16, v7
    v_mfma_f32_16x16x32_bf16 v[88:91], v[128:131], v[36:39], v[88:91]
    v_add_f32 v136, s56, v136
    v_add_f32 v137, s56, v137
    v_add_f32 v138, s56, v138
    v_add_f32 v139, s56, v139
    v_rcp_f32 v136, v136
    v_rcp_f32 v137, v137
    v_rcp_f32 v138, v138
    ds_write_b128 v0, v[72:75] offset:0
    ds_write_b128 v0, v[76:79] offset:64
    ds_write_b128 v0, v[80:83] offset:128
    ds_write_b128 v0, v[84:87] offset:192
    ds_write_b128 v0, v[88:91] offset:256
    v_xor_b32 v0, 0x10000, v0
    s_waitcnt vmcnt(6)
    v_mfma_f32_16x16x32_bf16 v[92:95], v[176:179], v[44:47], 0
    v_rcp_f32 v139, v139
    v_and_b32 v149, 0xffff0000, v6
    v_and_b32 v151, 0xffff0000, v7
    v_mfma_f32_16x16x32_bf16 v[96:99], v[180:183], v[44:47], 0
    v_add_f32 v40, v68, v40
    v_add_f32 v41, v69, v41
    v_add_f32 v42, v70, v42
    v_mfma_f32_16x16x32_bf16 v[100:103], v[184:187], v[44:47], 0
    v_add_f32 v43, v71, v43
    v_mul_f32 v132, v136, v132
    v_mul_f32 v133, v137, v133
    v_mfma_f32_16x16x32_bf16 v[104:107], v[188:191], v[44:47], 0
    v_mul_f32 v134, v138, v134
    v_mul_f32 v135, v139, v135
    v_add_f32 v40, v12, v40
    v_mfma_f32_16x16x32_bf16 v[108:111], v[192:195], v[44:47], 0
    v_add_f32 v41, v13, v41
    v_add_f32 v42, v14, v42
    v_add_f32 v43, v15, v43
    s_waitcnt vmcnt(5)
    v_mfma_f32_16x16x32_bf16 v[92:95], v[196:199], v[48:51], v[92:95]
    v_fma_f32 v132, v40, v132, v148
    v_fma_f32 v133, v41, v133, v149
    v_fma_f32 v134, v42, v134, v150
    v_mfma_f32_16x16x32_bf16 v[96:99], v[200:203], v[48:51], v[96:99]
    v_fma_f32 v135, v43, v135, v151
    v_cvt_pk_bf16_f32 v132, v132, v133
    v_cvt_pk_bf16_f32 v133, v134, v135
    v_mfma_f32_16x16x32_bf16 v[100:103], v[204:207], v[48:51], v[100:103]
    buffer_store_dwordx2 v[132:133], v3, s[60:63], s37 offen
    v_mfma_f32_16x16x32_bf16 v[104:107], v[208:211], v[48:51], v[104:107]
    v_mfma_f32_16x16x32_bf16 v[108:111], v[212:215], v[48:51], v[108:111]
    s_waitcnt lgkmcnt(0)
    s_barrier
    ds_read_b128 v[132:135], v2 offset:16128
    ds_read_b128 v[136:139], v2 offset:21504
    ds_read_b128 v[140:143], v2 offset:26880
    ds_read_b128 v[144:147], v2 offset:32256
    ds_read_b128 v[148:151], v2 offset:37632
    ds_read_b128 v[40:43], v2 offset:0
    ds_read_b128 v[68:71], v2 offset:5376
    ds_read_b128 v[12:15], v2 offset:10752
    v_xor_b32 v2, 0x10000, v2
    s_waitcnt vmcnt(5)
    v_mfma_f32_16x16x32_bf16 v[92:95], v[216:219], v[52:55], v[92:95]
    v_mfma_f32_16x16x32_bf16 v[96:99], v[220:223], v[52:55], v[96:99]
    v_mfma_f32_16x16x32_bf16 v[100:103], v[224:227], v[52:55], v[100:103]
    v_mfma_f32_16x16x32_bf16 v[104:107], v[228:231], v[52:55], v[104:107]
    v_mfma_f32_16x16x32_bf16 v[108:111], v[232:235], v[52:55], v[108:111]
    s_waitcnt vmcnt(4)
    v_mfma_f32_16x16x32_bf16 v[92:95], v[236:239], v[56:59], v[92:95]
    v_mfma_f32_16x16x32_bf16 v[96:99], v[240:243], v[56:59], v[96:99]
    v_mfma_f32_16x16x32_bf16 v[100:103], v[244:247], v[56:59], v[100:103]
    v_mfma_f32_16x16x32_bf16 v[104:107], v[248:251], v[56:59], v[104:107]
    v_mfma_f32_16x16x32_bf16 v[108:111], v[252:255], v[56:59], v[108:111]
    s_waitcnt vmcnt(3)
    v_mfma_f32_16x16x32_bf16 v[92:95], v[152:155], v[60:63], v[92:95]
    s_waitcnt lgkmcnt(0)
    v_add_f32 v132, v136, v132
    v_add_f32 v133, v137, v133
    v_mfma_f32_16x16x32_bf16 v[96:99], v[156:159], v[60:63], v[96:99]
    v_add_f32 v134, v138, v134
    v_add_f32 v135, v139, v135
    v_add_f32 v140, v144, v140
    v_mfma_f32_16x16x32_bf16 v[100:103], v[160:163], v[60:63], v[100:103]
    v_add_f32 v141, v145, v141
    v_add_f32 v142, v146, v142
    v_add_f32 v143, v147, v143
    v_mfma_f32_16x16x32_bf16 v[104:107], v[164:167], v[60:63], v[104:107]
    v_add_f32 v132, v148, v132
    v_add_f32 v133, v149, v133
    v_add_f32 v134, v150, v134
    v_mfma_f32_16x16x32_bf16 v[108:111], v[168:171], v[60:63], v[108:111]
    v_add_f32 v135, v151, v135
    v_add_f32 v132, v140, v132
    v_add_f32 v133, v141, v133
    s_waitcnt vmcnt(2)
    v_mfma_f32_16x16x32_bf16 v[92:95], v[112:115], v[64:67], v[92:95]
    v_add_f32 v134, v142, v134
    v_add_f32 v135, v143, v135
    v_mul_f32 v136, s54, v132
    v_mfma_f32_16x16x32_bf16 v[96:99], v[116:119], v[64:67], v[96:99]
    v_mul_f32 v137, s54, v133
    v_mul_f32 v138, s54, v134
    v_mul_f32 v139, s54, v135
    v_mfma_f32_16x16x32_bf16 v[100:103], v[120:123], v[64:67], v[100:103]
    v_exp_f32 v136, v136
    v_exp_f32 v137, v137
    v_exp_f32 v138, v138
    v_mfma_f32_16x16x32_bf16 v[104:107], v[124:127], v[64:67], v[104:107]
    v_exp_f32 v139, v139
    v_lshlrev_b32 v148, 16, v8
    v_lshlrev_b32 v150, 16, v9
    v_mfma_f32_16x16x32_bf16 v[108:111], v[128:131], v[64:67], v[108:111]
    v_add_f32 v136, s56, v136
    v_add_f32 v137, s56, v137
    v_add_f32 v138, s56, v138
    v_add_f32 v139, s56, v139
    v_rcp_f32 v136, v136
    v_rcp_f32 v137, v137
    v_rcp_f32 v138, v138
    ds_write_b128 v0, v[92:95] offset:0
    ds_write_b128 v0, v[96:99] offset:64
    ds_write_b128 v0, v[100:103] offset:128
    ds_write_b128 v0, v[104:107] offset:192
    ds_write_b128 v0, v[108:111] offset:256
    v_xor_b32 v0, 0x10000, v0
    v_rcp_f32 v139, v139
    v_and_b32 v149, 0xffff0000, v8
    v_and_b32 v151, 0xffff0000, v9
    v_add_f32 v40, v68, v40
    v_add_f32 v41, v69, v41
    v_add_f32 v42, v70, v42
    v_add_f32 v43, v71, v43
    v_mul_f32 v132, v136, v132
    v_mul_f32 v133, v137, v133
    v_mul_f32 v134, v138, v134
    v_mul_f32 v135, v139, v135
    v_add_f32 v40, v12, v40
    v_add_f32 v41, v13, v41
    v_add_f32 v42, v14, v42
    v_add_f32 v43, v15, v43
    v_fma_f32 v132, v40, v132, v148
    v_fma_f32 v133, v41, v133, v149
    v_fma_f32 v134, v42, v134, v150
    v_fma_f32 v135, v43, v135, v151
    v_cvt_pk_bf16_f32 v132, v132, v133
    v_cvt_pk_bf16_f32 v133, v134, v135
    buffer_store_dwordx2 v[132:133], v3, s[60:63], s38 offen
    s_waitcnt lgkmcnt(0)
    s_barrier
    ds_read_b128 v[132:135], v2 offset:16128
    ds_read_b128 v[136:139], v2 offset:21504
    ds_read_b128 v[140:143], v2 offset:26880
    ds_read_b128 v[144:147], v2 offset:32256
    ds_read_b128 v[148:151], v2 offset:37632
    ds_read_b128 v[40:43], v2 offset:0
    ds_read_b128 v[68:71], v2 offset:5376
    ds_read_b128 v[12:15], v2 offset:10752
    v_xor_b32 v2, 0x10000, v2
    s_waitcnt lgkmcnt(6)
    v_pk_add_f32 v[132:133], v[132:133], v[136:137]
    v_pk_add_f32 v[134:135], v[134:135], v[138:139]
    s_waitcnt lgkmcnt(4)
    v_pk_add_f32 v[140:141], v[140:141], v[144:145]
    v_pk_add_f32 v[142:143], v[142:143], v[146:147]
    s_waitcnt lgkmcnt(3)
    v_pk_add_f32 v[132:133], v[132:133], v[148:149]
    v_pk_add_f32 v[134:135], v[134:135], v[150:151]
    v_pk_add_f32 v[132:133], v[132:133], v[140:141]
    v_pk_add_f32 v[134:135], v[134:135], v[142:143]
    v_pk_mul_f32 v[136:137], v[132:133], s[54:55]
    v_pk_mul_f32 v[138:139], v[134:135], s[54:55]
    v_exp_f32 v136, v136
    v_exp_f32 v137, v137
    v_exp_f32 v138, v138
    v_exp_f32 v139, v139
    v_lshlrev_b32 v148, 16, v10
    v_lshlrev_b32 v150, 16, v11
    v_pk_add_f32 v[136:137], v[136:137], s[56:57]
    v_pk_add_f32 v[138:139], v[138:139], s[56:57]
    v_rcp_f32 v136, v136
    v_rcp_f32 v137, v137
    v_rcp_f32 v138, v138
    v_rcp_f32 v139, v139
    v_and_b32 v149, 0xffff0000, v10
    v_and_b32 v151, 0xffff0000, v11
    s_waitcnt lgkmcnt(0)
    v_pk_add_f32 v[40:41], v[40:41], v[68:69]
    v_pk_add_f32 v[42:43], v[42:43], v[70:71]
    v_pk_mul_f32 v[132:133], v[132:133], v[136:137]
    v_pk_mul_f32 v[134:135], v[134:135], v[138:139]
    v_pk_add_f32 v[40:41], v[40:41], v[12:13]
    v_pk_add_f32 v[42:43], v[42:43], v[14:15]
    v_pk_fma_f32 v[132:133], v[132:133], v[40:41], v[148:149]
    v_pk_fma_f32 v[134:135], v[134:135], v[42:43], v[150:151]
    v_cvt_pk_bf16_f32 v132, v132, v133
    v_cvt_pk_bf16_f32 v133, v134, v135
    buffer_store_dwordx2 v[132:133], v3, s[60:63], s39 offen
    s_branch k2_fin
k2_t51:
    buffer_load_dwordx2 v[4:5], v3, s[16:19], s36 offen
    buffer_load_dwordx2 v[6:7], v3, s[16:19], s37 offen
    buffer_load_dwordx2 v[8:9], v3, s[16:19], s38 offen
    buffer_load_dwordx2 v[10:11], v3, s[16:19], s39 offen
    s_mov_b64 exec, s[52:53]
k2_p51:
    buffer_load_dword v14, v13, s[4:7], s30 offen sc1
    s_sub_u32 s45, s45, 1
    s_cbranch_scc1 k2_p51x
    s_waitcnt vmcnt(0)
    v_cmp_eq_u32 vcc, 0, v14
    s_and_b64 exec, exec, vcc
    s_cbranch_vccnz k2_p51
k2_p51x:
    s_mov_b64 exec, -1
    s_waitcnt lgkmcnt(0)
    buffer_load_dwordx4 v[16:19], v1, s[4:7], s32 offen offset:0 sc1
    buffer_load_dwordx4 v[20:23], v1, s[4:7], s32 offen offset:1024 sc1
    buffer_load_dwordx4 v[24:27], v1, s[4:7], s32 offen offset:2048 sc1
    buffer_load_dwordx4 v[28:31], v1, s[4:7], s32 offen offset:3072 sc1
    buffer_load_dwordx4 v[32:35], v172, s[4:7], s32 offen offset:0 sc1
    buffer_load_dwordx4 v[44:47], v1, s[4:7], s33 offen offset:0 sc1
    buffer_load_dwordx4 v[48:51], v1, s[4:7], s33 offen offset:1024 sc1
    buffer_load_dwordx4 v[52:55], v1, s[4:7], s33 offen offset:2048 sc1
    buffer_load_dwordx4 v[56:59], v1, s[4:7], s33 offen offset:3072 sc1
    buffer_load_dwordx4 v[60:63], v172, s[4:7], s33 offen offset:0 sc1
    s_waitcnt vmcnt(9)
    v_mfma_f32_16x16x32_bf16 v[72:75], v[176:179], v[16:19], 0
    v_mfma_f32_16x16x32_bf16 v[76:79], v[180:183], v[16:19], 0
    v_mfma_f32_16x16x32_bf16 v[80:83], v[184:187], v[16:19], 0
    v_mfma_f32_16x16x32_bf16 v[84:87], v[188:191], v[16:19], 0
    v_mfma_f32_16x16x32_bf16 v[88:91], v[192:195], v[16:19], 0
    buffer_load_dwordx4 v[16:19], v1, s[4:7], s34 offen offset:0 sc1
    s_waitcnt vmcnt(9)
    v_mfma_f32_16x16x32_bf16 v[72:75], v[196:199], v[20:23], v[72:75]
    v_mfma_f32_16x16x32_bf16 v[76:79], v[200:203], v[20:23], v[76:79]
    v_mfma_f32_16x16x32_bf16 v[80:83], v[204:207], v[20:23], v[80:83]
    v_mfma_f32_16x16x32_bf16 v[84:87], v[208:211], v[20:23], v[84:87]
    v_mfma_f32_16x16x32_bf16 v[88:91], v[212:215], v[20:23], v[88:91]
    buffer_load_dwordx4 v[20:23], v1, s[4:7], s34 offen offset:1024 sc1
    s_waitcnt vmcnt(9)
    v_mfma_f32_16x16x32_bf16 v[72:75], v[216:219], v[24:27], v[72:75]
    v_mfma_f32_16x16x32_bf16 v[76:79], v[220:223], v[24:27], v[76:79]
    v_mfma_f32_16x16x32_bf16 v[80:83], v[224:227], v[24:27], v[80:83]
    v_mfma_f32_16x16x32_bf16 v[84:87], v[228:231], v[24:27], v[84:87]
    v_mfma_f32_16x16x32_bf16 v[88:91], v[232:235], v[24:27], v[88:91]
    buffer_load_dwordx4 v[24:27], v1, s[4:7], s34 offen offset:2048 sc1
    s_waitcnt vmcnt(9)
    v_mfma_f32_16x16x32_bf16 v[72:75], v[236:239], v[28:31], v[72:75]
    v_mfma_f32_16x16x32_bf16 v[76:79], v[240:243], v[28:31], v[76:79]
    v_mfma_f32_16x16x32_bf16 v[80:83], v[244:247], v[28:31], v[80:83]
    v_mfma_f32_16x16x32_bf16 v[84:87], v[248:251], v[28:31], v[84:87]
    v_mfma_f32_16x16x32_bf16 v[88:91], v[252:255], v[28:31], v[88:91]
    buffer_load_dwordx4 v[28:31], v1, s[4:7], s34 offen offset:3072 sc1
    s_waitcnt vmcnt(9)
    v_mfma_f32_16x16x32_bf16 v[72:75], v[152:155], v[32:35], v[72:75]
    v_mfma_f32_16x16x32_bf16 v[76:79], v[156:159], v[32:35], v[76:79]
    v_mfma_f32_16x16x32_bf16 v[80:83], v[160:163], v[32:35], v[80:83]
    v_mfma_f32_16x16x32_bf16 v[84:87], v[164:167], v[32:35], v[84:87]
    v_mfma_f32_16x16x32_bf16 v[88:91], v[168:171], v[32:35], v[88:91]
    buffer_load_dwordx4 v[32:35], v172, s[4:7], s34 offen offset:0 sc1
    s_nop 3
    ds_write_b128 v0, v[72:75] offset:0
    ds_write_b128 v0, v[76:79] offset:64
    ds_write_b128 v0, v[80:83] offset:128
    ds_write_b128 v0, v[84:87] offset:192
    ds_write_b128 v0, v[88:91] offset:256
    v_xor_b32 v0, 0x10000, v0
    s_waitcnt vmcnt(9)
    v_mfma_f32_16x16x32_bf16 v[92:95], v[176:179], v[44:47], 0
    v_mfma_f32_16x16x32_bf16 v[96:99], v[180:183], v[44:47], 0
    v_mfma_f32_16x16x32_bf16 v[100:103], v[184:187], v[44:47], 0
    v_mfma_f32_16x16x32_bf16 v[104:107], v[188:191], v[44:47], 0
    v_mfma_f32_16x16x32_bf16 v[108:111], v[192:195], v[44:47], 0
    buffer_load_dwordx4 v[44:47], v1, s[4:7], s35 offen offset:0 sc1
    s_waitcnt vmcnt(9)
    v_mfma_f32_16x16x32_bf16 v[92:95], v[196:199], v[48:51], v[92:95]
    v_mfma_f32_16x16x32_bf16 v[96:99], v[200:203], v[48:51], v[96:99]
    v_mfma_f32_16x16x32_bf16 v[100:103], v[204:207], v[48:51], v[100:103]
    v_mfma_f32_16x16x32_bf16 v[104:107], v[208:211], v[48:51], v[104:107]
    v_mfma_f32_16x16x32_bf16 v[108:111], v[212:215], v[48:51], v[108:111]
    buffer_load_dwordx4 v[48:51], v1, s[4:7], s35 offen offset:1024 sc1
    s_waitcnt lgkmcnt(0)
    s_barrier
    ds_read_b128 v[132:135], v2 offset:16128
    ds_read_b128 v[136:139], v2 offset:21504
    ds_read_b128 v[140:143], v2 offset:26880
    ds_read_b128 v[144:147], v2 offset:32256
    ds_read_b128 v[148:151], v2 offset:37632
    ds_read_b128 v[40:43], v2 offset:0
    ds_read_b128 v[68:71], v2 offset:5376
    ds_read_b128 v[12:15], v2 offset:10752
    v_xor_b32 v2, 0x10000, v2
    s_waitcnt vmcnt(9)
    v_mfma_f32_16x16x32_bf16 v[92:95], v[216:219], v[52:55], v[92:95]
    v_mfma_f32_16x16x32_bf16 v[96:99], v[220:223], v[52:55], v[96:99]
    v_mfma_f32_16x16x32_bf16 v[100:103], v[224:227], v[52:55], v[100:103]
    v_mfma_f32_16x16x32_bf16 v[104:107], v[228:231], v[52:55], v[104:107]
    v_mfma_f32_16x16x32_bf16 v[108:111], v[232:235], v[52:55], v[108:111]
    buffer_load_dwordx4 v[52:55], v1, s[4:7], s35 offen offset:2048 sc1
    s_waitcnt vmcnt(9)
    v_mfma_f32_16x16x32_bf16 v[92:95], v[236:239], v[56:59], v[92:95]
    v_mfma_f32_16x16x32_bf16 v[96:99], v[240:243], v[56:59], v[96:99]
    v_mfma_f32_16x16x32_bf16 v[100:103], v[244:247], v[56:59], v[100:103]
    v_mfma_f32_16x16x32_bf16 v[104:107], v[248:251], v[56:59], v[104:107]
    v_mfma_f32_16x16x32_bf16 v[108:111], v[252:255], v[56:59], v[108:111]
    buffer_load_dwordx4 v[56:59], v1, s[4:7], s35 offen offset:3072 sc1
    s_waitcnt vmcnt(9)
    v_mfma_f32_16x16x32_bf16 v[92:95], v[152:155], v[60:63], v[92:95]
    s_waitcnt lgkmcnt(0)
    v_add_f32 v132, v136, v132
    v_add_f32 v133, v137, v133
    v_add_f32 v134, v138, v134
    v_mfma_f32_16x16x32_bf16 v[96:99], v[156:159], v[60:63], v[96:99]
    v_add_f32 v135, v139, v135
    v_add_f32 v140, v144, v140
    v_add_f32 v141, v145, v141
    v_add_f32 v142, v146, v142
    v_mfma_f32_16x16x32_bf16 v[100:103], v[160:163], v[60:63], v[100:103]
    v_add_f32 v143, v147, v143
    v_add_f32 v132, v148, v132
    v_add_f32 v133, v149, v133
    v_add_f32 v134, v150, v134
    v_mfma_f32_16x16x32_bf16 v[104:107], v[164:167], v[60:63], v[104:107]
    v_add_f32 v135, v151, v135
    v_add_f32 v132, v140, v132
    v_add_f32 v133, v141, v133
    v_add_f32 v134, v142, v134
    v_mfma_f32_16x16x32_bf16 v[108:111], v[168:171], v[60:63], v[108:111]
    v_add_f32 v135, v143, v135
    v_mul_f32 v136, s54, v132
    v_mul_f32 v137, s54, v133
    v_mul_f32 v138, s54, v134
    buffer_load_dwordx4 v[60:63], v172, s[4:7], s35 offen offset:0 sc1
    v_mul_f32 v139, s54, v135
    v_exp_f32 v136, v136
    v_exp_f32 v137, v137
    v_exp_f32 v138, v138
    ds_write_b128 v0, v[92:95] offset:0
    ds_write_b128 v0, v[96:99] offset:64
    ds_write_b128 v0, v[100:103] offset:128
    ds_write_b128 v0, v[104:107] offset:192
    ds_write_b128 v0, v[108:111] offset:256
    v_xor_b32 v0, 0x10000, v0
    s_waitcnt vmcnt(9)
    v_mfma_f32_16x16x32_bf16 v[72:75], v[176:179], v[16:19], 0
    v_exp_f32 v139, v139
    v_lshlrev_b32 v148, 16, v4
    v_lshlrev_b32 v150, 16, v5
    v_add_f32 v136, s56, v136
    v_mfma_f32_16x16x32_bf16 v[76:79], v[180:183], v[16:19], 0
    v_add_f32 v137, s56, v137
    v_add_f32 v138, s56, v138
    v_add_f32 v139, s56, v139
    v_rcp_f32 v136, v136
    v_mfma_f32_16x16x32_bf16 v[80:83], v[184:187], v[16:19], 0
    v_rcp_f32 v137, v137
    v_rcp_f32 v138, v138
    v_rcp_f32 v139, v139
    v_and_b32 v149, 0xffff0000, v4
    v_mfma_f32_16x16x32_bf16 v[84:87], v[188:191], v[16:19], 0
    v_and_b32 v151, 0xffff0000, v5
    v_add_f32 v40, v68, v40
    v_add_f32 v41, v69, v41
    v_add_f32 v42, v70, v42
    v_mfma_f32_16x16x32_bf16 v[88:91], v[192:195], v[16:19], 0
    v_add_f32 v43, v71, v43
    v_mul_f32 v132, v136, v132
    v_mul_f32 v133, v137, v133
    v_mul_f32 v134, v138, v134
    s_waitcnt vmcnt(8)
    v_mfma_f32_16x16x32_bf16 v[72:75], v[196:199], v[20:23], v[72:75]
    v_mul_f32 v135, v139, v135
    v_add_f32 v40, v12, v40
    v_add_f32 v41, v13, v41
    v_add_f32 v42, v14, v42
    v_mfma_f32_16x16x32_bf16 v[76:79], v[200:203], v[20:23], v[76:79]
    v_add_f32 v43, v15, v43
    v_fma_f32 v132, v40, v132, v148
    v_fma_f32 v133, v41, v133, v149
    v_fma_f32 v134, v42, v134, v150
    v_mfma_f32_16x16x32_bf16 v[80:83], v[204:207], v[20:23], v[80:83]
    v_fma_f32 v135, v43, v135, v151
    v_cvt_pk_bf16_f32 v132, v132, v133
    v_cvt_pk_bf16_f32 v133, v134, v135
    buffer_store_dwordx2 v[132:133], v3, s[60:63], s36 offen
    v_mfma_f32_16x16x32_bf16 v[84:87], v[208:211], v[20:23], v[84:87]
    v_mfma_f32_16x16x32_bf16 v[88:91], v[212:215], v[20:23], v[88:91]
    s_waitcnt lgkmcnt(0)
    s_barrier
    ds_read_b128 v[132:135], v2 offset:16128
    ds_read_b128 v[136:139], v2 offset:21504
    ds_read_b128 v[140:143], v2 offset:26880
    ds_read_b128 v[144:147], v2 offset:32256
    ds_read_b128 v[148:151], v2 offset:37632
    ds_read_b128 v[40:43], v2 offset:0
    ds_read_b128 v[68:71], v2 offset:5376
    ds_read_b128 v[12:15], v2 offset:10752
    v_xor_b32 v2, 0x10000, v2
    s_waitcnt vmcnt(8)
    v_mfma_f32_16x16x32_bf16 v[72:75], v[216:219], v[24:27], v[72:75]
    v_mfma_f32_16x16x32_bf16 v[76:79], v[220:223], v[24:27], v[76:79]
    v_mfma_f32_16x16x32_bf16 v[80:83], v[224:227], v[24:27], v[80:83]
    v_mfma_f32_16x16x32_bf16 v[84:87], v[228:231], v[24:27], v[84:87]
    v_mfma_f32_16x16x32_bf16 v[88:91], v[232:235], v[24:27], v[88:91]
    s_waitcnt vmcnt(7)
    v_mfma_f32_16x16x32_bf16 v[72:75], v[236:239], v[28:31], v[72:75]
    v_mfma_f32_16x16x32_bf16 v[76:79], v[240:243], v[28:31], v[76:79]
    v_mfma_f32_16x16x32_bf16 v[80:83], v[244:247], v[28:31], v[80:83]
    v_mfma_f32_16x16x32_bf16 v[84:87], v[248:251], v[28:31], v[84:87]
    v_mfma_f32_16x16x32_bf16 v[88:91], v[252:255], v[28:31], v[88:91]
    s_waitcnt vmcnt(6)
    v_mfma_f32_16x16x32_bf16 v[72:75], v[152:155], v[32:35], v[72:75]
    s_waitcnt lgkmcnt(0)
    v_add_f32 v132, v136, v132
    v_add_f32 v133, v137, v133
    v_add_f32 v134, v138, v134
    v_mfma_f32_16x16x32_bf16 v[76:79], v[156:159], v[32:35], v[76:79]
    v_add_f32 v135, v139, v135
    v_add_f32 v140, v144, v140
    v_add_f32 v141, v145, v141
    v_add_f32 v142, v146, v142
    v_mfma_f32_16x16x32_bf16 v[80:83], v[160:163], v[32:35], v[80:83]
    v_add_f32 v143, v147, v143
    v_add_f32 v132, v148, v132
    v_add_f32 v133, v149, v133
    v_add_f32 v134, v150, v134
    v_mfma_f32_16x16x32_bf16 v[84:87], v[164:167], v[32:35], v[84:87]
    v_add_f32 v135, v151, v135
    v_add_f32 v132, v140, v132
    v_add_f32 v133, v141, v133
    v_add_f32 v134, v142, v134
    v_mfma_f32_16x16x32_bf16 v[88:91], v[168:171], v[32:35], v[88:91]
    v_add_f32 v135, v143, v135
    v_mul_f32 v136, s54, v132
    v_mul_f32 v137, s54, v133
    v_mul_f32 v138, s54, v134
    v_mul_f32 v139, s54, v135
    v_exp_f32 v136, v136
    v_exp_f32 v137, v137
    v_exp_f32 v138, v138
    ds_write_b128 v0, v[72:75] offset:0
    ds_write_b128 v0, v[76:79] offset:64
    ds_write_b128 v0, v[80:83] offset:128
    ds_write_b128 v0, v[84:87] offset:192
    ds_write_b128 v0, v[88:91] offset:256
    v_xor_b32 v0, 0x10000, v0
    s_waitcnt vmcnt(5)
    v_mfma_f32_16x16x32_bf16 v[92:95], v[176:179], v[44:47], 0
    v_exp_f32 v139, v139
    v_lshlrev_b32 v148, 16, v6
    v_lshlrev_b32 v150, 16, v7
    v_add_f32 v136, s56, v136
    v_mfma_f32_16x16x32_bf16 v[96:99], v[180:183], v[44:47], 0
    v_add_f32 v137, s56, v137
    v_add_f32 v138, s56, v138
    v_add_f32 v139, s56, v139
    v_rcp_f32 v136, v136
    v_mfma_f32_16x16x32_bf16 v[100:103], v[184:187], v[44:47], 0
    v_rcp_f32 v137, v137
    v_rcp_f32 v138, v138
    v_rcp_f32 v139, v139
    v_and_b32 v149, 0xffff0000, v6
    v_mfma_f32_16x16x32_bf16 v[104:107], v[188:191], v[44:47], 0
    v_and_b32 v151, 0xffff0000, v7
    v_add_f32 v40, v68, v40
    v_add_f32 v41, v69, v41
    v_add_f32 v42, v70, v42
    v_mfma_f32_16x16x32_bf16 v[108:111], v[192:195], v[44:47], 0
    v_add_f32 v43, v71, v43
    v_mul_f32 v132, v136, v132
    v_mul_f32 v133, v137, v133
    v_mul_f32 v134, v138, v134
    s_waitcnt vmcnt(4)
    v_mfma_f32_16x16x32_bf16 v[92:95], v[196:199], v[48:51], v[92:95]
    v_mul_f32 v135, v139, v135
    v_add_f32 v40, v12, v40
    v_add_f32 v41, v13, v41
    v_add_f32 v42, v14, v42
    v_mfma_f32_16x16x32_bf16 v[96:99], v[200:203], v[48:51], v[96:99]
    v_add_f32 v43, v15, v43
    v_fma_f32 v132, v40, v132, v148
    v_fma_f32 v133, v41, v133, v149
    v_fma_f32 v134, v42, v134, v150
    v_mfma_f32_16x16x32_bf16 v[100:103], v[204:207], v[48:51], v[100:103]
    v_fma_f32 v135, v43, v135, v151
    v_cvt_pk_bf16_f32 v132, v132, v133
    v_cvt_pk_bf16_f32 v133, v134, v135
    buffer_store_dwordx2 v[132:133], v3, s[60:63], s37 offen
    v_mfma_f32_16x16x32_bf16 v[104:107], v[208:211], v[48:51], v[104:107]
    v_mfma_f32_16x16x32_bf16 v[108:111], v[212:215], v[48:51], v[108:111]
    s_waitcnt lgkmcnt(0)
    s_barrier
    ds_read_b128 v[132:135], v2 offset:16128
    ds_read_b128 v[136:139], v2 offset:21504
    ds_read_b128 v[140:143], v2 offset:26880
    ds_read_b128 v[144:147], v2 offset:32256
    ds_read_b128 v[148:151], v2 offset:37632
    ds_read_b128 v[40:43], v2 offset:0
    ds_read_b128 v[68:71], v2 offset:5376
    ds_read_b128 v[12:15], v2 offset:10752
    v_xor_b32 v2, 0x10000, v2
    s_waitcnt vmcnt(4)
    v_mfma_f32_16x16x32_bf16 v[92:95], v[216:219], v[52:55], v[92:95]
    v_mfma_f32_16x16x32_bf16 v[96:99], v[220:223], v[52:55], v[96:99]
    v_mfma_f32_16x16x32_bf16 v[100:103], v[224:227], v[52:55], v[100:103]
    v_mfma_f32_16x16x32_bf16 v[104:107], v[228:231], v[52:55], v[104:107]
    v_mfma_f32_16x16x32_bf16 v[108:111], v[232:235], v[52:55], v[108:111]
    s_waitcnt vmcnt(3)
    v_mfma_f32_16x16x32_bf16 v[92:95], v[236:239], v[56:59], v[92:95]
    v_mfma_f32_16x16x32_bf16 v[96:99], v[240:243], v[56:59], v[96:99]
    v_mfma_f32_16x16x32_bf16 v[100:103], v[244:247], v[56:59], v[100:103]
    v_mfma_f32_16x16x32_bf16 v[104:107], v[248:251], v[56:59], v[104:107]
    v_mfma_f32_16x16x32_bf16 v[108:111], v[252:255], v[56:59], v[108:111]
    s_waitcnt vmcnt(2)
    v_mfma_f32_16x16x32_bf16 v[92:95], v[152:155], v[60:63], v[92:95]
    s_waitcnt lgkmcnt(0)
    v_add_f32 v132, v136, v132
    v_add_f32 v133, v137, v133
    v_add_f32 v134, v138, v134
    v_mfma_f32_16x16x32_bf16 v[96:99], v[156:159], v[60:63], v[96:99]
    v_add_f32 v135, v139, v135
    v_add_f32 v140, v144, v140
    v_add_f32 v141, v145, v141
    v_add_f32 v142, v146, v142
    v_mfma_f32_16x16x32_bf16 v[100:103], v[160:163], v[60:63], v[100:103]
    v_add_f32 v143, v147, v143
    v_add_f32 v132, v148, v132
    v_add_f32 v133, v149, v133
    v_add_f32 v134, v150, v134
    v_mfma_f32_16x16x32_bf16 v[104:107], v[164:167], v[60:63], v[104:107]
    v_add_f32 v135, v151, v135
    v_add_f32 v132, v140, v132
    v_add_f32 v133, v141, v133
    v_add_f32 v134, v142, v134
    v_mfma_f32_16x16x32_bf16 v[108:111], v[168:171], v[60:63], v[108:111]
    v_add_f32 v135, v143, v135
    v_mul_f32 v136, s54, v132
    v_mul_f32 v137, s54, v133
    v_mul_f32 v138, s54, v134
    v_mul_f32 v139, s54, v135
    v_exp_f32 v136, v136
    v_exp_f32 v137, v137
    v_exp_f32 v138, v138
    ds_write_b128 v0, v[92:95] offset:0
    ds_write_b128 v0, v[96:99] offset:64
    ds_write_b128 v0, v[100:103] offset:128
    ds_write_b128 v0, v[104:107] offset:192
    ds_write_b128 v0, v[108:111] offset:256
    v_xor_b32 v0, 0x10000, v0
    v_exp_f32 v139, v139
    v_lshlrev_b32 v148, 16, v8
    v_lshlrev_b32 v150, 16, v9
    v_add_f32 v136, s56, v136
    v_add_f32 v137, s56, v137
    v_add_f32 v138, s56, v138
    v_add_f32 v139, s56, v139
    v_rcp_f32 v136, v136
    v_rcp_f32 v137, v137
    v_rcp_f32 v138, v138
    v_rcp_f32 v139, v139
    v_and_b32 v149, 0xffff0000, v8
    v_and_b32 v151, 0xffff0000, v9
    v_add_f32 v40, v68, v40
    v_add_f32 v41, v69, v41
    v_add_f32 v42, v70, v42
    v_add_f32 v43, v71, v43
    v_mul_f32 v132, v136, v132
    v_mul_f32 v133, v137, v133
    v_mul_f32 v134, v138, v134
    v_mul_f32 v135, v139, v135
    v_add_f32 v40, v12, v40
    v_add_f32 v41, v13, v41
    v_add_f32 v42, v14, v42
    v_add_f32 v43, v15, v43
    v_fma_f32 v132, v40, v132, v148
    v_fma_f32 v133, v41, v133, v149
    v_fma_f32 v134, v42, v134, v150
    v_fma_f32 v135, v43, v135, v151
    v_cvt_pk_bf16_f32 v132, v132, v133
    v_cvt_pk_bf16_f32 v133, v134, v135
    buffer_store_dwordx2 v[132:133], v3, s[60:63], s38 offen
    s_waitcnt lgkmcnt(0)
    s_barrier
    ds_read_b128 v[132:135], v2 offset:16128
    ds_read_b128 v[136:139], v2 offset:21504
    ds_read_b128 v[140:143], v2 offset:26880
    ds_read_b128 v[144:147], v2 offset:32256
    ds_read_b128 v[148:151], v2 offset:37632
    ds_read_b128 v[40:43], v2 offset:0
    ds_read_b128 v[68:71], v2 offset:5376
    ds_read_b128 v[12:15], v2 offset:10752
    v_xor_b32 v2, 0x10000, v2
    s_waitcnt lgkmcnt(6)
    v_pk_add_f32 v[132:133], v[132:133], v[136:137]
    v_pk_add_f32 v[134:135], v[134:135], v[138:139]
    s_waitcnt lgkmcnt(4)
    v_pk_add_f32 v[140:141], v[140:141], v[144:145]
    v_pk_add_f32 v[142:143], v[142:143], v[146:147]
    s_waitcnt lgkmcnt(3)
    v_pk_add_f32 v[132:133], v[132:133], v[148:149]
    v_pk_add_f32 v[134:135], v[134:135], v[150:151]
    v_pk_add_f32 v[132:133], v[132:133], v[140:141]
    v_pk_add_f32 v[134:135], v[134:135], v[142:143]
    v_pk_mul_f32 v[136:137], v[132:133], s[54:55]
    v_pk_mul_f32 v[138:139], v[134:135], s[54:55]
    v_exp_f32 v136, v136
    v_exp_f32 v137, v137
    v_exp_f32 v138, v138
    v_exp_f32 v139, v139
    v_lshlrev_b32 v148, 16, v10
    v_lshlrev_b32 v150, 16, v11
    v_pk_add_f32 v[136:137], v[136:137], s[56:57]
    v_pk_add_f32 v[138:139], v[138:139], s[56:57]
    v_rcp_f32 v136, v136
    v_rcp_f32 v137, v137
    v_rcp_f32 v138, v138
    v_rcp_f32 v139, v139
    v_and_b32 v149, 0xffff0000, v10
    v_and_b32 v151, 0xffff0000, v11
    s_waitcnt lgkmcnt(0)
    v_pk_add_f32 v[40:41], v[40:41], v[68:69]
    v_pk_add_f32 v[42:43], v[42:43], v[70:71]
    v_pk_mul_f32 v[132:133], v[132:133], v[136:137]
    v_pk_mul_f32 v[134:135], v[134:135], v[138:139]
    v_pk_add_f32 v[40:41], v[40:41], v[12:13]
    v_pk_add_f32 v[42:43], v[42:43], v[14:15]
    v_pk_fma_f32 v[132:133], v[132:133], v[40:41], v[148:149]
    v_pk_fma_f32 v[134:135], v[134:135], v[42:43], v[150:151]
    v_cvt_pk_bf16_f32 v132, v132, v133
    v_cvt_pk_bf16_f32 v133, v134, v135
    buffer_store_dwordx2 v[132:133], v3, s[60:63], s39 offen
    s_branch k2_fin
k2_t60:
    s_add_u32 s47, s47, 40960
    buffer_load_dwordx4 v[112:115], v1, s[4:7], s47 offen offset:0
    buffer_load_dwordx4 v[116:119], v1, s[4:7], s47 offen offset:1024
    buffer_load_dwordx4 v[120:123], v1, s[4:7], s47 offen offset:2048
    buffer_load_dwordx4 v[124:127], v1, s[4:7], s47 offen offset:3072
    buffer_load_dwordx4 v[128:131], v172, s[4:7], s47 offen offset:0
    s_mov_b64 exec, s[52:53]
k2_p60:
    buffer_load_dword v14, v13, s[4:7], s30 offen sc1
    s_sub_u32 s45, s45, 1
    s_cbranch_scc1 k2_p60x
    s_waitcnt vmcnt(0)
    v_cmp_eq_u32 vcc, 0, v14
    s_and_b64 exec, exec, vcc
    s_cbranch_vccnz k2_p60
k2_p60x:
    s_mov_b64 exec, -1
    s_waitcnt lgkmcnt(0)
    buffer_load_dwordx4 v[16:19], v1, s[4:7], s32 offen offset:0 sc1
    buffer_load_dwordx4 v[20:23], v1, s[4:7], s32 offen offset:1024 sc1
    buffer_load_dwordx4 v[24:27], v1, s[4:7], s32 offen offset:2048 sc1
    buffer_load_dwordx4 v[28:31], v1, s[4:7], s32 offen offset:3072 sc1
    buffer_load_dwordx4 v[32:35], v172, s[4:7], s32 offen offset:0 sc1
    buffer_load_dwordx4 v[36:39], v172, s[4:7], s32 offen offset:1024 sc1
    buffer_load_dwordx4 v[44:47], v1, s[4:7], s33 offen offset:0 sc1
    buffer_load_dwordx4 v[48:51], v1, s[4:7], s33 offen offset:1024 sc1
    buffer_load_dwordx4 v[52:55], v1, s[4:7], s33 offen offset:2048 sc1
    buffer_load_dwordx4 v[56:59], v1, s[4:7], s33 offen offset:3072 sc1
    buffer_load_dwordx4 v[60:63], v172, s[4:7], s33 offen offset:0 sc1
    buffer_load_dwordx4 v[64:67], v172, s[4:7], s33 offen offset:1024 sc1
    s_waitcnt vmcnt(11)
    v_mfma_f32_16x16x32_bf16 v[72:75], v[176:179], v[16:19], 0
    v_mfma_f32_16x16x32_bf16 v[76:79], v[180:183], v[16:19], 0
    v_mfma_f32_16x16x32_bf16 v[80:83], v[184:187], v[16:19], 0
    v_mfma_f32_16x16x32_bf16 v[84:87], v[188:191], v[16:19], 0
    v_mfma_f32_16x16x32_bf16 v[88:91], v[192:195], v[16:19], 0
    buffer_load_dwordx4 v[16:19], v1, s[4:7], s34 offen offset:0 sc1
    s_waitcnt vmcnt(11)
    v_mfma_f32_16x16x32_bf16 v[72:75], v[196:199], v[20:23], v[72:75]
    v_mfma_f32_16x16x32_bf16 v[76:79], v[200:203], v[20:23], v[76:79]
    v_mfma_f32_16x16x32_bf16 v[80:83], v[204:207], v[20:23], v[80:83]
    v_mfma_f32_16x16x32_bf16 v[84:87], v[208:211], v[20:23], v[84:87]
    v_mfma_f32_16x16x32_bf16 v[88:91], v[212:215], v[20:23], v[88:91]
    buffer_load_dwordx4 v[20:23], v1, s[4:7], s34 offen offset:1024 sc1
    s_waitcnt vmcnt(11)
    v_mfma_f32_16x16x32_bf16 v[72:75], v[216:219], v[24:27], v[72:75]
    v_mfma_f32_16x16x32_bf16 v[76:79], v[220:223], v[24:27], v[76:79]
    v_mfma_f32_16x16x32_bf16 v[80:83], v[224:227], v[24:27], v[80:83]
    v_mfma_f32_16x16x32_bf16 v[84:87], v[228:231], v[24:27], v[84:87]
    v_mfma_f32_16x16x32_bf16 v[88:91], v[232:235], v[24:27], v[88:91]
    buffer_load_dwordx4 v[24:27], v1, s[4:7], s34 offen offset:2048 sc1
    s_waitcnt vmcnt(11)
    v_mfma_f32_16x16x32_bf16 v[72:75], v[236:239], v[28:31], v[72:75]
    v_mfma_f32_16x16x32_bf16 v[76:79], v[240:243], v[28:31], v[76:79]
    v_mfma_f32_16x16x32_bf16 v[80:83], v[244:247], v[28:31], v[80:83]
    v_mfma_f32_16x16x32_bf16 v[84:87], v[248:251], v[28:31], v[84:87]
    v_mfma_f32_16x16x32_bf16 v[88:91], v[252:255], v[28:31], v[88:91]
    buffer_load_dwordx4 v[28:31], v1, s[4:7], s34 offen offset:3072 sc1
    s_waitcnt vmcnt(11)
    v_mfma_f32_16x16x32_bf16 v[72:75], v[152:155], v[32:35], v[72:75]
    v_mfma_f32_16x16x32_bf16 v[76:79], v[156:159], v[32:35], v[76:79]
    v_mfma_f32_16x16x32_bf16 v[80:83], v[160:163], v[32:35], v[80:83]
    v_mfma_f32_16x16x32_bf16 v[84:87], v[164:167], v[32:35], v[84:87]
    v_mfma_f32_16x16x32_bf16 v[88:91], v[168:171], v[32:35], v[88:91]
    buffer_load_dwordx4 v[32:35], v172, s[4:7], s34 offen offset:0 sc1
    s_waitcnt vmcnt(11)
    v_mfma_f32_16x16x32_bf16 v[72:75], v[112:115], v[36:39], v[72:75]
    v_mfma_f32_16x16x32_bf16 v[76:79], v[116:119], v[36:39], v[76:79]
    v_mfma_f32_16x16x32_bf16 v[80:83], v[120:123], v[36:39], v[80:83]
    v_mfma_f32_16x16x32_bf16 v[84:87], v[124:127], v[36:39], v[84:87]
    v_mfma_f32_16x16x32_bf16 v[88:91], v[128:131], v[36:39], v[88:91]
    buffer_load_dwordx4 v[36:39], v172, s[4:7], s34 offen offset:1024 sc1
    s_nop 3
    ds_write_b128 v0, v[72:75] offset:0
    ds_write_b128 v0, v[76:79] offset:64
    ds_write_b128 v0, v[80:83] offset:128
    ds_write_b128 v0, v[84:87] offset:192
    ds_write_b128 v0, v[88:91] offset:256
    v_xor_b32 v0, 0x10000, v0
    s_waitcnt vmcnt(11)
    v_mfma_f32_16x16x32_bf16 v[92:95], v[176:179], v[44:47], 0
    v_mfma_f32_16x16x32_bf16 v[96:99], v[180:183], v[44:47], 0
    v_mfma_f32_16x16x32_bf16 v[100:103], v[184:187], v[44:47], 0
    v_mfma_f32_16x16x32_bf16 v[104:107], v[188:191], v[44:47], 0
    v_mfma_f32_16x16x32_bf16 v[108:111], v[192:195], v[44:47], 0
    buffer_load_dwordx4 v[44:47], v1, s[4:7], s35 offen offset:0 sc1
    s_waitcnt vmcnt(11)
    v_mfma_f32_16x16x32_bf16 v[92:95], v[196:199], v[48:51], v[92:95]
    v_mfma_f32_16x16x32_bf16 v[96:99], v[200:203], v[48:51], v[96:99]
    v_mfma_f32_16x16x32_bf16 v[100:103], v[204:207], v[48:51], v[100:103]
    v_mfma_f32_16x16x32_bf16 v[104:107], v[208:211], v[48:51], v[104:107]
    v_mfma_f32_16x16x32_bf16 v[108:111], v[212:215], v[48:51], v[108:111]
    buffer_load_dwordx4 v[48:51], v1, s[4:7], s35 offen offset:1024 sc1
    s_waitcnt lgkmcnt(0)
    s_barrier
    s_waitcnt vmcnt(11)
    v_mfma_f32_16x16x32_bf16 v[92:95], v[216:219], v[52:55], v[92:95]
    v_mfma_f32_16x16x32_bf16 v[96:99], v[220:223], v[52:55], v[96:99]
    v_mfma_f32_16x16x32_bf16 v[100:103], v[224:227], v[52:55], v[100:103]
    v_mfma_f32_16x16x32_bf16 v[104:107], v[228:231], v[52:55], v[104:107]
    v_mfma_f32_16x16x32_bf16 v[108:111], v[232:235], v[52:55], v[108:111]
    buffer_load_dwordx4 v[52:55], v1, s[4:7], s35 offen offset:2048 sc1
    s_waitcnt vmcnt(11)
    v_mfma_f32_16x16x32_bf16 v[92:95], v[236:239], v[56:59], v[92:95]
    v_mfma_f32_16x16x32_bf16 v[96:99], v[240:243], v[56:59], v[96:99]
    v_mfma_f32_16x16x32_bf16 v[100:103], v[244:247], v[56:59], v[100:103]
    v_mfma_f32_16x16x32_bf16 v[104:107], v[248:251], v[56:59], v[104:107]
    v_mfma_f32_16x16x32_bf16 v[108:111], v[252:255], v[56:59], v[108:111]
    buffer_load_dwordx4 v[56:59], v1, s[4:7], s35 offen offset:3072 sc1
    s_waitcnt vmcnt(11)
    v_mfma_f32_16x16x32_bf16 v[92:95], v[152:155], v[60:63], v[92:95]
    v_mfma_f32_16x16x32_bf16 v[96:99], v[156:159], v[60:63], v[96:99]
    v_mfma_f32_16x16x32_bf16 v[100:103], v[160:163], v[60:63], v[100:103]
    v_mfma_f32_16x16x32_bf16 v[104:107], v[164:167], v[60:63], v[104:107]
    v_mfma_f32_16x16x32_bf16 v[108:111], v[168:171], v[60:63], v[108:111]
    buffer_load_dwordx4 v[60:63], v172, s[4:7], s35 offen offset:0 sc1
    s_waitcnt vmcnt(11)
    v_mfma_f32_16x16x32_bf16 v[92:95], v[112:115], v[64:67], v[92:95]
    v_mfma_f32_16x16x32_bf16 v[96:99], v[116:119], v[64:67], v[96:99]
    v_mfma_f32_16x16x32_bf16 v[100:103], v[120:123], v[64:67], v[100:103]
    v_mfma_f32_16x16x32_bf16 v[104:107], v[124:127], v[64:67], v[104:107]
    v_mfma_f32_16x16x32_bf16 v[108:111], v[128:131], v[64:67], v[108:111]
    buffer_load_dwordx4 v[64:67], v172, s[4:7], s35 offen offset:1024 sc1
    s_nop 3
    ds_write_b128 v0, v[92:95] offset:0
    ds_write_b128 v0, v[96:99] offset:64
    ds_write_b128 v0, v[100:103] offset:128
    ds_write_b128 v0, v[104:107] offset:192
    ds_write_b128 v0, v[108:111] offset:256
    v_xor_b32 v0, 0x10000, v0
    s_waitcnt vmcnt(11)
    v_mfma_f32_16x16x32_bf16 v[72:75], v[176:179], v[16:19], 0
    v_mfma_f32_16x16x32_bf16 v[76:79], v[180:183], v[16:19], 0
    v_mfma_f32_16x16x32_bf16 v[80:83], v[184:187], v[16:19], 0
    v_mfma_f32_16x16x32_bf16 v[84:87], v[188:191], v[16:19], 0
    v_mfma_f32_16x16x32_bf16 v[88:91], v[192:195], v[16:19], 0
    s_waitcnt vmcnt(10)
    v_mfma_f32_16x16x32_bf16 v[72:75], v[196:199], v[20:23], v[72:75]
    v_mfma_f32_16x16x32_bf16 v[76:79], v[200:203], v[20:23], v[76:79]
    v_mfma_f32_16x16x32_bf16 v[80:83], v[204:207], v[20:23], v[80:83]
    v_mfma_f32_16x16x32_bf16 v[84:87], v[208:211], v[20:23], v[84:87]
    v_mfma_f32_16x16x32_bf16 v[88:91], v[212:215], v[20:23], v[88:91]
    s_waitcnt lgkmcnt(0)
    s_barrier
    s_waitcnt vmcnt(9)
    v_mfma_f32_16x16x32_bf16 v[72:75], v[216:219], v[24:27], v[72:75]
    v_mfma_f32_16x16x32_bf16 v[76:79], v[220:223], v[24:27], v[76:79]
    v_mfma_f32_16x16x32_bf16 v[80:83], v[224:227], v[24:27], v[80:83]
    v_mfma_f32_16x16x32_bf16 v[84:87], v[228:231], v[24:27], v[84:87]
    v_mfma_f32_16x16x32_bf16 v[88:91], v[232:235], v[24:27], v[88:91]
    s_waitcnt vmcnt(8)
    v_mfma_f32_16x16x32_bf16 v[72:75], v[236:239], v[28:31], v[72:75]
    v_mfma_f32_16x16x32_bf16 v[76:79], v[240:243], v[28:31], v[76:79]
    v_mfma_f32_16x16x32_bf16 v[80:83], v[244:247], v[28:31], v[80:83]
    v_mfma_f32_16x16x32_bf16 v[84:87], v[248:251], v[28:31], v[84:87]
    v_mfma_f32_16x16x32_bf16 v[88:91], v[252:255], v[28:31], v[88:91]
    s_waitcnt vmcnt(7)
    v_mfma_f32_16x16x32_bf16 v[72:75], v[152:155], v[32:35], v[72:75]
    v_mfma_f32_16x16x32_bf16 v[76:79], v[156:159], v[32:35], v[76:79]
    v_mfma_f32_16x16x32_bf16 v[80:83], v[160:163], v[32:35], v[80:83]
    v_mfma_f32_16x16x32_bf16 v[84:87], v[164:167], v[32:35], v[84:87]
    v_mfma_f32_16x16x32_bf16 v[88:91], v[168:171], v[32:35], v[88:91]
    s_waitcnt vmcnt(6)
    v_mfma_f32_16x16x32_bf16 v[72:75], v[112:115], v[36:39], v[72:75]
    v_mfma_f32_16x16x32_bf16 v[76:79], v[116:119], v[36:39], v[76:79]
    v_mfma_f32_16x16x32_bf16 v[80:83], v[120:123], v[36:39], v[80:83]
    v_mfma_f32_16x16x32_bf16 v[84:87], v[124:127], v[36:39], v[84:87]
    v_mfma_f32_16x16x32_bf16 v[88:91], v[128:131], v[36:39], v[88:91]
    s_nop 3
    ds_write_b128 v0, v[72:75] offset:0
    ds_write_b128 v0, v[76:79] offset:64
    ds_write_b128 v0, v[80:83] offset:128
    ds_write_b128 v0, v[84:87] offset:192
    ds_write_b128 v0, v[88:91] offset:256
    v_xor_b32 v0, 0x10000, v0
    s_waitcnt vmcnt(5)
    v_mfma_f32_16x16x32_bf16 v[92:95], v[176:179], v[44:47], 0
    v_mfma_f32_16x16x32_bf16 v[96:99], v[180:183], v[44:47], 0
    v_mfma_f32_16x16x32_bf16 v[100:103], v[184:187], v[44:47], 0
    v_mfma_f32_16x16x32_bf16 v[104:107], v[188:191], v[44:47], 0
    v_mfma_f32_16x16x32_bf16 v[108:111], v[192:195], v[44:47], 0
    s_waitcnt vmcnt(4)
    v_mfma_f32_16x16x32_bf16 v[92:95], v[196:199], v[48:51], v[92:95]
    v_mfma_f32_16x16x32_bf16 v[96:99], v[200:203], v[48:51], v[96:99]
    v_mfma_f32_16x16x32_bf16 v[100:103], v[204:207], v[48:51], v[100:103]
    v_mfma_f32_16x16x32_bf16 v[104:107], v[208:211], v[48:51], v[104:107]
    v_mfma_f32_16x16x32_bf16 v[108:111], v[212:215], v[48:51], v[108:111]
    s_waitcnt lgkmcnt(0)
    s_barrier
    s_waitcnt vmcnt(3)
    v_mfma_f32_16x16x32_bf16 v[92:95], v[216:219], v[52:55], v[92:95]
    v_mfma_f32_16x16x32_bf16 v[96:99], v[220:223], v[52:55], v[96:99]
    v_mfma_f32_16x16x32_bf16 v[100:103], v[224:227], v[52:55], v[100:103]
    v_mfma_f32_16x16x32_bf16 v[104:107], v[228:231], v[52:55], v[104:107]
    v_mfma_f32_16x16x32_bf16 v[108:111], v[232:235], v[52:55], v[108:111]
    s_waitcnt vmcnt(2)
    v_mfma_f32_16x16x32_bf16 v[92:95], v[236:239], v[56:59], v[92:95]
    v_mfma_f32_16x16x32_bf16 v[96:99], v[240:243], v[56:59], v[96:99]
    v_mfma_f32_16x16x32_bf16 v[100:103], v[244:247], v[56:59], v[100:103]
    v_mfma_f32_16x16x32_bf16 v[104:107], v[248:251], v[56:59], v[104:107]
    v_mfma_f32_16x16x32_bf16 v[108:111], v[252:255], v[56:59], v[108:111]
    s_waitcnt vmcnt(1)
    v_mfma_f32_16x16x32_bf16 v[92:95], v[152:155], v[60:63], v[92:95]
    v_mfma_f32_16x16x32_bf16 v[96:99], v[156:159], v[60:63], v[96:99]
    v_mfma_f32_16x16x32_bf16 v[100:103], v[160:163], v[60:63], v[100:103]
    v_mfma_f32_16x16x32_bf16 v[104:107], v[164:167], v[60:63], v[104:107]
    v_mfma_f32_16x16x32_bf16 v[108:111], v[168:171], v[60:63], v[108:111]
    s_waitcnt vmcnt(0)
    v_mfma_f32_16x16x32_bf16 v[92:95], v[112:115], v[64:67], v[92:95]
    v_mfma_f32_16x16x32_bf16 v[96:99], v[116:119], v[64:67], v[96:99]
    v_mfma_f32_16x16x32_bf16 v[100:103], v[120:123], v[64:67], v[100:103]
    v_mfma_f32_16x16x32_bf16 v[104:107], v[124:127], v[64:67], v[104:107]
    v_mfma_f32_16x16x32_bf16 v[108:111], v[128:131], v[64:67], v[108:111]
    s_nop 3
    ds_write_b128 v0, v[92:95] offset:0
    ds_write_b128 v0, v[96:99] offset:64
    ds_write_b128 v0, v[100:103] offset:128
    ds_write_b128 v0, v[104:107] offset:192
    ds_write_b128 v0, v[108:111] offset:256
    v_xor_b32 v0, 0x10000, v0
    s_waitcnt lgkmcnt(0)
    s_barrier
    s_branch k2_fin
k2_t70:
    s_add_u32 s47, s47, 40960
    buffer_load_dwordx4 v[112:115], v1, s[4:7], s47 offen offset:0
    buffer_load_dwordx4 v[116:119], v1, s[4:7], s47 offen offset:1024
    buffer_load_dwordx4 v[120:123], v1, s[4:7], s47 offen offset:2048
    buffer_load_dwordx4 v[124:127], v1, s[4:7], s47 offen offset:3072
    buffer_load_dwordx4 v[128:131], v172, s[4:7], s47 offen offset:0
    s_add_u32 s47, s47, 40960
    buffer_load_dwordx4 v[132:135], v1, s[4:7], s47 offen offset:0
    buffer_load_dwordx4 v[136:139], v1, s[4:7], s47 offen offset:1024
    buffer_load_dwordx4 v[140:143], v1, s[4:7], s47 offen offset:2048
    buffer_load_dwordx4 v[144:147], v1, s[4:7], s47 offen offset:3072
    buffer_load_dwordx4 v[148:151], v172, s[4:7], s47 offen offset:0
    s_mov_b64 exec, s[52:53]
k2_p70:
    buffer_load_dword v14, v13, s[4:7], s30 offen sc1
    s_sub_u32 s45, s45, 1
    s_cbranch_scc1 k2_p70x
    s_waitcnt vmcnt(0)
    v_cmp_eq_u32 vcc, 0, v14
    s_and_b64 exec, exec, vcc
    s_cbranch_vccnz k2_p70
k2_p70x:
    s_mov_b64 exec, -1
    s_waitcnt lgkmcnt(0)
    buffer_load_dwordx4 v[16:19], v1, s[4:7], s32 offen offset:0 sc1
    buffer_load_dwordx4 v[20:23], v1, s[4:7], s32 offen offset:1024 sc1
    buffer_load_dwordx4 v[24:27], v1, s[4:7], s32 offen offset:2048 sc1
    buffer_load_dwordx4 v[28:31], v1, s[4:7], s32 offen offset:3072 sc1
    buffer_load_dwordx4 v[32:35], v172, s[4:7], s32 offen offset:0 sc1
    buffer_load_dwordx4 v[36:39], v172, s[4:7], s32 offen offset:1024 sc1
    buffer_load_dwordx4 v[40:43], v172, s[4:7], s32 offen offset:2048 sc1
    buffer_load_dwordx4 v[44:47], v1, s[4:7], s33 offen offset:0 sc1
    buffer_load_dwordx4 v[48:51], v1, s[4:7], s33 offen offset:1024 sc1
    buffer_load_dwordx4 v[52:55], v1, s[4:7], s33 offen offset:2048 sc1
    buffer_load_dwordx4 v[56:59], v1, s[4:7], s33 offen offset:3072 sc1
    buffer_load_dwordx4 v[60:63], v172, s[4:7], s33 offen offset:0 sc1
    buffer_load_dwordx4 v[64:67], v172, s[4:7], s33 offen offset:1024 sc1
    buffer_load_dwordx4 v[68:71], v172, s[4:7], s33 offen offset:2048 sc1
    s_waitcnt vmcnt(13)
    v_mfma_f32_16x16x32_bf16 v[72:75], v[176:179], v[16:19], 0
    v_mfma_f32_16x16x32_bf16 v[76:79], v[180:183], v[16:19], 0
    v_mfma_f32_16x16x32_bf16 v[80:83], v[184:187], v[16:19], 0
    v_mfma_f32_16x16x32_bf16 v[84:87], v[188:191], v[16:19], 0
    v_mfma_f32_16x16x32_bf16 v[88:91], v[192:195], v[16:19], 0
    buffer_load_dwordx4 v[16:19], v1, s[4:7], s34 offen offset:0 sc1
    s_waitcnt vmcnt(13)
    v_mfma_f32_16x16x32_bf16 v[72:75], v[196:199], v[20:23], v[72:75]
    v_mfma_f32_16x16x32_bf16 v[76:79], v[200:203], v[20:23], v[76:79]
    v_mfma_f32_16x16x32_bf16 v[80:83], v[204:207], v[20:23], v[80:83]
    v_mfma_f32_16x16x32_bf16 v[84:87], v[208:211], v[20:23], v[84:87]
    v_mfma_f32_16x16x32_bf16 v[88:91], v[212:215], v[20:23], v[88:91]
    buffer_load_dwordx4 v[20:23], v1, s[4:7], s34 offen offset:1024 sc1
    s_waitcnt vmcnt(13)
    v_mfma_f32_16x16x32_bf16 v[72:75], v[216:219], v[24:27], v[72:75]
    v_mfma_f32_16x16x32_bf16 v[76:79], v[220:223], v[24:27], v[76:79]
    v_mfma_f32_16x16x32_bf16 v[80:83], v[224:227], v[24:27], v[80:83]
    v_mfma_f32_16x16x32_bf16 v[84:87], v[228:231], v[24:27], v[84:87]
    v_mfma_f32_16x16x32_bf16 v[88:91], v[232:235], v[24:27], v[88:91]
    buffer_load_dwordx4 v[24:27], v1, s[4:7], s34 offen offset:2048 sc1
    s_waitcnt vmcnt(13)
    v_mfma_f32_16x16x32_bf16 v[72:75], v[236:239], v[28:31], v[72:75]
    v_mfma_f32_16x16x32_bf16 v[76:79], v[240:243], v[28:31], v[76:79]
    v_mfma_f32_16x16x32_bf16 v[80:83], v[244:247], v[28:31], v[80:83]
    v_mfma_f32_16x16x32_bf16 v[84:87], v[248:251], v[28:31], v[84:87]
    v_mfma_f32_16x16x32_bf16 v[88:91], v[252:255], v[28:31], v[88:91]
    buffer_load_dwordx4 v[28:31], v1, s[4:7], s34 offen offset:3072 sc1
    s_waitcnt vmcnt(13)
    v_mfma_f32_16x16x32_bf16 v[72:75], v[152:155], v[32:35], v[72:75]
    v_mfma_f32_16x16x32_bf16 v[76:79], v[156:159], v[32:35], v[76:79]
    v_mfma_f32_16x16x32_bf16 v[80:83], v[160:163], v[32:35], v[80:83]
    v_mfma_f32_16x16x32_bf16 v[84:87], v[164:167], v[32:35], v[84:87]
    v_mfma_f32_16x16x32_bf16 v[88:91], v[168:171], v[32:35], v[88:91]
    buffer_load_dwordx4 v[32:35], v172, s[4:7], s34 offen offset:0 sc1
    s_waitcnt vmcnt(13)
    v_mfma_f32_16x16x32_bf16 v[72:75], v[112:115], v[36:39], v[72:75]
    v_mfma_f32_16x16x32_bf16 v[76:79], v[116:119], v[36:39], v[76:79]
    v_mfma_f32_16x16x32_bf16 v[80:83], v[120:123], v[36:39], v[80:83]
    v_mfma_f32_16x16x32_bf16 v[84:87], v[124:127], v[36:39], v[84:87]
    v_mfma_f32_16x16x32_bf16 v[88:91], v[128:131], v[36:39], v[88:91]
    buffer_load_dwordx4 v[36:39], v172, s[4:7], s34 offen offset:1024 sc1
    s_waitcnt vmcnt(13)
    v_mfma_f32_16x16x32_bf16 v[72:75], v[132:135], v[40:43], v[72:75]
    v_mfma_f32_16x16x32_bf16 v[76:79], v[136:139], v[40:43], v[76:79]
    v_mfma_f32_16x16x32_bf16 v[80:83], v[140:143], v[40:43], v[80:83]
    v_mfma_f32_16x16x32_bf16 v[84:87], v[144:147], v[40:43], v[84:87]
    v_mfma_f32_16x16x32_bf16 v[88:91], v[148:151], v[40:43], v[88:91]
    buffer_load_dwordx4 v[40:43], v172, s[4:7], s34 offen offset:2048 sc1
    s_nop 3
    ds_write_b128 v0, v[72:75] offset:0
    ds_write_b128 v0, v[76:79] offset:64
    ds_write_b128 v0, v[80:83] offset:128
    ds_write_b128 v0, v[84:87] offset:192
    ds_write_b128 v0, v[88:91] offset:256
    v_xor_b32 v0, 0x10000, v0
    s_waitcnt vmcnt(13)
    v_mfma_f32_16x16x32_bf16 v[92:95], v[176:179], v[44:47], 0
    v_mfma_f32_16x16x32_bf16 v[96:99], v[180:183], v[44:47], 0
    v_mfma_f32_16x16x32_bf16 v[100:103], v[184:187], v[44:47], 0
    v_mfma_f32_16x16x32_bf16 v[104:107], v[188:191], v[44:47], 0
    v_mfma_f32_16x16x32_bf16 v[108:111], v[192:195], v[44:47], 0
    buffer_load_dwordx4 v[44:47], v1, s[4:7], s35 offen offset:0 sc1
    s_waitcnt vmcnt(13)
    v_mfma_f32_16x16x32_bf16 v[92:95], v[196:199], v[48:51], v[92:95]
    v_mfma_f32_16x16x32_bf16 v[96:99], v[200:203], v[48:51], v[96:99]
    v_mfma_f32_16x16x32_bf16 v[100:103], v[204:207], v[48:51], v[100:103]
    v_mfma_f32_16x16x32_bf16 v[104:107], v[208:211], v[48:51], v[104:107]
    v_mfma_f32_16x16x32_bf16 v[108:111], v[212:215], v[48:51], v[108:111]
    buffer_load_dwordx4 v[48:51], v1, s[4:7], s35 offen offset:1024 sc1
    s_waitcnt lgkmcnt(0)
    s_barrier
    s_waitcnt vmcnt(13)
    v_mfma_f32_16x16x32_bf16 v[92:95], v[216:219], v[52:55], v[92:95]
    v_mfma_f32_16x16x32_bf16 v[96:99], v[220:223], v[52:55], v[96:99]
    v_mfma_f32_16x16x32_bf16 v[100:103], v[224:227], v[52:55], v[100:103]
    v_mfma_f32_16x16x32_bf16 v[104:107], v[228:231], v[52:55], v[104:107]
    v_mfma_f32_16x16x32_bf16 v[108:111], v[232:235], v[52:55], v[108:111]
    buffer_load_dwordx4 v[52:55], v1, s[4:7], s35 offen offset:2048 sc1
    s_waitcnt vmcnt(13)
    v_mfma_f32_16x16x32_bf16 v[92:95], v[236:239], v[56:59], v[92:95]
    v_mfma_f32_16x16x32_bf16 v[96:99], v[240:243], v[56:59], v[96:99]
    v_mfma_f32_16x16x32_bf16 v[100:103], v[244:247], v[56:59], v[100:103]
    v_mfma_f32_16x16x32_bf16 v[104:107], v[248:251], v[56:59], v[104:107]
    v_mfma_f32_16x16x32_bf16 v[108:111], v[252:255], v[56:59], v[108:111]
    buffer_load_dwordx4 v[56:59], v1, s[4:7], s35 offen offset:3072 sc1
    s_waitcnt vmcnt(13)
    v_mfma_f32_16x16x32_bf16 v[92:95], v[152:155], v[60:63], v[92:95]
    v_mfma_f32_16x16x32_bf16 v[96:99], v[156:159], v[60:63], v[96:99]
    v_mfma_f32_16x16x32_bf16 v[100:103], v[160:163], v[60:63], v[100:103]
    v_mfma_f32_16x16x32_bf16 v[104:107], v[164:167], v[60:63], v[104:107]
    v_mfma_f32_16x16x32_bf16 v[108:111], v[168:171], v[60:63], v[108:111]
    buffer_load_dwordx4 v[60:63], v172, s[4:7], s35 offen offset:0 sc1
    s_waitcnt vmcnt(13)
    v_mfma_f32_16x16x32_bf16 v[92:95], v[112:115], v[64:67], v[92:95]
    v_mfma_f32_16x16x32_bf16 v[96:99], v[116:119], v[64:67], v[96:99]
    v_mfma_f32_16x16x32_bf16 v[100:103], v[120:123], v[64:67], v[100:103]
    v_mfma_f32_16x16x32_bf16 v[104:107], v[124:127], v[64:67], v[104:107]
    v_mfma_f32_16x16x32_bf16 v[108:111], v[128:131], v[64:67], v[108:111]
    buffer_load_dwordx4 v[64:67], v172, s[4:7], s35 offen offset:1024 sc1
    s_waitcnt vmcnt(13)
    v_mfma_f32_16x16x32_bf16 v[92:95], v[132:135], v[68:71], v[92:95]
    v_mfma_f32_16x16x32_bf16 v[96:99], v[136:139], v[68:71], v[96:99]
    v_mfma_f32_16x16x32_bf16 v[100:103], v[140:143], v[68:71], v[100:103]
    v_mfma_f32_16x16x32_bf16 v[104:107], v[144:147], v[68:71], v[104:107]
    v_mfma_f32_16x16x32_bf16 v[108:111], v[148:151], v[68:71], v[108:111]
    buffer_load_dwordx4 v[68:71], v172, s[4:7], s35 offen offset:2048 sc1
    s_nop 3
    ds_write_b128 v0, v[92:95] offset:0
    ds_write_b128 v0, v[96:99] offset:64
    ds_write_b128 v0, v[100:103] offset:128
    ds_write_b128 v0, v[104:107] offset:192
    ds_write_b128 v0, v[108:111] offset:256
    v_xor_b32 v0, 0x10000, v0
    s_waitcnt vmcnt(13)
    v_mfma_f32_16x16x32_bf16 v[72:75], v[176:179], v[16:19], 0
    v_mfma_f32_16x16x32_bf16 v[76:79], v[180:183], v[16:19], 0
    v_mfma_f32_16x16x32_bf16 v[80:83], v[184:187], v[16:19], 0
    v_mfma_f32_16x16x32_bf16 v[84:87], v[188:191], v[16:19], 0
    v_mfma_f32_16x16x32_bf16 v[88:91], v[192:195], v[16:19], 0
    s_waitcnt vmcnt(12)
    v_mfma_f32_16x16x32_bf16 v[72:75], v[196:199], v[20:23], v[72:75]
    v_mfma_f32_16x16x32_bf16 v[76:79], v[200:203], v[20:23], v[76:79]
    v_mfma_f32_16x16x32_bf16 v[80:83], v[204:207], v[20:23], v[80:83]
    v_mfma_f32_16x16x32_bf16 v[84:87], v[208:211], v[20:23], v[84:87]
    v_mfma_f32_16x16x32_bf16 v[88:91], v[212:215], v[20:23], v[88:91]
    s_waitcnt lgkmcnt(0)
    s_barrier
    s_waitcnt vmcnt(11)
    v_mfma_f32_16x16x32_bf16 v[72:75], v[216:219], v[24:27], v[72:75]
    v_mfma_f32_16x16x32_bf16 v[76:79], v[220:223], v[24:27], v[76:79]
    v_mfma_f32_16x16x32_bf16 v[80:83], v[224:227], v[24:27], v[80:83]
    v_mfma_f32_16x16x32_bf16 v[84:87], v[228:231], v[24:27], v[84:87]
    v_mfma_f32_16x16x32_bf16 v[88:91], v[232:235], v[24:27], v[88:91]
    s_waitcnt vmcnt(10)
    v_mfma_f32_16x16x32_bf16 v[72:75], v[236:239], v[28:31], v[72:75]
    v_mfma_f32_16x16x32_bf16 v[76:79], v[240:243], v[28:31], v[76:79]
    v_mfma_f32_16x16x32_bf16 v[80:83], v[244:247], v[28:31], v[80:83]
    v_mfma_f32_16x16x32_bf16 v[84:87], v[248:251], v[28:31], v[84:87]
    v_mfma_f32_16x16x32_bf16 v[88:91], v[252:255], v[28:31], v[88:91]
    s_waitcnt vmcnt(9)
    v_mfma_f32_16x16x32_bf16 v[72:75], v[152:155], v[32:35], v[72:75]
    v_mfma_f32_16x16x32_bf16 v[76:79], v[156:159], v[32:35], v[76:79]
    v_mfma_f32_16x16x32_bf16 v[80:83], v[160:163], v[32:35], v[80:83]
    v_mfma_f32_16x16x32_bf16 v[84:87], v[164:167], v[32:35], v[84:87]
    v_mfma_f32_16x16x32_bf16 v[88:91], v[168:171], v[32:35], v[88:91]
    s_waitcnt vmcnt(8)
    v_mfma_f32_16x16x32_bf16 v[72:75], v[112:115], v[36:39], v[72:75]
    v_mfma_f32_16x16x32_bf16 v[76:79], v[116:119], v[36:39], v[76:79]
    v_mfma_f32_16x16x32_bf16 v[80:83], v[120:123], v[36:39], v[80:83]
    v_mfma_f32_16x16x32_bf16 v[84:87], v[124:127], v[36:39], v[84:87]
    v_mfma_f32_16x16x32_bf16 v[88:91], v[128:131], v[36:39], v[88:91]
    s_waitcnt vmcnt(7)
    v_mfma_f32_16x16x32_bf16 v[72:75], v[132:135], v[40:43], v[72:75]
    v_mfma_f32_16x16x32_bf16 v[76:79], v[136:139], v[40:43], v[76:79]
    v_mfma_f32_16x16x32_bf16 v[80:83], v[140:143], v[40:43], v[80:83]
    v_mfma_f32_16x16x32_bf16 v[84:87], v[144:147], v[40:43], v[84:87]
    v_mfma_f32_16x16x32_bf16 v[88:91], v[148:151], v[40:43], v[88:91]
    s_nop 3
    ds_write_b128 v0, v[72:75] offset:0
    ds_write_b128 v0, v[76:79] offset:64
    ds_write_b128 v0, v[80:83] offset:128
    ds_write_b128 v0, v[84:87] offset:192
    ds_write_b128 v0, v[88:91] offset:256
    v_xor_b32 v0, 0x10000, v0
    s_waitcnt vmcnt(6)
    v_mfma_f32_16x16x32_bf16 v[92:95], v[176:179], v[44:47], 0
    v_mfma_f32_16x16x32_bf16 v[96:99], v[180:183], v[44:47], 0
    v_mfma_f32_16x16x32_bf16 v[100:103], v[184:187], v[44:47], 0
    v_mfma_f32_16x16x32_bf16 v[104:107], v[188:191], v[44:47], 0
    v_mfma_f32_16x16x32_bf16 v[108:111], v[192:195], v[44:47], 0
    s_waitcnt vmcnt(5)
    v_mfma_f32_16x16x32_bf16 v[92:95], v[196:199], v[48:51], v[92:95]
    v_mfma_f32_16x16x32_bf16 v[96:99], v[200:203], v[48:51], v[96:99]
    v_mfma_f32_16x16x32_bf16 v[100:103], v[204:207], v[48:51], v[100:103]
    v_mfma_f32_16x16x32_bf16 v[104:107], v[208:211], v[48:51], v[104:107]
    v_mfma_f32_16x16x32_bf16 v[108:111], v[212:215], v[48:51], v[108:111]
    s_waitcnt lgkmcnt(0)
    s_barrier
    s_waitcnt vmcnt(4)
    v_mfma_f32_16x16x32_bf16 v[92:95], v[216:219], v[52:55], v[92:95]
    v_mfma_f32_16x16x32_bf16 v[96:99], v[220:223], v[52:55], v[96:99]
    v_mfma_f32_16x16x32_bf16 v[100:103], v[224:227], v[52:55], v[100:103]
    v_mfma_f32_16x16x32_bf16 v[104:107], v[228:231], v[52:55], v[104:107]
    v_mfma_f32_16x16x32_bf16 v[108:111], v[232:235], v[52:55], v[108:111]
    s_waitcnt vmcnt(3)
    v_mfma_f32_16x16x32_bf16 v[92:95], v[236:239], v[56:59], v[92:95]
    v_mfma_f32_16x16x32_bf16 v[96:99], v[240:243], v[56:59], v[96:99]
    v_mfma_f32_16x16x32_bf16 v[100:103], v[244:247], v[56:59], v[100:103]
    v_mfma_f32_16x16x32_bf16 v[104:107], v[248:251], v[56:59], v[104:107]
    v_mfma_f32_16x16x32_bf16 v[108:111], v[252:255], v[56:59], v[108:111]
    s_waitcnt vmcnt(2)
    v_mfma_f32_16x16x32_bf16 v[92:95], v[152:155], v[60:63], v[92:95]
    v_mfma_f32_16x16x32_bf16 v[96:99], v[156:159], v[60:63], v[96:99]
    v_mfma_f32_16x16x32_bf16 v[100:103], v[160:163], v[60:63], v[100:103]
    v_mfma_f32_16x16x32_bf16 v[104:107], v[164:167], v[60:63], v[104:107]
    v_mfma_f32_16x16x32_bf16 v[108:111], v[168:171], v[60:63], v[108:111]
    s_waitcnt vmcnt(1)
    v_mfma_f32_16x16x32_bf16 v[92:95], v[112:115], v[64:67], v[92:95]
    v_mfma_f32_16x16x32_bf16 v[96:99], v[116:119], v[64:67], v[96:99]
    v_mfma_f32_16x16x32_bf16 v[100:103], v[120:123], v[64:67], v[100:103]
    v_mfma_f32_16x16x32_bf16 v[104:107], v[124:127], v[64:67], v[104:107]
    v_mfma_f32_16x16x32_bf16 v[108:111], v[128:131], v[64:67], v[108:111]
    s_waitcnt vmcnt(0)
    v_mfma_f32_16x16x32_bf16 v[92:95], v[132:135], v[68:71], v[92:95]
    v_mfma_f32_16x16x32_bf16 v[96:99], v[136:139], v[68:71], v[96:99]
    v_mfma_f32_16x16x32_bf16 v[100:103], v[140:143], v[68:71], v[100:103]
    v_mfma_f32_16x16x32_bf16 v[104:107], v[144:147], v[68:71], v[104:107]
    v_mfma_f32_16x16x32_bf16 v[108:111], v[148:151], v[68:71], v[108:111]
    s_nop 3
    ds_write_b128 v0, v[92:95] offset:0
    ds_write_b128 v0, v[96:99] offset:64
    ds_write_b128 v0, v[100:103] offset:128
    ds_write_b128 v0, v[104:107] offset:192
    ds_write_b128 v0, v[108:111] offset:256
    v_xor_b32 v0, 0x10000, v0
    s_waitcnt lgkmcnt(0)
    s_barrier
k2_fin:
k2_end:
    s_endpgm
k2_slow:
    v_and_b32 v12, 31, v0
    v_lshlrev_b32 v12, 3, v12
    v_mov_b32 v14, 0xff800000
    v_mov_b32 v15, 0xff800000
    s_mov_b32 s38, 0
k2_sl0:
    s_lshr_b32 s29, s38, 1
    s_mul_i32 s29, s29, 6656
    s_add_u32 s29, s29, s31
    s_and_b32 s30, s38, 1
    s_lshl_b32 s50, s30, 8
    s_add_u32 s50, s50, s29
    s_add_u32 s50, s50, 6144
    s_lshl_b32 s30, s30, 10
    s_add_u32 s29, s29, s30
    s_add_u32 s30, s29, s30
    buffer_load_dwordx4 v[124:127], v1, s[4:7], s29 offen
    buffer_load_dwordx2 v[128:129], v12, s[4:7], s50 offen
    buffer_load_dwordx4 v[132:135], v1, s[4:7], s30 offen offset:2048
    buffer_load_dwordx4 v[136:139], v1, s[4:7], s30 offen offset:3072
    s_waitcnt vmcnt(0)
    v_mfma_f32_32x32x16_bf16 v[16:31], v[124:127], v[112:115], 0
    v_mfma_f32_32x32x8_bf16 v[16:31], v[128:129], v[120:121], v[16:31]
    v_mfma_f32_32x32x16_bf16 v[32:47], v[124:127], v[116:119], 0
    v_mfma_f32_32x32x8_bf16 v[32:47], v[128:129], v[122:123], v[32:47]
    s_nop 11
    v_max_f32 v14, v14, v16
    v_max_f32 v14, v14, v17
    v_max_f32 v14, v14, v18
    v_max_f32 v14, v14, v19
    v_max_f32 v14, v14, v20
    v_max_f32 v14, v14, v21
    v_max_f32 v14, v14, v22
    v_max_f32 v14, v14, v23
    v_max_f32 v14, v14, v24
    v_max_f32 v14, v14, v25
    v_max_f32 v14, v14, v26
    v_max_f32 v14, v14, v27
    v_max_f32 v14, v14, v28
    v_max_f32 v14, v14, v29
    v_max_f32 v14, v14, v30
    v_max_f32 v14, v14, v31
    v_max_f32 v15, v15, v32
    v_max_f32 v15, v15, v33
    v_max_f32 v15, v15, v34
    v_max_f32 v15, v15, v35
    v_max_f32 v15, v15, v36
    v_max_f32 v15, v15, v37
    v_max_f32 v15, v15, v38
    v_max_f32 v15, v15, v39
    v_max_f32 v15, v15, v40
    v_max_f32 v15, v15, v41
    v_max_f32 v15, v15, v42
    v_max_f32 v15, v15, v43
    v_max_f32 v15, v15, v44
    v_max_f32 v15, v15, v45
    v_max_f32 v15, v15, v46
    v_max_f32 v15, v15, v47
    s_add_u32 s38, s38, 1
    s_cmp_lt_u32 s38, 64
    s_cbranch_scc1 k2_sl0
    v_mov_b32 v13, v14
    s_nop 1
    v_permlane32_swap_b32 v13, v14
    s_nop 0
    v_max_f32 v14, v13, v14
    v_mov_b32 v13, v15
    s_nop 1
    v_permlane32_swap_b32 v13, v15
    s_nop 0
    v_max_f32 v15, v13, v15
    v_sub_f32 v80, 0, v14
    v_mov_b32 v48, 0
    v_sub_f32 v81, 0, v14
    v_mov_b32 v49, 0
    v_sub_f32 v82, 0, v14
    v_mov_b32 v50, 0
    v_sub_f32 v83, 0, v14
    v_mov_b32 v51, 0
    v_sub_f32 v84, 0, v14
    v_mov_b32 v52, 0
    v_sub_f32 v85, 0, v14
    v_mov_b32 v53, 0
    v_sub_f32 v86, 0, v14
    v_mov_b32 v54, 0
    v_sub_f32 v87, 0, v14
    v_mov_b32 v55, 0
    v_sub_f32 v88, 0, v14
    v_mov_b32 v56, 0
    v_sub_f32 v89, 0, v14
    v_mov_b32 v57, 0
    v_sub_f32 v90, 0, v14
    v_mov_b32 v58, 0
    v_sub_f32 v91, 0, v14
    v_mov_b32 v59, 0
    v_sub_f32 v92, 0, v14
    v_mov_b32 v60, 0
    v_sub_f32 v93, 0, v14
    v_mov_b32 v61, 0
    v_sub_f32 v94, 0, v14
    v_mov_b32 v62, 0
    v_sub_f32 v95, 0, v14
    v_mov_b32 v63, 0
    v_sub_f32 v96, 0, v15
    v_mov_b32 v64, 0
    v_sub_f32 v97, 0, v15
    v_mov_b32 v65, 0
    v_sub_f32 v98, 0, v15
    v_mov_b32 v66, 0
    v_sub_f32 v99, 0, v15
    v_mov_b32 v67, 0
    v_sub_f32 v100, 0, v15
    v_mov_b32 v68, 0
    v_sub_f32 v101, 0, v15
    v_mov_b32 v69, 0
    v_sub_f32 v102, 0, v15
    v_mov_b32 v70, 0
    v_sub_f32 v103, 0, v15
    v_mov_b32 v71, 0
    v_sub_f32 v104, 0, v15
    v_mov_b32 v72, 0
    v_sub_f32 v105, 0, v15
    v_mov_b32 v73, 0
    v_sub_f32 v106, 0, v15
    v_mov_b32 v74, 0
    v_sub_f32 v107, 0, v15
    v_mov_b32 v75, 0
    v_sub_f32 v108, 0, v15
    v_mov_b32 v76, 0
    v_sub_f32 v109, 0, v15
    v_mov_b32 v77, 0
    v_sub_f32 v110, 0, v15
    v_mov_b32 v78, 0
    v_sub_f32 v111, 0, v15
    v_mov_b32 v79, 0
    s_mov_b32 s38, 0
k2_sl1:
    s_lshr_b32 s29, s38, 1
    s_mul_i32 s29, s29, 6656
    s_add_u32 s29, s29, s31
    s_and_b32 s30, s38, 1
    s_lshl_b32 s50, s30, 8
    s_add_u32 s50, s50, s29
    s_add_u32 s50, s50, 6144
    s_lshl_b32 s30, s30, 10
    s_add_u32 s29, s29, s30
    s_add_u32 s30, s29, s30
    buffer_load_dwordx4 v[124:127], v1, s[4:7], s29 offen
    buffer_load_dwordx2 v[128:129], v12, s[4:7], s50 offen
    buffer_load_dwordx4 v[132:135], v1, s[4:7], s30 offen offset:2048
    buffer_load_dwordx4 v[136:139], v1, s[4:7], s30 offen offset:3072
    s_waitcnt vmcnt(0)
    v_mfma_f32_32x32x16_bf16 v[16:31], v[124:127], v[112:115], v[80:95]
    v_mfma_f32_32x32x8_bf16 v[16:31], v[128:129], v[120:121], v[16:31]
    v_mfma_f32_32x32x16_bf16 v[32:47], v[124:127], v[116:119], v[96:111]
    v_mfma_f32_32x32x8_bf16 v[32:47], v[128:129], v[122:123], v[32:47]
    s_nop 11
    v_exp_f32 v16, v16
    v_exp_f32 v17, v17
    v_exp_f32 v18, v18
    v_exp_f32 v19, v19
    v_exp_f32 v20, v20
    v_exp_f32 v21, v21
    v_exp_f32 v22, v22
    v_exp_f32 v23, v23
    v_exp_f32 v24, v24
    v_exp_f32 v25, v25
    v_exp_f32 v26, v26
    v_exp_f32 v27, v27
    v_exp_f32 v28, v28
    v_exp_f32 v29, v29
    v_exp_f32 v30, v30
    v_exp_f32 v31, v31
    v_exp_f32 v32, v32
    v_exp_f32 v33, v33
    v_exp_f32 v34, v34
    v_exp_f32 v35, v35
    v_exp_f32 v36, v36
    v_exp_f32 v37, v37
    v_exp_f32 v38, v38
    v_exp_f32 v39, v39
    v_exp_f32 v40, v40
    v_exp_f32 v41, v41
    v_exp_f32 v42, v42
    v_exp_f32 v43, v43
    v_exp_f32 v44, v44
    v_exp_f32 v45, v45
    v_exp_f32 v46, v46
    v_exp_f32 v47, v47
    s_nop 1
    v_smfmac_f32_32x32x32_bf16 v[48:63], v[132:135], v[16:23], v9
    v_smfmac_f32_32x32x32_bf16 v[48:63], v[136:139], v[24:31], v9
    v_smfmac_f32_32x32x32_bf16 v[64:79], v[132:135], v[32:39], v9
    v_smfmac_f32_32x32x32_bf16 v[64:79], v[136:139], v[40:47], v9
    s_add_u32 s38, s38, 1
    s_cmp_lt_u32 s38, 64
    s_cbranch_scc1 k2_sl1
code_end:
    s_nop 11
    s_branch k2_ofin
.section .rodata,"a"
.p2align 6
.amdhsa_kernel k1_kernel
  .amdhsa_next_free_vgpr 512
  .amdhsa_next_free_sgpr 102
  .amdhsa_accum_offset 256
  .amdhsa_group_segment_fixed_size 0
  .amdhsa_kernarg_size 88
  .amdhsa_user_sgpr_count 2
  .amdhsa_user_sgpr_kernarg_segment_ptr 1
  .amdhsa_system_sgpr_workgroup_id_x 1
.end_amdhsa_kernel
.p2align 6
.amdhsa_kernel recurrent_scan__softmax_full_mha__mixer_gmlp__prompt_kernel
  .amdhsa_next_free_vgpr 256
  .amdhsa_next_free_sgpr 102
  .amdhsa_accum_offset 256
  .amdhsa_group_segment_fixed_size 0
  .amdhsa_kernarg_size 88
  .amdhsa_user_sgpr_count 2
  .amdhsa_user_sgpr_kernarg_segment_ptr 1
  .amdhsa_system_sgpr_workgroup_id_x 1
.end_amdhsa_kernel
```
